```python
import torch

def _softmax(x, axis=-1):
    return torch.softmax(x, dim=axis)
def _gelu(x):
    return torch.nn.functional.gelu(x, approximate="tanh")
def _silu(x):
    return torch.nn.functional.silu(x)
def _sigmoid(x):
    return torch.sigmoid(x)
def _layernorm(x, axis=-1, eps=1e-5):
    m = x.mean(dim=axis, keepdim=True)
    v = x.var(dim=axis, keepdim=True, unbiased=False)
    return (x - m) / torch.sqrt(v + eps)
def _scatter_add(tgt, idx, src, axis=0):
    return tgt.clone().index_add_(axis, idx, src)
def _segment_sum(src, seg, n):
    out = torch.zeros((n,) + src.shape[1:], dtype=src.dtype)
    return out.index_add_(0, seg, src)
def _pad(x, pw):
    flat = tuple(v for pair in reversed(pw) for v in pair)
    return torch.nn.functional.pad(x, flat)

kernel_name = 'sequential_preLN__ssm_conv_s4d__mixer_token_mlp__prompt'

def setup_inputs():

    _w = (lambda a: (lambda t: t.to(torch.bfloat16) if t.is_floating_point() else t)(torch.as_tensor(a)))
    def _A_setup():
        Bsz, L, D, N = 1, 2048, 576, 128
        return {
            "u": _w((lambda *s: torch.randn(*s, dtype=torch.bfloat16) * 0.05)(Bsz, L, D)),
            "log_A_real": _w((lambda *s: torch.randn(*s, dtype=torch.bfloat16) * 6.4)(D, N) * 0.5),
            "A_imag": _w((lambda *s: torch.randn(*s, dtype=torch.bfloat16) * 0.05)(D, N) * 3.14),
            "C_real": _w((lambda *s: torch.randn(*s, dtype=torch.bfloat16) * 0.05)(D, N) / N ** 0.5),
            "C_imag": _w((lambda *s: torch.randn(*s, dtype=torch.bfloat16) * 0.05)(D, N) / N ** 0.5),
            "log_dt": _w((lambda *s: torch.randn(*s, dtype=torch.bfloat16) * 0.05)(D) * 0.5 - 4.0),
            "D_skip": _w((lambda *s: torch.randn(*s, dtype=torch.bfloat16) * 0.05)(D)),
        }
    _A_in = _A_setup()

    def _B_setup():
        B, S, D, F = 1, 2048, 576, 4608
        return {
            "x": _w((lambda *s: torch.randn(*s, dtype=torch.bfloat16) * 0.05)(B, S, D)),
            "w1": _w((lambda *s: torch.randn(*s, dtype=torch.bfloat16) * 0.4)(S, F) * (S ** -0.5)),
            "b1": _w((lambda *s: torch.randn(*s, dtype=torch.bfloat16) * 0.1)(F) * 0.02),
            "w2": _w((lambda *s: torch.randn(*s, dtype=torch.bfloat16) * 0.1)(F, S) * (F ** -0.5)),
            "b2": _w((lambda *s: torch.randn(*s, dtype=torch.bfloat16) * 0.1)(S) * 0.02),
        }
    _B_in = _B_setup()

    return {
        "A_u": _A_in["u"],
        "A_log_A_real": _A_in["log_A_real"],
        "A_A_imag": _A_in["A_imag"],
        "A_C_real": _A_in["C_real"],
        "A_C_imag": _A_in["C_imag"],
        "A_log_dt": _A_in["log_dt"],
        "A_D_skip": _A_in["D_skip"],
        "B_x": _B_in["x"],
        "B_w1": _B_in["w1"],
        "B_b1": _B_in["b1"],
        "B_w2": _B_in["w2"],
        "B_b2": _B_in["b2"],
    }

def reference(A_u, A_log_A_real, A_A_imag, A_C_real, A_C_imag, A_log_dt, A_D_skip, B_x, B_w1, B_b1, B_w2, B_b2):
    def _A_ref(u, log_A_real, A_imag, C_real, C_imag, log_dt, D_skip):
        L = u.shape[1]
        dt = torch.exp(log_dt)
        A = -torch.exp(log_A_real) + 1j * A_imag
        C = (C_real + 1j * C_imag) * dt[:, None]
        pos = (lambda x, dt: x.to(dt))(torch.arange(L), log_dt.dtype)
        P = torch.exp((A * dt[:, None])[:, :, None] * pos[None, None, :])
        K = 2.0 * torch.einsum("dn,dnl->dl", C, P).real
        L2 = 2 * L
        u_t = (lambda x, *d: x.permute(*d))(u, 0, 2, 1)
        Kf = (lambda x, *a, **k: torch.fft.rfft(x.float(), *a, **k))(K, L2)
        Uf = (lambda x, *a, **k: torch.fft.rfft(x.float(), *a, **k))(u_t, L2)
        y = (lambda x, *a, **k: torch.fft.irfft(x, *a, **k).to(torch.bfloat16))(Uf * Kf[None, :, :], L2)[:, :, :L]
        y = (lambda x, *d: x.permute(*d))(y, 0, 2, 1)
        return y + u * D_skip[None, None, :]

    def _B_ref(x, w1, b1, w2, b2):
        B, S, D = x.shape
        h = _layernorm(x, axis=-1)
        u = torch.einsum("bsd,sf->bdf", h, w1) + b1
        u = _gelu(u)
        y = torch.einsum("bdf,fs->bds", u, w2) + b2
        return (lambda x, *d: x.permute(*d))(y, 0, 2, 1)

    x = A_u
    h = x + _A_ref(_layernorm(x, axis=-1), A_log_A_real, A_A_imag, A_C_real, A_C_imag, A_log_dt, A_D_skip)
    h2 = h + _B_ref(_layernorm(h, axis=-1), B_w1, B_b1, B_w2, B_b2)
    return h2
```

```asm
; @launch grid=(256,1,1) block=(512,1,1) lds=161104
.amdgcn_target "amdgcn-amd-amdhsa--gfx950"
.text
.globl sequential_preLN__ssm_conv_s4d__mixer_token_mlp__prompt_kernel
.p2align 8
.type sequential_preLN__ssm_conv_s4d__mixer_token_mlp__prompt_kernel,@function
sequential_preLN__ssm_conv_s4d__mixer_token_mlp__prompt_kernel:
    s_cmp_ge_u32 s2, 256
    s_cbranch_scc1 L_all_end
    s_load_dwordx8 s[4:11], s[0:1], 0
    s_load_dwordx4 s[12:15], s[0:1], 32
    s_load_dwordx2 s[16:17], s[0:1], 48
    s_load_dwordx4 s[68:71], s[0:1], 104
    s_load_dwordx2 s[60:61], s[0:1], 64
    s_load_dwordx2 s[56:57], s[0:1], 80
    s_memrealtime s[76:77]

    s_cmp_lt_u32 s2, 32
    s_cbranch_scc0 L_kA_nocpf0
    s_getpc_b64 s[72:73]
L_cpc_1:
    s_sub_u32 s72, s72, L_cpc_1-sequential_preLN__ssm_conv_s4d__mixer_token_mlp__prompt_kernel
    s_subb_u32 s73, s73, 0
    s_and_b32 s73, s73, 0xffff
    s_mov_b32 s74, L_all_end-sequential_preLN__ssm_conv_s4d__mixer_token_mlp__prompt_kernel
    s_mov_b32 s75, 0x00020000
    s_lshr_b32 s64, s2, 3
    s_and_b32 s64, s64, 1
    s_lshl_b32 s64, s64, 16
    v_lshlrev_b32 v158, 7, v0
    buffer_load_dword v157, v158, s[72:75], s64 offen

L_kA_nocpf0:
    v_lshrrev_b32 v1, 6, v0
    v_and_b32 v2, 63, v0
    s_nop 0
    v_readfirstlane_b32 s3, v1
    s_and_b32 s62, s2, 7
    s_lshr_b32 s63, s2, 3
    s_mul_i32 s50, s62, 24
    s_add_u32 s50, s50, s63
    s_mul_i32 s51, s50, 3
    s_mul_i32 s18, s50, 6
    s_and_b32 s19, s18, 2
    s_lshl_b32 s19, s19, 3
    s_and_b32 s18, s18, 0xfffffffc
    s_cmp_lt_u32 s2, 192
    s_cselect_b32 s59, 1, 0
    s_lshr_b32 s62, s3, 1
    s_and_b32 s63, s3, 1
    s_add_u32 s64, s51, s62
    s_lshl_b32 s64, s64, 8
    s_lshl_b32 s65, s63, 7
    s_add_u32 s64, s64, s65
    v_lshlrev_b32 v27, 1, v2

    v_mov_b32 v146, 0
    v_mov_b32 v147, 0
    v_mov_b32 v148, 0
    v_mov_b32 v149, 0
    v_mov_b32 v150, 0
    v_mov_b32 v151, 0
    v_mov_b32 v152, 0
    v_mov_b32 v153, 0
    v_mov_b32 v154, 0
    s_cmp_eq_u32 s3, 0
    s_cbranch_scc0 L_kA_noinit
    v_mov_b32 v32, 0
    v_mov_b32 v33, 0
    v_mov_b32 v34, 0
    v_mov_b32 v35, 0
    v_lshlrev_b32 v36, 4, v0
    v_add_u32 v36, 115024, v36
    s_mov_b32 exec_hi, 0
    ds_write_b128 v36, v[32:35]
    ds_write_b128 v36, v[32:35] offset:4608
    ds_write_b128 v36, v[32:35] offset:9216
    v_mov_b32 v36, 98484
    ds_write_b32 v36, v32
    ds_write_b32 v36, v32 offset:8224
    ds_write_b32 v36, v32 offset:16448
    v_mov_b32 v36, 114976
    ds_write_b128 v36, v[32:35]
    ds_write_b128 v36, v[32:35] offset:16
    ds_write_b128 v36, v[32:35] offset:32
    s_mov_b32 exec_hi, -1

L_kA_noinit:
    s_waitcnt lgkmcnt(0)
    s_cmp_ge_u32 s3, 6
    s_cbranch_scc1 L_kA_uw
    s_mov_b32 s24, s70
    s_and_b32 s25, s71, 0xffff
    s_mov_b32 s26, 268435456
    s_mov_b32 s27, 0x00020000
    s_mov_b32 s20, s4
    s_and_b32 s21, s5, 0xffff
    s_mov_b32 s22, 2359296
    s_mov_b32 s23, 0x00020000
    s_cmp_eq_u32 s59, 0
    s_cbranch_scc1 L_kA_extra0
    s_mov_b32 s28, s6
    s_and_b32 s29, s7, 0xffff
    s_mov_b32 s30, 147456
    s_mov_b32 s31, 0x00020000
    s_mov_b32 s32, s8
    s_and_b32 s33, s9, 0xffff
    s_mov_b32 s34, 147456
    s_mov_b32 s35, 0x00020000
    s_mov_b32 s36, s10
    s_and_b32 s37, s11, 0xffff
    s_mov_b32 s38, 147456
    s_mov_b32 s39, 0x00020000
    s_mov_b32 s40, s12
    s_and_b32 s41, s13, 0xffff
    s_mov_b32 s42, 147456
    s_mov_b32 s43, 0x00020000
    buffer_load_ushort v28, v27, s[28:31], s64 offen
    buffer_load_ushort v29, v27, s[32:35], s64 offen
    buffer_load_ushort v30, v27, s[36:39], s64 offen
    buffer_load_ushort v31, v27, s[40:43], s64 offen
    s_load_dwordx2 s[52:53], s[14:15], s18
    s_load_dwordx2 s[54:55], s[16:17], s18
    s_barrier

    s_lshl_b32 s65, s63, 7
    v_add_u32 v24, s65, v2
    v_lshlrev_b32 v24, 3, v24
    v_mov_b32 v26, 2049
    s_mul_i32 s66, s62, 8224
    s_add_u32 s66, s66, 90288

    v_sub_u32 v25, 2048, v24
    v_cmp_gt_u32 vcc, 2048, v25
    v_cvt_f32_i32 v84, v25
    v_cvt_pk_bf16_f32 v84, v84, v84
    v_lshlrev_b32 v84, 16, v84
    v_cvt_i32_f32 v84, v84
    v_cndmask_b32 v84, v26, v84, vcc
    v_lshl_add_u32 v84, v84, 2, s66
    v_sub_u32 v25, 2047, v24
    v_cmp_gt_u32 vcc, 2048, v25
    v_cvt_f32_i32 v85, v25
    v_cvt_pk_bf16_f32 v85, v85, v85
    v_lshlrev_b32 v85, 16, v85
    v_cvt_i32_f32 v85, v85
    v_cndmask_b32 v85, v26, v85, vcc
    v_lshl_add_u32 v85, v85, 2, s66
    v_sub_u32 v25, 2046, v24
    v_cmp_gt_u32 vcc, 2048, v25
    v_cvt_f32_i32 v86, v25
    v_cvt_pk_bf16_f32 v86, v86, v86
    v_lshlrev_b32 v86, 16, v86
    v_cvt_i32_f32 v86, v86
    v_cndmask_b32 v86, v26, v86, vcc
    v_lshl_add_u32 v86, v86, 2, s66
    v_sub_u32 v25, 2045, v24
    v_cmp_gt_u32 vcc, 2048, v25
    v_cvt_f32_i32 v87, v25
    v_cvt_pk_bf16_f32 v87, v87, v87
    v_lshlrev_b32 v87, 16, v87
    v_cvt_i32_f32 v87, v87
    v_cndmask_b32 v87, v26, v87, vcc
    v_lshl_add_u32 v87, v87, 2, s66
    v_sub_u32 v25, 2044, v24
    v_cmp_gt_u32 vcc, 2048, v25
    v_cvt_f32_i32 v88, v25
    v_cvt_pk_bf16_f32 v88, v88, v88
    v_lshlrev_b32 v88, 16, v88
    v_cvt_i32_f32 v88, v88
    v_cndmask_b32 v88, v26, v88, vcc
    v_lshl_add_u32 v88, v88, 2, s66
    v_sub_u32 v25, 2043, v24
    v_cmp_gt_u32 vcc, 2048, v25
    v_cvt_f32_i32 v89, v25
    v_cvt_pk_bf16_f32 v89, v89, v89
    v_lshlrev_b32 v89, 16, v89
    v_cvt_i32_f32 v89, v89
    v_cndmask_b32 v89, v26, v89, vcc
    v_lshl_add_u32 v89, v89, 2, s66
    v_sub_u32 v25, 2042, v24
    v_cmp_gt_u32 vcc, 2048, v25
    v_cvt_f32_i32 v90, v25
    v_cvt_pk_bf16_f32 v90, v90, v90
    v_lshlrev_b32 v90, 16, v90
    v_cvt_i32_f32 v90, v90
    v_cndmask_b32 v90, v26, v90, vcc
    v_lshl_add_u32 v90, v90, 2, s66
    v_sub_u32 v25, 2041, v24
    v_cmp_gt_u32 vcc, 2048, v25
    v_cvt_f32_i32 v91, v25
    v_cvt_pk_bf16_f32 v91, v91, v91
    v_lshlrev_b32 v91, 16, v91
    v_cvt_i32_f32 v91, v91
    v_cndmask_b32 v91, v26, v91, vcc
    v_lshl_add_u32 v91, v91, 2, s66
    v_sub_u32 v25, 2040, v24
    v_cmp_gt_u32 vcc, 2048, v25
    v_cvt_f32_i32 v92, v25
    v_cvt_pk_bf16_f32 v92, v92, v92
    v_lshlrev_b32 v92, 16, v92
    v_cvt_i32_f32 v92, v92
    v_cndmask_b32 v92, v26, v92, vcc
    v_lshl_add_u32 v92, v92, 2, s66
    v_sub_u32 v25, 2039, v24
    v_cmp_gt_u32 vcc, 2048, v25
    v_cvt_f32_i32 v93, v25
    v_cvt_pk_bf16_f32 v93, v93, v93
    v_lshlrev_b32 v93, 16, v93
    v_cvt_i32_f32 v93, v93
    v_cndmask_b32 v93, v26, v93, vcc
    v_lshl_add_u32 v93, v93, 2, s66
    v_sub_u32 v25, 2038, v24
    v_cmp_gt_u32 vcc, 2048, v25
    v_cvt_f32_i32 v94, v25
    v_cvt_pk_bf16_f32 v94, v94, v94
    v_lshlrev_b32 v94, 16, v94
    v_cvt_i32_f32 v94, v94
    v_cndmask_b32 v94, v26, v94, vcc
    v_lshl_add_u32 v94, v94, 2, s66
    v_sub_u32 v25, 2037, v24
    v_cmp_gt_u32 vcc, 2048, v25
    v_cvt_f32_i32 v95, v25
    v_cvt_pk_bf16_f32 v95, v95, v95
    v_lshlrev_b32 v95, 16, v95
    v_cvt_i32_f32 v95, v95
    v_cndmask_b32 v95, v26, v95, vcc
    v_lshl_add_u32 v95, v95, 2, s66
    v_sub_u32 v25, 1536, v24
    v_cmp_gt_u32 vcc, 2048, v25
    v_cvt_f32_i32 v96, v25
    v_cvt_pk_bf16_f32 v96, v96, v96
    v_lshlrev_b32 v96, 16, v96
    v_cvt_i32_f32 v96, v96
    v_cndmask_b32 v96, v26, v96, vcc
    v_lshl_add_u32 v96, v96, 2, s66
    v_sub_u32 v25, 1535, v24
    v_cmp_gt_u32 vcc, 2048, v25
    v_cvt_f32_i32 v97, v25
    v_cvt_pk_bf16_f32 v97, v97, v97
    v_lshlrev_b32 v97, 16, v97
    v_cvt_i32_f32 v97, v97
    v_cndmask_b32 v97, v26, v97, vcc
    v_lshl_add_u32 v97, v97, 2, s66
    v_sub_u32 v25, 1534, v24
    v_cmp_gt_u32 vcc, 2048, v25
    v_cvt_f32_i32 v98, v25
    v_cvt_pk_bf16_f32 v98, v98, v98
    v_lshlrev_b32 v98, 16, v98
    v_cvt_i32_f32 v98, v98
    v_cndmask_b32 v98, v26, v98, vcc
    v_lshl_add_u32 v98, v98, 2, s66
    v_sub_u32 v25, 1533, v24
    v_cmp_gt_u32 vcc, 2048, v25
    v_cvt_f32_i32 v99, v25
    v_cvt_pk_bf16_f32 v99, v99, v99
    v_lshlrev_b32 v99, 16, v99
    v_cvt_i32_f32 v99, v99
    v_cndmask_b32 v99, v26, v99, vcc
    v_lshl_add_u32 v99, v99, 2, s66
    v_sub_u32 v25, 1532, v24
    v_cmp_gt_u32 vcc, 2048, v25
    v_cvt_f32_i32 v100, v25
    v_cvt_pk_bf16_f32 v100, v100, v100
    v_lshlrev_b32 v100, 16, v100
    v_cvt_i32_f32 v100, v100
    v_cndmask_b32 v100, v26, v100, vcc
    v_lshl_add_u32 v100, v100, 2, s66
    v_sub_u32 v25, 1531, v24
    v_cmp_gt_u32 vcc, 2048, v25
    v_cvt_f32_i32 v101, v25
    v_cvt_pk_bf16_f32 v101, v101, v101
    v_lshlrev_b32 v101, 16, v101
    v_cvt_i32_f32 v101, v101
    v_cndmask_b32 v101, v26, v101, vcc
    v_lshl_add_u32 v101, v101, 2, s66
    v_sub_u32 v25, 1530, v24
    v_cmp_gt_u32 vcc, 2048, v25
    v_cvt_f32_i32 v102, v25
    v_cvt_pk_bf16_f32 v102, v102, v102
    v_lshlrev_b32 v102, 16, v102
    v_cvt_i32_f32 v102, v102
    v_cndmask_b32 v102, v26, v102, vcc
    v_lshl_add_u32 v102, v102, 2, s66
    v_sub_u32 v25, 1529, v24
    v_cmp_gt_u32 vcc, 2048, v25
    v_cvt_f32_i32 v103, v25
    v_cvt_pk_bf16_f32 v103, v103, v103
    v_lshlrev_b32 v103, 16, v103
    v_cvt_i32_f32 v103, v103
    v_cndmask_b32 v103, v26, v103, vcc
    v_lshl_add_u32 v103, v103, 2, s66
    v_sub_u32 v25, 1528, v24
    v_cmp_gt_u32 vcc, 2048, v25
    v_cvt_f32_i32 v104, v25
    v_cvt_pk_bf16_f32 v104, v104, v104
    v_lshlrev_b32 v104, 16, v104
    v_cvt_i32_f32 v104, v104
    v_cndmask_b32 v104, v26, v104, vcc
    v_lshl_add_u32 v104, v104, 2, s66
    v_sub_u32 v25, 1527, v24
    v_cmp_gt_u32 vcc, 2048, v25
    v_cvt_f32_i32 v105, v25
    v_cvt_pk_bf16_f32 v105, v105, v105
    v_lshlrev_b32 v105, 16, v105
    v_cvt_i32_f32 v105, v105
    v_cndmask_b32 v105, v26, v105, vcc
    v_lshl_add_u32 v105, v105, 2, s66
    v_sub_u32 v25, 1526, v24
    v_cmp_gt_u32 vcc, 2048, v25
    v_cvt_f32_i32 v106, v25
    v_cvt_pk_bf16_f32 v106, v106, v106
    v_lshlrev_b32 v106, 16, v106
    v_cvt_i32_f32 v106, v106
    v_cndmask_b32 v106, v26, v106, vcc
    v_lshl_add_u32 v106, v106, 2, s66
    v_sub_u32 v25, 1525, v24
    v_cmp_gt_u32 vcc, 2048, v25
    v_cvt_f32_i32 v107, v25
    v_cvt_pk_bf16_f32 v107, v107, v107
    v_lshlrev_b32 v107, 16, v107
    v_cvt_i32_f32 v107, v107
    v_cndmask_b32 v107, v26, v107, vcc
    v_lshl_add_u32 v107, v107, 2, s66
    v_and_b32 v3, 15, v2
    v_lshrrev_b32 v4, 4, v2
    v_mul_u32_u24 v5, 528, v3
    v_lshlrev_b32 v6, 4, v4
    v_add_u32 v5, v5, v6
    s_mul_i32 s65, s62, 30096
    v_add_u32 v117, s65, v5
    s_mul_i32 s67, s63, 8448
    v_add_u32 v116, s67, v117
    s_lshl_b32 s67, s62, 3
    s_add_u32 s67, s67, 114960
    v_mov_b32 v118, s67
    s_lshl_b32 s67, s3, 2
    s_add_u32 s67, s67, 114992
    v_mov_b32 v119, s67
    s_xor_b32 s67, s67, 4
    v_mov_b32 v120, s67
    v_lshlrev_b32 v7, 5, v3
    v_add_u32 v7, s66, v7
    v_mov_b32 v8, s66
    v_add_u32 v8, 8208, v8
    s_lshl_b32 s67, s63, 11
    s_add_u32 s67, s67, s65
    v_lshlrev_b32 v122, 4, v2
    v_add_u32 v122, s67, v122
    s_cmp_eq_u32 s63, 1
    s_cbranch_scc1 L_kA_t1
    v_lshrrev_b32 v9, 1, v4
    v_lshlrev_b32 v9, 9, v9
    v_and_b32 v10, 1, v4
    v_lshlrev_b32 v10, 4, v10
    v_add_u32 v9, v9, v10
    v_add_u32 v108, v9, v7
    v_add_u32 v109, 4, v108
    v_add_u32 v110, 8, v108
    v_add_u32 v111, 12, v108
    v_lshlrev_b32 v112, 11, v4
    v_add_u32 v112, 4096, v112
    v_add_u32 v112, v112, v7
    v_add_u32 v113, 512, v112
    v_add_u32 v114, 1024, v112
    v_add_u32 v115, 1536, v112
    v_cmp_gt_u32 vcc, 2, v4
    s_nop 1
    v_cndmask_b32 v113, v8, v113, vcc
    v_cndmask_b32 v114, v8, v114, vcc
    v_cndmask_b32 v115, v8, v115, vcc
    v_cmp_eq_u32 vcc, 32, v2
    s_nop 1
    v_cndmask_b32 v9, v8, v112, vcc
    v_cmp_gt_u32 vcc, 2, v4
    s_nop 1
    v_cndmask_b32 v112, v9, v112, vcc
    s_branch L_kA_tdone

L_kA_t1:
    v_lshlrev_b32 v108, 9, v4
    v_add_u32 v108, 1024, v108
    v_add_u32 v108, v108, v7
    v_subrev_u32 v9, 2, v4
    v_lshlrev_b32 v9, 10, v9
    v_add_u32 v9, 2048, v9
    v_add_u32 v9, v9, v7
    v_cmp_gt_u32 vcc, 2, v4
    v_add_u32 v109, 8, v108
    v_add_u32 v110, 16, v108
    v_add_u32 v111, 24, v108
    v_add_u32 v10, 16, v9
    v_cndmask_b32 v109, v10, v109, vcc
    v_add_u32 v10, 512, v9
    v_cndmask_b32 v110, v10, v110, vcc
    v_add_u32 v10, 528, v9
    v_cndmask_b32 v111, v10, v111, vcc
    v_cndmask_b32 v108, v9, v108, vcc

L_kA_tdone:
    s_waitcnt vmcnt(0) lgkmcnt(0)
    s_lshr_b32 s64, s19, 4
    s_add_u32 s64, s64, s62
    s_lshl_b32 s64, s64, 4
    s_lshr_b64 s[64:65], s[52:53], s64
    s_lshl_b32 s64, s64, 16
    v_mov_b32 v32, s64
    v_mul_f32 v32, 1069066811, v32
    v_exp_f32 v32, v32
    v_lshlrev_b32 v28, 16, v28
    v_lshlrev_b32 v29, 16, v29
    v_lshlrev_b32 v30, 16, v30
    v_lshlrev_b32 v31, 16, v31
    v_mul_f32 v28, 1069066811, v28
    v_exp_f32 v28, v28

    v_cvt_pk_bf16_f32 v32, v32, v32
    v_lshlrev_b32 v32, 16, v32
    v_cvt_pk_bf16_f32 v28, v28, v28
    v_lshlrev_b32 v28, 16, v28
    v_mul_f32 v28, v28, v32
    v_mul_f32 v28, 0xbfb8aa3b, v28
    v_mul_f32 v29, v29, v32
    v_mul_f32 v29, 1042479491, v29
    s_mul_i32 s65, s62, 30096
    s_lshl_b32 s66, s63, 8
    s_add_u32 s65, s65, s66
    v_lshlrev_b32 v34, 2, v2
    v_add_u32 v34, s65, v34

    v_mul_f32 v30, v30, v32
    v_mul_f32 v31, v31, v32
    v_max_f32 v33, abs(v30), abs(v31)

    s_nop 1
    v_max_f32 v33, v33, v33 row_shr:1 bound_ctrl:0
    s_nop 1
    v_max_f32 v33, v33, v33 row_shr:2 bound_ctrl:0
    s_nop 1
    v_max_f32 v33, v33, v33 row_shr:4 bound_ctrl:0
    s_nop 1
    v_max_f32 v33, v33, v33 row_shr:8 bound_ctrl:0
    s_nop 1
    v_max_f32 v33, v33, v33 row_bcast:15 row_mask:0xa
    s_nop 1
    v_max_f32 v33, v33, v33 row_bcast:31 row_mask:0xc
    s_nop 0
    v_frexp_exp_i32_f32 v33, v33
    s_nop 1
    v_readlane_b32 s64, v33, 63
    s_lshl_b32 s65, s62, 1
    s_add_u32 s65, s65, s63
    s_lshl_b32 s65, s65, 2
    s_sub_u32 s66, 1, s64
    v_mov_b32 v35, s65
    v_ldexp_f32 v30, v30, s66
    v_ldexp_f32 v31, v31, s66
    v_mov_b32 v36, s64
    v_add_u32 v35, 114960, v35
    s_mov_b64 exec, 1
    ds_write_b32 v35, v36
    s_mov_b64 exec, -1

    v_mov_b32 v76, v28
    v_mov_b32 v77, v29
    v_exp_f32 v76, v76
    v_fract_f32 v77, v77
    v_cos_f32 v40, v77
    v_sin_f32 v41, v77
    s_nop 0
    v_pk_mul_f32 v[40:41], v[40:41], v[76:77] op_sel:[0,0] op_sel_hi:[1,0]
    v_mul_f32 v124, 0x43000000, v28
    v_mul_f32 v125, 0x43000000, v29
    v_exp_f32 v124, v124
    v_fract_f32 v125, v125
    v_cos_f32 v54, v125
    v_sin_f32 v55, v125
    s_nop 0
    v_pk_mul_f32 v[54:55], v[54:55], v[124:125] op_sel:[0,0] op_sel_hi:[1,0]
    v_mul_f32 v76, 0x44800000, v28
    v_mul_f32 v77, 0x44800000, v29
    v_exp_f32 v76, v76
    v_fract_f32 v77, v77
    v_cos_f32 v68, v77
    v_sin_f32 v69, v77
    s_nop 0
    v_pk_mul_f32 v[68:69], v[68:69], v[76:77] op_sel:[0,0] op_sel_hi:[1,0]
    v_mul_f32 v124, 0x41000000, v28
    v_mul_f32 v125, 0x41000000, v29
    v_exp_f32 v124, v124
    v_fract_f32 v125, v125
    v_cos_f32 v70, v125
    v_sin_f32 v71, v125
    s_nop 0
    v_pk_mul_f32 v[70:71], v[70:71], v[124:125] op_sel:[0,0] op_sel_hi:[1,0]
    v_mov_b32 v36, 0x00003c00
    ds_write_b32 v34, v36 offset:0
    v_cvt_pk_f16_f32 v37, v40, v41
    ds_write_b32 v34, v37 offset:528
    v_cvt_pk_f16_f32 v36, v54, v55
    ds_write_b32 v34, v36 offset:4224
    v_cvt_pk_f16_f32 v37, v68, v69
    ds_write_b32 v34, v37 offset:16896
    v_pk_mul_f32 v[42:43], v[40:41], v[40:41] op_sel:[0,0] op_sel_hi:[0,1]
    v_pk_fma_f32 v[42:43], v[40:41], v[40:41], v[42:43] op_sel:[1,1,0] op_sel_hi:[1,0,1] neg_lo:[1,0,0]
    v_cvt_pk_f16_f32 v36, v42, v43
    ds_write_b32 v34, v36 offset:1056
    v_pk_mul_f32 v[56:57], v[54:55], v[54:55] op_sel:[0,0] op_sel_hi:[0,1]
    v_pk_fma_f32 v[56:57], v[54:55], v[54:55], v[56:57] op_sel:[1,1,0] op_sel_hi:[1,0,1] neg_lo:[1,0,0]
    v_cvt_pk_f16_f32 v37, v56, v57
    ds_write_b32 v34, v37 offset:8448
    v_pk_mul_f32 v[44:45], v[42:43], v[40:41] op_sel:[0,0] op_sel_hi:[0,1]
    v_pk_fma_f32 v[44:45], v[42:43], v[40:41], v[44:45] op_sel:[1,1,0] op_sel_hi:[1,0,1] neg_lo:[1,0,0]
    v_cvt_pk_f16_f32 v36, v44, v45
    ds_write_b32 v34, v36 offset:1584
    v_pk_mul_f32 v[58:59], v[56:57], v[54:55] op_sel:[0,0] op_sel_hi:[0,1]
    v_pk_fma_f32 v[58:59], v[56:57], v[54:55], v[58:59] op_sel:[1,1,0] op_sel_hi:[1,0,1] neg_lo:[1,0,0]
    v_cvt_pk_f16_f32 v37, v58, v59
    ds_write_b32 v34, v37 offset:10560
    v_pk_mul_f32 v[46:47], v[42:43], v[42:43] op_sel:[0,0] op_sel_hi:[0,1]
    v_pk_fma_f32 v[46:47], v[42:43], v[42:43], v[46:47] op_sel:[1,1,0] op_sel_hi:[1,0,1] neg_lo:[1,0,0]
    v_cvt_pk_f16_f32 v36, v46, v47
    ds_write_b32 v34, v36 offset:2112
    v_pk_mul_f32 v[60:61], v[56:57], v[56:57] op_sel:[0,0] op_sel_hi:[0,1]
    v_pk_fma_f32 v[60:61], v[56:57], v[56:57], v[60:61] op_sel:[1,1,0] op_sel_hi:[1,0,1] neg_lo:[1,0,0]
    v_cvt_pk_f16_f32 v37, v60, v61
    ds_write_b32 v34, v37 offset:12672
    v_pk_mul_f32 v[48:49], v[46:47], v[40:41] op_sel:[0,0] op_sel_hi:[0,1]
    v_pk_fma_f32 v[48:49], v[46:47], v[40:41], v[48:49] op_sel:[1,1,0] op_sel_hi:[1,0,1] neg_lo:[1,0,0]
    v_cvt_pk_f16_f32 v36, v48, v49
    ds_write_b32 v34, v36 offset:2640
    v_pk_mul_f32 v[62:63], v[60:61], v[54:55] op_sel:[0,0] op_sel_hi:[0,1]
    v_pk_fma_f32 v[62:63], v[60:61], v[54:55], v[62:63] op_sel:[1,1,0] op_sel_hi:[1,0,1] neg_lo:[1,0,0]
    v_cvt_pk_f16_f32 v37, v62, v63
    ds_write_b32 v34, v37 offset:13728
    v_pk_mul_f32 v[50:51], v[44:45], v[44:45] op_sel:[0,0] op_sel_hi:[0,1]
    v_pk_fma_f32 v[50:51], v[44:45], v[44:45], v[50:51] op_sel:[1,1,0] op_sel_hi:[1,0,1] neg_lo:[1,0,0]
    v_cvt_pk_f16_f32 v36, v50, v51
    ds_write_b32 v34, v36 offset:3168
    v_pk_mul_f32 v[64:65], v[58:59], v[58:59] op_sel:[0,0] op_sel_hi:[0,1]
    v_pk_fma_f32 v[64:65], v[58:59], v[58:59], v[64:65] op_sel:[1,1,0] op_sel_hi:[1,0,1] neg_lo:[1,0,0]
    v_cvt_pk_f16_f32 v37, v64, v65
    ds_write_b32 v34, v37 offset:14784
    v_pk_mul_f32 v[52:53], v[46:47], v[44:45] op_sel:[0,0] op_sel_hi:[0,1]
    v_pk_fma_f32 v[52:53], v[46:47], v[44:45], v[52:53] op_sel:[1,1,0] op_sel_hi:[1,0,1] neg_lo:[1,0,0]
    v_cvt_pk_f16_f32 v36, v52, v53
    ds_write_b32 v34, v36 offset:3696
    v_pk_mul_f32 v[66:67], v[60:61], v[58:59] op_sel:[0,0] op_sel_hi:[0,1]
    v_pk_fma_f32 v[66:67], v[60:61], v[58:59], v[66:67] op_sel:[1,1,0] op_sel_hi:[1,0,1] neg_lo:[1,0,0]
    v_cvt_pk_f16_f32 v37, v66, v67
    ds_write_b32 v34, v37 offset:15840
    v_cvt_pk_f16_f32 v36, v30, -v31
    ds_write_b32 v34, v36 offset:21648
    v_pk_mul_f32 v[72:73], v[30:31], v[70:71] op_sel:[0,0] op_sel_hi:[0,1]
    v_pk_fma_f32 v[72:73], v[30:31], v[70:71], v[72:73] op_sel:[1,1,0] op_sel_hi:[1,0,1] neg_lo:[1,0,0]
    v_pk_mul_f32 v[80:81], v[54:55], v[40:41] op_sel:[0,0] op_sel_hi:[0,1]
    v_pk_fma_f32 v[80:81], v[54:55], v[40:41], v[80:81] op_sel:[1,1,0] op_sel_hi:[1,0,1] neg_lo:[1,0,0]
    v_cvt_pk_f16_f32 v37, v80, v81
    ds_write_b32 v34, v37 offset:4752
    v_pk_mul_f32 v[78:79], v[54:55], v[42:43] op_sel:[0,0] op_sel_hi:[0,1]
    v_pk_fma_f32 v[78:79], v[54:55], v[42:43], v[78:79] op_sel:[1,1,0] op_sel_hi:[1,0,1] neg_lo:[1,0,0]
    v_cvt_pk_f16_f32 v36, v78, v79
    ds_write_b32 v34, v36 offset:5280
    v_cvt_pk_f16_f32 v37, v72, -v73
    ds_write_b32 v34, v37 offset:22176
    v_pk_mul_f32 v[74:75], v[72:73], v[70:71] op_sel:[0,0] op_sel_hi:[0,1]
    v_pk_fma_f32 v[74:75], v[72:73], v[70:71], v[74:75] op_sel:[1,1,0] op_sel_hi:[1,0,1] neg_lo:[1,0,0]
    v_pk_mul_f32 v[80:81], v[54:55], v[44:45] op_sel:[0,0] op_sel_hi:[0,1]
    v_pk_fma_f32 v[80:81], v[54:55], v[44:45], v[80:81] op_sel:[1,1,0] op_sel_hi:[1,0,1] neg_lo:[1,0,0]
    v_cvt_pk_f16_f32 v36, v80, v81
    ds_write_b32 v34, v36 offset:5808
    v_pk_mul_f32 v[78:79], v[54:55], v[46:47] op_sel:[0,0] op_sel_hi:[0,1]
    v_pk_fma_f32 v[78:79], v[54:55], v[46:47], v[78:79] op_sel:[1,1,0] op_sel_hi:[1,0,1] neg_lo:[1,0,0]
    v_cvt_pk_f16_f32 v37, v78, v79
    ds_write_b32 v34, v37 offset:6336
    v_cvt_pk_f16_f32 v36, v74, -v75
    ds_write_b32 v34, v36 offset:22704
    v_pk_mul_f32 v[72:73], v[74:75], v[70:71] op_sel:[0,0] op_sel_hi:[0,1]
    v_pk_fma_f32 v[72:73], v[74:75], v[70:71], v[72:73] op_sel:[1,1,0] op_sel_hi:[1,0,1] neg_lo:[1,0,0]
    v_pk_mul_f32 v[80:81], v[54:55], v[48:49] op_sel:[0,0] op_sel_hi:[0,1]
    v_pk_fma_f32 v[80:81], v[54:55], v[48:49], v[80:81] op_sel:[1,1,0] op_sel_hi:[1,0,1] neg_lo:[1,0,0]
    v_cvt_pk_f16_f32 v37, v80, v81
    ds_write_b32 v34, v37 offset:6864
    v_pk_mul_f32 v[78:79], v[54:55], v[50:51] op_sel:[0,0] op_sel_hi:[0,1]
    v_pk_fma_f32 v[78:79], v[54:55], v[50:51], v[78:79] op_sel:[1,1,0] op_sel_hi:[1,0,1] neg_lo:[1,0,0]
    v_cvt_pk_f16_f32 v36, v78, v79
    ds_write_b32 v34, v36 offset:7392
    v_cvt_pk_f16_f32 v37, v72, -v73
    ds_write_b32 v34, v37 offset:23232
    v_pk_mul_f32 v[74:75], v[72:73], v[70:71] op_sel:[0,0] op_sel_hi:[0,1]
    v_pk_fma_f32 v[74:75], v[72:73], v[70:71], v[74:75] op_sel:[1,1,0] op_sel_hi:[1,0,1] neg_lo:[1,0,0]
    v_pk_mul_f32 v[80:81], v[54:55], v[52:53] op_sel:[0,0] op_sel_hi:[0,1]
    v_pk_fma_f32 v[80:81], v[54:55], v[52:53], v[80:81] op_sel:[1,1,0] op_sel_hi:[1,0,1] neg_lo:[1,0,0]
    v_cvt_pk_f16_f32 v36, v80, v81
    ds_write_b32 v34, v36 offset:7920
    v_pk_mul_f32 v[78:79], v[56:57], v[42:43] op_sel:[0,0] op_sel_hi:[0,1]
    v_pk_fma_f32 v[78:79], v[56:57], v[42:43], v[78:79] op_sel:[1,1,0] op_sel_hi:[1,0,1] neg_lo:[1,0,0]
    v_cvt_pk_f16_f32 v37, v78, v79
    ds_write_b32 v34, v37 offset:8976
    v_cvt_pk_f16_f32 v36, v74, -v75
    ds_write_b32 v34, v36 offset:23760
    v_pk_mul_f32 v[72:73], v[74:75], v[70:71] op_sel:[0,0] op_sel_hi:[0,1]
    v_pk_fma_f32 v[72:73], v[74:75], v[70:71], v[72:73] op_sel:[1,1,0] op_sel_hi:[1,0,1] neg_lo:[1,0,0]
    v_pk_mul_f32 v[80:81], v[56:57], v[46:47] op_sel:[0,0] op_sel_hi:[0,1]
    v_pk_fma_f32 v[80:81], v[56:57], v[46:47], v[80:81] op_sel:[1,1,0] op_sel_hi:[1,0,1] neg_lo:[1,0,0]
    v_cvt_pk_f16_f32 v37, v80, v81
    ds_write_b32 v34, v37 offset:9504
    v_pk_mul_f32 v[78:79], v[56:57], v[50:51] op_sel:[0,0] op_sel_hi:[0,1]
    v_pk_fma_f32 v[78:79], v[56:57], v[50:51], v[78:79] op_sel:[1,1,0] op_sel_hi:[1,0,1] neg_lo:[1,0,0]
    v_cvt_pk_f16_f32 v36, v78, v79
    ds_write_b32 v34, v36 offset:10032
    v_cvt_pk_f16_f32 v37, v72, -v73
    ds_write_b32 v34, v37 offset:24288
    v_pk_mul_f32 v[74:75], v[72:73], v[70:71] op_sel:[0,0] op_sel_hi:[0,1]
    v_pk_fma_f32 v[74:75], v[72:73], v[70:71], v[74:75] op_sel:[1,1,0] op_sel_hi:[1,0,1] neg_lo:[1,0,0]
    v_pk_mul_f32 v[80:81], v[58:59], v[42:43] op_sel:[0,0] op_sel_hi:[0,1]
    v_pk_fma_f32 v[80:81], v[58:59], v[42:43], v[80:81] op_sel:[1,1,0] op_sel_hi:[1,0,1] neg_lo:[1,0,0]
    v_cvt_pk_f16_f32 v36, v80, v81
    ds_write_b32 v34, v36 offset:11088
    v_pk_mul_f32 v[78:79], v[58:59], v[46:47] op_sel:[0,0] op_sel_hi:[0,1]
    v_pk_fma_f32 v[78:79], v[58:59], v[46:47], v[78:79] op_sel:[1,1,0] op_sel_hi:[1,0,1] neg_lo:[1,0,0]
    v_cvt_pk_f16_f32 v37, v78, v79
    ds_write_b32 v34, v37 offset:11616
    v_cvt_pk_f16_f32 v36, v74, -v75
    ds_write_b32 v34, v36 offset:24816
    v_pk_mul_f32 v[72:73], v[74:75], v[70:71] op_sel:[0,0] op_sel_hi:[0,1]
    v_pk_fma_f32 v[72:73], v[74:75], v[70:71], v[72:73] op_sel:[1,1,0] op_sel_hi:[1,0,1] neg_lo:[1,0,0]
    v_pk_mul_f32 v[80:81], v[58:59], v[50:51] op_sel:[0,0] op_sel_hi:[0,1]
    v_pk_fma_f32 v[80:81], v[58:59], v[50:51], v[80:81] op_sel:[1,1,0] op_sel_hi:[1,0,1] neg_lo:[1,0,0]
    v_cvt_pk_f16_f32 v37, v80, v81
    ds_write_b32 v34, v37 offset:12144
    v_pk_mul_f32 v[78:79], v[60:61], v[46:47] op_sel:[0,0] op_sel_hi:[0,1]
    v_pk_fma_f32 v[78:79], v[60:61], v[46:47], v[78:79] op_sel:[1,1,0] op_sel_hi:[1,0,1] neg_lo:[1,0,0]
    v_cvt_pk_f16_f32 v36, v78, v79
    ds_write_b32 v34, v36 offset:13200
    v_cvt_pk_f16_f32 v37, v72, -v73
    ds_write_b32 v34, v37 offset:25344
    v_pk_mul_f32 v[74:75], v[72:73], v[70:71] op_sel:[0,0] op_sel_hi:[0,1]
    v_pk_fma_f32 v[74:75], v[72:73], v[70:71], v[74:75] op_sel:[1,1,0] op_sel_hi:[1,0,1] neg_lo:[1,0,0]
    v_pk_mul_f32 v[80:81], v[62:63], v[46:47] op_sel:[0,0] op_sel_hi:[0,1]
    v_pk_fma_f32 v[80:81], v[62:63], v[46:47], v[80:81] op_sel:[1,1,0] op_sel_hi:[1,0,1] neg_lo:[1,0,0]
    v_cvt_pk_f16_f32 v36, v80, v81
    ds_write_b32 v34, v36 offset:14256
    v_pk_mul_f32 v[78:79], v[64:65], v[46:47] op_sel:[0,0] op_sel_hi:[0,1]
    v_pk_fma_f32 v[78:79], v[64:65], v[46:47], v[78:79] op_sel:[1,1,0] op_sel_hi:[1,0,1] neg_lo:[1,0,0]
    v_cvt_pk_f16_f32 v37, v78, v79
    ds_write_b32 v34, v37 offset:15312
    v_cvt_pk_f16_f32 v36, v74, -v75
    ds_write_b32 v34, v36 offset:25872
    v_pk_mul_f32 v[72:73], v[74:75], v[70:71] op_sel:[0,0] op_sel_hi:[0,1]
    v_pk_fma_f32 v[72:73], v[74:75], v[70:71], v[72:73] op_sel:[1,1,0] op_sel_hi:[1,0,1] neg_lo:[1,0,0]
    v_pk_mul_f32 v[80:81], v[66:67], v[46:47] op_sel:[0,0] op_sel_hi:[0,1]
    v_pk_fma_f32 v[80:81], v[66:67], v[46:47], v[80:81] op_sel:[1,1,0] op_sel_hi:[1,0,1] neg_lo:[1,0,0]
    v_cvt_pk_f16_f32 v37, v80, v81
    ds_write_b32 v34, v37 offset:16368
    v_pk_mul_f32 v[78:79], v[68:69], v[54:55] op_sel:[0,0] op_sel_hi:[0,1]
    v_pk_fma_f32 v[78:79], v[68:69], v[54:55], v[78:79] op_sel:[1,1,0] op_sel_hi:[1,0,1] neg_lo:[1,0,0]
    v_cvt_pk_f16_f32 v36, v78, v79
    ds_write_b32 v34, v36 offset:17424
    v_cvt_pk_f16_f32 v37, v72, -v73
    ds_write_b32 v34, v37 offset:26400
    v_pk_mul_f32 v[74:75], v[72:73], v[70:71] op_sel:[0,0] op_sel_hi:[0,1]
    v_pk_fma_f32 v[74:75], v[72:73], v[70:71], v[74:75] op_sel:[1,1,0] op_sel_hi:[1,0,1] neg_lo:[1,0,0]
    v_pk_mul_f32 v[80:81], v[68:69], v[56:57] op_sel:[0,0] op_sel_hi:[0,1]
    v_pk_fma_f32 v[80:81], v[68:69], v[56:57], v[80:81] op_sel:[1,1,0] op_sel_hi:[1,0,1] neg_lo:[1,0,0]
    v_cvt_pk_f16_f32 v36, v80, v81
    ds_write_b32 v34, v36 offset:17952
    v_pk_mul_f32 v[78:79], v[68:69], v[58:59] op_sel:[0,0] op_sel_hi:[0,1]
    v_pk_fma_f32 v[78:79], v[68:69], v[58:59], v[78:79] op_sel:[1,1,0] op_sel_hi:[1,0,1] neg_lo:[1,0,0]
    v_cvt_pk_f16_f32 v37, v78, v79
    ds_write_b32 v34, v37 offset:18480
    v_cvt_pk_f16_f32 v36, v74, -v75
    ds_write_b32 v34, v36 offset:26928
    v_pk_mul_f32 v[72:73], v[74:75], v[70:71] op_sel:[0,0] op_sel_hi:[0,1]
    v_pk_fma_f32 v[72:73], v[74:75], v[70:71], v[72:73] op_sel:[1,1,0] op_sel_hi:[1,0,1] neg_lo:[1,0,0]
    v_pk_mul_f32 v[80:81], v[68:69], v[60:61] op_sel:[0,0] op_sel_hi:[0,1]
    v_pk_fma_f32 v[80:81], v[68:69], v[60:61], v[80:81] op_sel:[1,1,0] op_sel_hi:[1,0,1] neg_lo:[1,0,0]
    v_cvt_pk_f16_f32 v37, v80, v81
    ds_write_b32 v34, v37 offset:19008
    v_cvt_pk_f16_f32 v36, v72, -v73
    ds_write_b32 v34, v36 offset:27456
    v_pk_mul_f32 v[74:75], v[72:73], v[70:71] op_sel:[0,0] op_sel_hi:[0,1]
    v_pk_fma_f32 v[74:75], v[72:73], v[70:71], v[74:75] op_sel:[1,1,0] op_sel_hi:[1,0,1] neg_lo:[1,0,0]
    v_pk_mul_f32 v[78:79], v[68:69], v[62:63] op_sel:[0,0] op_sel_hi:[0,1]
    v_pk_fma_f32 v[78:79], v[68:69], v[62:63], v[78:79] op_sel:[1,1,0] op_sel_hi:[1,0,1] neg_lo:[1,0,0]
    v_cvt_pk_f16_f32 v37, v78, v79
    ds_write_b32 v34, v37 offset:19536
    v_cvt_pk_f16_f32 v36, v74, -v75
    ds_write_b32 v34, v36 offset:27984
    v_pk_mul_f32 v[72:73], v[74:75], v[70:71] op_sel:[0,0] op_sel_hi:[0,1]
    v_pk_fma_f32 v[72:73], v[74:75], v[70:71], v[72:73] op_sel:[1,1,0] op_sel_hi:[1,0,1] neg_lo:[1,0,0]
    v_pk_mul_f32 v[80:81], v[68:69], v[64:65] op_sel:[0,0] op_sel_hi:[0,1]
    v_pk_fma_f32 v[80:81], v[68:69], v[64:65], v[80:81] op_sel:[1,1,0] op_sel_hi:[1,0,1] neg_lo:[1,0,0]
    v_cvt_pk_f16_f32 v37, v80, v81
    ds_write_b32 v34, v37 offset:20064
    v_cvt_pk_f16_f32 v36, v72, -v73
    ds_write_b32 v34, v36 offset:28512
    v_pk_mul_f32 v[74:75], v[72:73], v[70:71] op_sel:[0,0] op_sel_hi:[0,1]
    v_pk_fma_f32 v[74:75], v[72:73], v[70:71], v[74:75] op_sel:[1,1,0] op_sel_hi:[1,0,1] neg_lo:[1,0,0]
    v_pk_mul_f32 v[78:79], v[68:69], v[66:67] op_sel:[0,0] op_sel_hi:[0,1]
    v_pk_fma_f32 v[78:79], v[68:69], v[66:67], v[78:79] op_sel:[1,1,0] op_sel_hi:[1,0,1] neg_lo:[1,0,0]
    v_cvt_pk_f16_f32 v37, v78, v79
    ds_write_b32 v34, v37 offset:20592
    v_cvt_pk_f16_f32 v36, v74, -v75
    ds_write_b32 v34, v36 offset:29040
    v_pk_mul_f32 v[72:73], v[74:75], v[70:71] op_sel:[0,0] op_sel_hi:[0,1]
    v_pk_fma_f32 v[72:73], v[74:75], v[70:71], v[72:73] op_sel:[1,1,0] op_sel_hi:[1,0,1] neg_lo:[1,0,0]
    v_pk_mul_f32 v[80:81], v[68:69], v[68:69] op_sel:[0,0] op_sel_hi:[0,1]
    v_pk_fma_f32 v[80:81], v[68:69], v[68:69], v[80:81] op_sel:[1,1,0] op_sel_hi:[1,0,1] neg_lo:[1,0,0]
    v_cvt_pk_f16_f32 v37, v80, v81
    ds_write_b32 v34, v37 offset:21120
    v_cvt_pk_f16_f32 v36, v72, -v73
    ds_write_b32 v34, v36 offset:29568
    v_mov_b32 v36, 1
    s_waitcnt lgkmcnt(0)
    ds_write_b32 v119, v36

    s_mov_b32 s77, 0
L_kA_ps1:
    ds_read_b32 v37, v120
    s_add_u32 s77, s77, 1
    s_waitcnt lgkmcnt(0)
    v_readfirstlane_b32 s76, v37
    s_cmp_gt_u32 s77, 100000
    s_cbranch_scc1 L_kA_ps1_ok
    s_cmp_ge_u32 s76, 1
    s_cbranch_scc0 L_kA_ps1

L_kA_ps1_ok:
    v_mov_b32 v40, 0
    v_mov_b32 v41, 0
    v_mov_b32 v42, 0
    v_mov_b32 v43, 0
    v_mov_b32 v44, 0
    v_mov_b32 v45, 0
    v_mov_b32 v46, 0
    v_mov_b32 v47, 0
    v_mov_b32 v48, 0
    v_mov_b32 v49, 0
    v_mov_b32 v50, 0
    v_mov_b32 v51, 0
    v_mov_b32 v52, 0
    v_mov_b32 v53, 0
    v_mov_b32 v54, 0
    v_mov_b32 v55, 0
    s_cmp_eq_u32 s63, 1
    s_cbranch_scc1 L_kA_kg1
    ds_read_b128 a[0:3], v116 offset:0
    ds_read_b128 a[32:35], v117 offset:21648
    ds_read_b128 a[16:19], v116 offset:256
    ds_read_b128 a[48:51], v117 offset:21904
    ds_read_b128 a[4:7], v116 offset:64
    ds_read_b128 a[36:39], v117 offset:21712
    ds_read_b128 a[20:23], v116 offset:320
    ds_read_b128 a[52:55], v117 offset:21968
    ds_read_b128 a[8:11], v116 offset:128
    ds_read_b128 a[40:43], v117 offset:21776
    ds_read_b128 a[24:27], v116 offset:384
    ds_read_b128 a[56:59], v117 offset:22032
    ds_read_b128 a[12:15], v116 offset:192
    ds_read_b128 a[44:47], v117 offset:21840
    ds_read_b128 a[28:31], v116 offset:448
    ds_read_b128 a[60:63], v117 offset:22096
    ds_read_b64 v[34:35], v118
    ds_read_b128 a[64:67], v117 offset:16896
    ds_read_b128 a[80:83], v117 offset:17152
    ds_read_b128 a[68:71], v117 offset:16960
    ds_read_b128 a[84:87], v117 offset:17216
    ds_read_b128 a[72:75], v117 offset:17024
    ds_read_b128 a[88:91], v117 offset:17280
    ds_read_b128 a[76:79], v117 offset:17088
    ds_read_b128 a[92:95], v117 offset:17344
    s_waitcnt lgkmcnt(15)
    v_mfma_f32_16x16x32_f16 v[40:43], a[0:3], a[32:35], v[40:43]
    s_waitcnt lgkmcnt(15)
    v_mfma_f32_16x16x32_f16 v[44:47], a[16:19], a[48:51], v[44:47]
    s_waitcnt lgkmcnt(15)
    v_mfma_f32_16x16x32_f16 v[40:43], a[4:7], a[36:39], v[40:43]
    s_waitcnt lgkmcnt(15)
    v_mfma_f32_16x16x32_f16 v[44:47], a[20:23], a[52:55], v[44:47]
    s_waitcnt lgkmcnt(15)
    v_mfma_f32_16x16x32_f16 v[40:43], a[8:11], a[40:43], v[40:43]
    s_waitcnt lgkmcnt(13)
    v_mfma_f32_16x16x32_f16 v[44:47], a[24:27], a[56:59], v[44:47]
    s_waitcnt lgkmcnt(11)
    v_mfma_f32_16x16x32_f16 v[40:43], a[12:15], a[44:47], v[40:43]
    s_waitcnt lgkmcnt(9)
    v_mfma_f32_16x16x32_f16 v[44:47], a[28:31], a[60:63], v[44:47]
    s_waitcnt lgkmcnt(7)
    v_mfma_f32_16x16x32_f16 v[48:51], a[64:67], a[32:35], v[48:51]
    s_waitcnt lgkmcnt(6)
    v_mfma_f32_16x16x32_f16 v[52:55], a[80:83], a[48:51], v[52:55]
    s_waitcnt lgkmcnt(5)
    v_mfma_f32_16x16x32_f16 v[48:51], a[68:71], a[36:39], v[48:51]
    s_waitcnt lgkmcnt(4)
    v_mfma_f32_16x16x32_f16 v[52:55], a[84:87], a[52:55], v[52:55]
    s_waitcnt lgkmcnt(3)
    v_mfma_f32_16x16x32_f16 v[48:51], a[72:75], a[40:43], v[48:51]
    s_waitcnt lgkmcnt(2)
    v_mfma_f32_16x16x32_f16 v[52:55], a[88:91], a[56:59], v[52:55]
    s_waitcnt lgkmcnt(1)
    v_mfma_f32_16x16x32_f16 v[48:51], a[76:79], a[44:47], v[48:51]
    s_waitcnt lgkmcnt(0)
    v_mfma_f32_16x16x32_f16 v[52:55], a[92:95], a[60:63], v[52:55]
    v_max_i32 v32, v34, v35
    v_sub_u32 v34, v34, v32
    v_sub_u32 v35, v35, v32
    s_nop 4

    v_ldexp_f32 v40, v40, v34
    v_ldexp_f32 v44, v44, v35
    v_add_f32 v40, v40, v44
    ds_write_b32 v108, v40
    v_ldexp_f32 v41, v41, v34
    v_ldexp_f32 v45, v45, v35
    v_add_f32 v41, v41, v45
    ds_write_b32 v109, v41
    v_ldexp_f32 v42, v42, v34
    v_ldexp_f32 v46, v46, v35
    v_add_f32 v42, v42, v46
    ds_write_b32 v110, v42
    v_ldexp_f32 v43, v43, v34
    v_ldexp_f32 v47, v47, v35
    v_add_f32 v43, v43, v47
    ds_write_b32 v111, v43
    s_nop 3
    v_ldexp_f32 v48, v48, v34
    v_ldexp_f32 v52, v52, v35
    v_add_f32 v48, v48, v52
    ds_write_b32 v112, v48
    v_ldexp_f32 v49, v49, v34
    v_ldexp_f32 v53, v53, v35
    v_add_f32 v49, v49, v53
    ds_write_b32 v113, v49
    v_ldexp_f32 v50, v50, v34
    v_ldexp_f32 v54, v54, v35
    v_add_f32 v50, v50, v54
    ds_write_b32 v114, v50
    v_ldexp_f32 v51, v51, v34
    v_ldexp_f32 v55, v55, v35
    v_add_f32 v51, v51, v55
    ds_write_b32 v115, v51
    s_branch L_kA_kgd
L_kA_kg1:
    ds_read_b128 a[0:3], v116 offset:0
    ds_read_b128 a[32:35], v117 offset:21648
    ds_read_b128 a[16:19], v116 offset:256
    ds_read_b128 a[48:51], v117 offset:21904
    ds_read_b128 a[4:7], v116 offset:64
    ds_read_b128 a[36:39], v117 offset:21712
    ds_read_b128 a[20:23], v116 offset:320
    ds_read_b128 a[52:55], v117 offset:21968
    ds_read_b128 a[8:11], v116 offset:128
    ds_read_b128 a[40:43], v117 offset:21776
    ds_read_b128 a[24:27], v116 offset:384
    ds_read_b128 a[56:59], v117 offset:22032
    ds_read_b128 a[12:15], v116 offset:192
    ds_read_b128 a[44:47], v117 offset:21840
    ds_read_b128 a[28:31], v116 offset:448
    ds_read_b128 a[60:63], v117 offset:22096
    ds_read_b64 v[34:35], v118
    s_waitcnt lgkmcnt(15)
    v_mfma_f32_16x16x32_f16 v[40:43], a[0:3], a[32:35], v[40:43]
    s_waitcnt lgkmcnt(13)
    v_mfma_f32_16x16x32_f16 v[44:47], a[16:19], a[48:51], v[44:47]
    s_waitcnt lgkmcnt(11)
    v_mfma_f32_16x16x32_f16 v[40:43], a[4:7], a[36:39], v[40:43]
    s_waitcnt lgkmcnt(9)
    v_mfma_f32_16x16x32_f16 v[44:47], a[20:23], a[52:55], v[44:47]
    s_waitcnt lgkmcnt(7)
    v_mfma_f32_16x16x32_f16 v[40:43], a[8:11], a[40:43], v[40:43]
    s_waitcnt lgkmcnt(5)
    v_mfma_f32_16x16x32_f16 v[44:47], a[24:27], a[56:59], v[44:47]
    s_waitcnt lgkmcnt(3)
    v_mfma_f32_16x16x32_f16 v[40:43], a[12:15], a[44:47], v[40:43]
    s_waitcnt lgkmcnt(1)
    v_mfma_f32_16x16x32_f16 v[44:47], a[28:31], a[60:63], v[44:47]
    s_waitcnt lgkmcnt(0)
    v_max_i32 v32, v34, v35
    v_sub_u32 v34, v34, v32
    v_sub_u32 v35, v35, v32
    s_nop 7

    v_ldexp_f32 v40, v40, v34
    v_ldexp_f32 v44, v44, v35
    v_add_f32 v40, v40, v44
    ds_write_b32 v108, v40
    v_ldexp_f32 v41, v41, v34
    v_ldexp_f32 v45, v45, v35
    v_add_f32 v41, v41, v45
    ds_write_b32 v109, v41
    v_ldexp_f32 v42, v42, v34
    v_ldexp_f32 v46, v46, v35
    v_add_f32 v42, v42, v46
    ds_write_b32 v110, v42
    v_ldexp_f32 v43, v43, v34
    v_ldexp_f32 v47, v47, v35
    v_add_f32 v43, v43, v47
    ds_write_b32 v111, v43
L_kA_kgd:
    v_mov_b32 v36, 2
    s_waitcnt lgkmcnt(0)
    ds_write_b32 v119, v36

    s_mov_b32 s77, 0
L_kA_ps2:
    ds_read_b32 v37, v120
    s_add_u32 s77, s77, 1
    s_waitcnt lgkmcnt(0)
    v_readfirstlane_b32 s76, v37
    s_cmp_gt_u32 s77, 100000
    s_cbranch_scc1 L_kA_ps2_ok
    s_cmp_ge_u32 s76, 2
    s_cbranch_scc0 L_kA_ps2

L_kA_ps2_ok:
    ds_read_b32 v124, v84
    ds_read_b32 v125, v85
    ds_read_b32 v126, v86
    ds_read_b32 v127, v87
    ds_read_b32 v128, v88
    ds_read_b32 v129, v89
    ds_read_b32 v130, v90
    ds_read_b32 v131, v91
    ds_read_b32 v132, v92
    ds_read_b32 v133, v93
    ds_read_b32 v134, v94
    ds_read_b32 v135, v95
    ds_read_b32 v136, v96
    ds_read_b32 v137, v97
    ds_read_b32 v138, v98
    ds_read_b32 v139, v99
    ds_read_b32 v140, v100
    ds_read_b32 v141, v101
    ds_read_b32 v142, v102
    ds_read_b32 v143, v103
    ds_read_b32 v144, v104
    ds_read_b32 v145, v105
    ds_read_b32 v146, v106
    ds_read_b32 v147, v107
    s_cmp_eq_u32 s63, 1
    s_cbranch_scc0 L_kA_notail
    s_mul_i32 s66, s62, 8224
    s_add_u32 s66, s66, 90288
    v_mov_b32 v44, s66
    ds_read_b32 v45, v44
    v_lshrrev_b32 v41, 2, v2
    v_and_b32 v42, 3, v2
    v_mul_u32_u24 v43, 4160, v41
    v_lshlrev_b32 v44, 4, v42
    v_add_u32 v43, v43, v44
    s_mul_i32 s66, s62, 30096
    s_add_u32 s66, s66, 4096
    v_add_u32 v43, s66, v43
    v_mov_b32 v49, 0
    v_mov_b32 v50, 0
    v_mov_b32 v51, 0
    s_waitcnt lgkmcnt(0)
    v_cvt_pk_f16_f32 v48, v45, v49
    v_cmp_eq_u32 vcc, 0, v2
    s_nop 1
    v_cndmask_b32 v48, v49, v48, vcc
    s_mov_b64 exec, 0xffff
    ds_write_b128 v43, v[48:51]
    s_mov_b64 exec, -1

L_kA_notail:
    s_waitcnt lgkmcnt(12)
    v_cvt_pk_f16_f32 v56, v124, v125
    v_cvt_pk_f16_f32 v57, v126, v127
    v_cvt_pk_f16_f32 v58, v128, v129
    v_cvt_pk_f16_f32 v59, v130, v131
    v_cvt_pk_f16_f32 v60, v132, v133
    v_cvt_pk_f16_f32 v61, v134, v135
    ds_write_b128 v122, v[56:59] offset:0
    v_mov_b32 v64, v57
    v_mov_b32 v65, v58
    v_mov_b32 v66, v59
    v_mov_b32 v67, v60
    ds_write_b128 v122, v[64:67] offset:8320
    v_alignbit_b32 v68, v57, v56, 16
    v_alignbit_b32 v69, v58, v57, 16
    v_alignbit_b32 v70, v59, v58, 16
    v_alignbit_b32 v71, v60, v59, 16
    ds_write_b128 v122, v[68:71] offset:4160
    v_alignbit_b32 v72, v58, v57, 16
    v_alignbit_b32 v73, v59, v58, 16
    v_alignbit_b32 v74, v60, v59, 16
    v_alignbit_b32 v75, v61, v60, 16
    ds_write_b128 v122, v[72:75] offset:12480
    s_waitcnt lgkmcnt(4)
    v_cvt_pk_f16_f32 v4, v136, v137
    v_cvt_pk_f16_f32 v5, v138, v139
    v_cvt_pk_f16_f32 v6, v140, v141
    v_cvt_pk_f16_f32 v7, v142, v143
    v_cvt_pk_f16_f32 v8, v144, v145
    v_cvt_pk_f16_f32 v9, v146, v147
    ds_write_b128 v122, v[4:7] offset:1024
    v_mov_b32 v12, v5
    v_mov_b32 v13, v6
    v_mov_b32 v14, v7
    v_mov_b32 v15, v8
    ds_write_b128 v122, v[12:15] offset:9344
    v_alignbit_b32 v16, v5, v4, 16
    v_alignbit_b32 v17, v6, v5, 16
    v_alignbit_b32 v18, v7, v6, 16
    v_alignbit_b32 v19, v8, v7, 16
    ds_write_b128 v122, v[16:19] offset:5184
    v_alignbit_b32 v20, v6, v5, 16
    v_alignbit_b32 v21, v7, v6, 16
    v_alignbit_b32 v22, v8, v7, 16
    v_alignbit_b32 v23, v9, v8, 16
    ds_write_b128 v122, v[20:23] offset:13504
    s_branch L_kA_b3
L_kA_uw:
    s_mov_b32 s44, s68
    s_and_b32 s45, s69, 0xffff
    s_mov_b32 s46, 256
    s_mov_b32 s47, 0x00020000
    v_mov_b32 v83, 0
    v_mov_b32 v84, 0
    s_cmp_ge_u32 s2, 1
    s_cbranch_scc1 L_kA_n5ld
    s_cmp_eq_u32 s3, 7
    s_cbranch_scc0 L_kA_n5ld
    s_or_b32 s76, s76, 1
    v_mov_b32 v82, s76
    s_mov_b64 exec, 1
    buffer_atomic_cmpswap v[82:83], v84, s[44:47], 0 offen sc1
    s_mov_b64 exec, -1

L_kA_n5ld:
    s_mov_b32 s20, s4
    s_and_b32 s21, s5, 0xffff
    s_mov_b32 s22, 2359296
    s_mov_b32 s23, 0x00020000
    s_setprio 3
    s_sub_u32 s62, s3, 6
    s_lshl_b32 s63, s2, 3
    s_lshl_b32 s64, s62, 2
    s_add_u32 s63, s63, s64
    v_lshrrev_b32 v3, 4, v2
    v_add_u32 v3, s63, v3
    v_and_b32 v4, 15, v2
    v_mul_u32_u24 v5, 1152, v3
    v_mul_u32_u24 v6, 72, v4
    v_add_u32 v5, v5, v6

    buffer_load_dwordx4 v[8:11], v5, s[20:23], 0 offen offset:0
    buffer_load_dwordx4 v[12:15], v5, s[20:23], 0 offen offset:16
    buffer_load_dwordx4 v[16:19], v5, s[20:23], 0 offen offset:32
    buffer_load_dwordx4 v[20:23], v5, s[20:23], 0 offen offset:48
    buffer_load_dwordx2 v[24:25], v5, s[20:23], 0 offen offset:64
    s_mov_b32 s24, s70
    s_and_b32 s25, s71, 0xffff
    s_mov_b32 s26, 268435456
    s_mov_b32 s27, 0x00020000
    s_cmp_eq_u32 s59, 0
    s_cbranch_scc1 L_kA_nodl
    s_load_dwordx2 s[54:55], s[16:17], s18

L_kA_nodl:
    s_barrier
    v_mul_u32_u24 v6, 720, v4
    v_lshrrev_b32 v3, 4, v2
    v_add_u32 v3, s64, v3
    v_lshl_add_u32 v6, v3, 1, v6
    v_add_u32 v6, 128848, v6
    s_lshl_b32 s65, s62, 6
    v_add_u32 v3, s65, v2
    v_mul_u32_u24 v40, 20, v3
    v_add_u32 v40, 128848, v40
    v_lshlrev_b32 v41, 4, v3
    s_lshl_b32 s65, s62, 5
    v_add_u32 v3, s65, v2
    v_mul_u32_u24 v38, 20, v3
    v_add_u32 v38, 139088, v38
    v_lshlrev_b32 v39, 4, v3
    s_mul_i32 s66, s2, 9216
    s_add_u32 s66, s66, 33554432
    s_lshl_b32 s67, s3, 2
    s_add_u32 s67, s67, 114992
    v_mov_b32 v119, s67
    s_xor_b32 s67, s67, 4
    v_mov_b32 v120, s67
    v_mov_b32 v121, 114984
    v_mov_b32 v122, 0xfff8fff8
    s_mul_i32 s63, s62, 384
    s_mov_b32 s65, 1431655766

    s_add_u32 s67, s63, 0
    v_add_u32 v3, s67, v2
    v_mul_hi_u32 v4, v3, s65
    v_mul_u32_u24 v5, 3, v4
    v_sub_u32 v5, v3, v5
    v_mul_u32_u24 v7, 9216, v4
    v_lshl_add_u32 v96, v5, 4, v7
    v_mul_u32_u24 v7, 4608, v5
    v_lshl_add_u32 v7, v4, 4, v7
    v_add_u32 v102, 115536, v7

    s_add_u32 s67, s63, 64
    v_add_u32 v3, s67, v2
    v_mul_hi_u32 v4, v3, s65
    v_mul_u32_u24 v5, 3, v4
    v_sub_u32 v5, v3, v5
    v_mul_u32_u24 v7, 9216, v4
    v_lshl_add_u32 v97, v5, 4, v7
    v_mul_u32_u24 v7, 4608, v5
    v_lshl_add_u32 v7, v4, 4, v7
    v_add_u32 v103, 115536, v7

    s_add_u32 s67, s63, 128
    v_add_u32 v3, s67, v2
    v_mul_hi_u32 v4, v3, s65
    v_mul_u32_u24 v5, 3, v4
    v_sub_u32 v5, v3, v5
    v_mul_u32_u24 v7, 9216, v4
    v_lshl_add_u32 v98, v5, 4, v7
    v_mul_u32_u24 v7, 4608, v5
    v_lshl_add_u32 v7, v4, 4, v7
    v_add_u32 v104, 115536, v7

    s_add_u32 s67, s63, 192
    v_add_u32 v3, s67, v2
    v_mul_hi_u32 v4, v3, s65
    v_mul_u32_u24 v5, 3, v4
    v_sub_u32 v5, v3, v5
    v_mul_u32_u24 v7, 9216, v4
    v_lshl_add_u32 v99, v5, 4, v7
    v_mul_u32_u24 v7, 4608, v5
    v_lshl_add_u32 v7, v4, 4, v7
    v_add_u32 v105, 115536, v7

    s_add_u32 s67, s63, 256
    v_add_u32 v3, s67, v2
    v_mul_hi_u32 v4, v3, s65
    v_mul_u32_u24 v5, 3, v4
    v_sub_u32 v5, v3, v5
    v_mul_u32_u24 v7, 9216, v4
    v_lshl_add_u32 v100, v5, 4, v7
    v_mul_u32_u24 v7, 4608, v5
    v_lshl_add_u32 v7, v4, 4, v7
    v_add_u32 v106, 115536, v7

    s_add_u32 s67, s63, 320
    v_add_u32 v3, s67, v2
    v_mul_hi_u32 v4, v3, s65
    v_mul_u32_u24 v5, 3, v4
    v_sub_u32 v5, v3, v5
    v_mul_u32_u24 v7, 9216, v4
    v_lshl_add_u32 v101, v5, 4, v7
    v_mul_u32_u24 v7, 4608, v5
    v_lshl_add_u32 v7, v4, 4, v7
    v_add_u32 v107, 115536, v7

    v_mov_b32 v82, -1
    s_cmp_eq_u32 s3, 7
    s_cbranch_scc0 L_kA_np1
    buffer_load_dword v82, v84, s[44:47], 0 offen sc1
L_kA_np1:
    s_cmp_eq_u32 s59, 0
    s_cbranch_scc1 L_kA_nozc
    s_mul_i32 s76, s51, 4224
    s_lshl_b32 s77, s62, 11
    s_add_u32 s76, s76, s77
    s_add_u32 s76, s76, 4194304
    v_lshlrev_b32 v36, 4, v2
    v_mov_b32 v32, 0x7f817f81
    v_mov_b32 v33, 0x7f817f81
    v_mov_b32 v34, 0x7f817f81
    v_mov_b32 v35, 0x7f817f81

    buffer_store_dwordx4 v[32:35], v36, s[24:27], s76 offen sc1
    buffer_store_dwordx4 v[32:35], v36, s[24:27], s76 offen offset:1024 sc1
    s_add_u32 s76, s76, 4224
    buffer_store_dwordx4 v[32:35], v36, s[24:27], s76 offen sc1
    buffer_store_dwordx4 v[32:35], v36, s[24:27], s76 offen offset:1024 sc1
    s_add_u32 s76, s76, 4224
    buffer_store_dwordx4 v[32:35], v36, s[24:27], s76 offen sc1
    buffer_store_dwordx4 v[32:35], v36, s[24:27], s76 offen offset:1024 sc1
    s_waitcnt vmcnt(6)
    s_branch L_kA_zc1
L_kA_nozc:
    s_waitcnt vmcnt(0)
L_kA_zc1:
    v_readfirstlane_b32 s28, v82
    s_cmp_lg_u32 s28, 0
    s_cbranch_scc1 L_kA_uwn
    buffer_load_dword v82, v84, s[44:47], 0 offen sc1

L_kA_uwn:
    v_mov_b32 v26, 0
    v_mov_b32 v28, 0
    v_mov_b32 v30, 0x3f803f80
    v_mov_b32 v27, 0
    v_mov_b32 v29, 0
    v_dot2_f32_bf16 v26, v8, v30, v26
    v_dot2_f32_bf16 v28, v8, v8, v28
    v_dot2_f32_bf16 v27, v9, v30, v27
    v_dot2_f32_bf16 v29, v9, v9, v29
    v_dot2_f32_bf16 v26, v10, v30, v26
    v_dot2_f32_bf16 v28, v10, v10, v28
    v_dot2_f32_bf16 v27, v11, v30, v27
    v_dot2_f32_bf16 v29, v11, v11, v29
    v_dot2_f32_bf16 v26, v12, v30, v26
    v_dot2_f32_bf16 v28, v12, v12, v28
    v_dot2_f32_bf16 v27, v13, v30, v27
    v_dot2_f32_bf16 v29, v13, v13, v29
    v_dot2_f32_bf16 v26, v14, v30, v26
    v_dot2_f32_bf16 v28, v14, v14, v28
    v_dot2_f32_bf16 v27, v15, v30, v27
    v_dot2_f32_bf16 v29, v15, v15, v29
    v_dot2_f32_bf16 v26, v16, v30, v26
    v_dot2_f32_bf16 v28, v16, v16, v28
    v_dot2_f32_bf16 v27, v17, v30, v27
    v_dot2_f32_bf16 v29, v17, v17, v29
    v_dot2_f32_bf16 v26, v18, v30, v26
    v_dot2_f32_bf16 v28, v18, v18, v28
    v_dot2_f32_bf16 v27, v19, v30, v27
    v_dot2_f32_bf16 v29, v19, v19, v29
    v_dot2_f32_bf16 v26, v20, v30, v26
    v_dot2_f32_bf16 v28, v20, v20, v28
    v_dot2_f32_bf16 v27, v21, v30, v27
    v_dot2_f32_bf16 v29, v21, v21, v29
    v_dot2_f32_bf16 v26, v22, v30, v26
    v_dot2_f32_bf16 v28, v22, v22, v28
    v_dot2_f32_bf16 v27, v23, v30, v27
    v_dot2_f32_bf16 v29, v23, v23, v29
    v_dot2_f32_bf16 v26, v24, v30, v26
    v_dot2_f32_bf16 v28, v24, v24, v28
    v_dot2_f32_bf16 v27, v25, v30, v27
    v_dot2_f32_bf16 v29, v25, v25, v29
    s_nop 3
    v_add_f32 v26, v26, v27
    v_add_f32 v28, v28, v29
    s_nop 1
    v_add_f32 v26, v26, v26 row_ror:1
    v_add_f32 v28, v28, v28 row_ror:1
    s_nop 1
    v_add_f32 v26, v26, v26 row_ror:2
    v_add_f32 v28, v28, v28 row_ror:2
    s_nop 1
    v_add_f32 v26, v26, v26 row_ror:4
    v_add_f32 v28, v28, v28 row_ror:4
    s_nop 1
    v_add_f32 v26, v26, v26 row_ror:8
    v_add_f32 v28, v28, v28 row_ror:8
    v_mul_f32 v26, 0x3ae38e39, v26
    v_mul_f32 v28, 0x3ae38e39, v28
    v_fma_f32 v28, -v26, v26, v28
    v_max_f32 v28, 0, v28
    v_cvt_pk_bf16_f32 v26, v26, v26
    v_lshlrev_b32 v26, 16, v26
    v_cvt_pk_bf16_f32 v28, v28, v28
    v_lshlrev_b32 v28, 16, v28
    v_add_f32 v28, 0x3727c5ac, v28
    v_cvt_pk_bf16_f32 v28, v28, v28
    v_lshlrev_b32 v28, 16, v28
    v_sqrt_f32 v28, v28
    s_nop 0
    v_cvt_pk_bf16_f32 v28, v28, v28
    v_lshlrev_b32 v28, 16, v28
    v_rcp_f32 v28, v28
    v_mov_b32 v27, v26
    s_nop 0
    v_mov_b32 v29, v28
    v_lshlrev_b32 v32, 16, v8
    v_and_b32 v33, 0xffff0000, v8
    v_lshlrev_b32 v34, 16, v9
    v_and_b32 v35, 0xffff0000, v9
    v_lshlrev_b32 v36, 16, v10
    v_and_b32 v37, 0xffff0000, v10
    v_pk_add_f32 v[32:33], v[32:33], v[26:27] neg_lo:[0,1] neg_hi:[0,1]
    v_pk_add_f32 v[34:35], v[34:35], v[26:27] neg_lo:[0,1] neg_hi:[0,1]
    v_pk_add_f32 v[36:37], v[36:37], v[26:27] neg_lo:[0,1] neg_hi:[0,1]
    v_cvt_pk_bf16_f32 v42, v32, v33
    v_cvt_pk_bf16_f32 v43, v34, v35
    v_cvt_pk_bf16_f32 v44, v36, v37
    v_lshlrev_b32 v32, 16, v42
    v_and_b32 v33, 0xffff0000, v42
    v_lshlrev_b32 v34, 16, v43
    v_and_b32 v35, 0xffff0000, v43
    v_lshlrev_b32 v36, 16, v44
    v_and_b32 v37, 0xffff0000, v44
    v_pk_mul_f32 v[32:33], v[32:33], v[28:29]
    v_pk_mul_f32 v[34:35], v[34:35], v[28:29]
    v_pk_mul_f32 v[36:37], v[36:37], v[28:29]
    v_cvt_pk_bf16_f32 v42, v32, v33
    v_cvt_pk_bf16_f32 v43, v34, v35
    v_cvt_pk_bf16_f32 v44, v36, v37
    v_lshlrev_b32 v32, 16, v42
    v_and_b32 v33, 0xffff0000, v42
    v_lshlrev_b32 v34, 16, v43
    v_and_b32 v35, 0xffff0000, v43
    v_lshlrev_b32 v36, 16, v44
    v_and_b32 v37, 0xffff0000, v44
    v_cvt_pk_f16_f32 v42, v32, v33
    v_cvt_pk_f16_f32 v43, v34, v35
    v_cvt_pk_f16_f32 v44, v36, v37
    ds_write_b16 v6, v42 offset:0
    ds_write_b16_d16_hi v6, v42 offset:20
    ds_write_b16 v6, v43 offset:40
    ds_write_b16_d16_hi v6, v43 offset:60
    ds_write_b16 v6, v44 offset:80
    ds_write_b16_d16_hi v6, v44 offset:100
    v_lshlrev_b32 v32, 16, v11
    v_and_b32 v33, 0xffff0000, v11
    v_lshlrev_b32 v34, 16, v12
    v_and_b32 v35, 0xffff0000, v12
    v_lshlrev_b32 v36, 16, v13
    v_and_b32 v37, 0xffff0000, v13
    v_pk_add_f32 v[32:33], v[32:33], v[26:27] neg_lo:[0,1] neg_hi:[0,1]
    v_pk_add_f32 v[34:35], v[34:35], v[26:27] neg_lo:[0,1] neg_hi:[0,1]
    v_pk_add_f32 v[36:37], v[36:37], v[26:27] neg_lo:[0,1] neg_hi:[0,1]
    v_cvt_pk_bf16_f32 v42, v32, v33
    v_cvt_pk_bf16_f32 v43, v34, v35
    v_cvt_pk_bf16_f32 v44, v36, v37
    v_lshlrev_b32 v32, 16, v42
    v_and_b32 v33, 0xffff0000, v42
    v_lshlrev_b32 v34, 16, v43
    v_and_b32 v35, 0xffff0000, v43
    v_lshlrev_b32 v36, 16, v44
    v_and_b32 v37, 0xffff0000, v44
    v_pk_mul_f32 v[32:33], v[32:33], v[28:29]
    v_pk_mul_f32 v[34:35], v[34:35], v[28:29]
    v_pk_mul_f32 v[36:37], v[36:37], v[28:29]
    v_cvt_pk_bf16_f32 v42, v32, v33
    v_cvt_pk_bf16_f32 v43, v34, v35
    v_cvt_pk_bf16_f32 v44, v36, v37
    v_lshlrev_b32 v32, 16, v42
    v_and_b32 v33, 0xffff0000, v42
    v_lshlrev_b32 v34, 16, v43
    v_and_b32 v35, 0xffff0000, v43
    v_lshlrev_b32 v36, 16, v44
    v_and_b32 v37, 0xffff0000, v44
    v_cvt_pk_f16_f32 v42, v32, v33
    v_cvt_pk_f16_f32 v43, v34, v35
    v_cvt_pk_f16_f32 v44, v36, v37
    ds_write_b16 v6, v42 offset:120
    ds_write_b16_d16_hi v6, v42 offset:140
    ds_write_b16 v6, v43 offset:160
    ds_write_b16_d16_hi v6, v43 offset:180
    ds_write_b16 v6, v44 offset:200
    ds_write_b16_d16_hi v6, v44 offset:220
    v_lshlrev_b32 v32, 16, v14
    v_and_b32 v33, 0xffff0000, v14
    v_lshlrev_b32 v34, 16, v15
    v_and_b32 v35, 0xffff0000, v15
    v_lshlrev_b32 v36, 16, v16
    v_and_b32 v37, 0xffff0000, v16
    v_pk_add_f32 v[32:33], v[32:33], v[26:27] neg_lo:[0,1] neg_hi:[0,1]
    v_pk_add_f32 v[34:35], v[34:35], v[26:27] neg_lo:[0,1] neg_hi:[0,1]
    v_pk_add_f32 v[36:37], v[36:37], v[26:27] neg_lo:[0,1] neg_hi:[0,1]
    v_cvt_pk_bf16_f32 v42, v32, v33
    v_cvt_pk_bf16_f32 v43, v34, v35
    v_cvt_pk_bf16_f32 v44, v36, v37
    v_lshlrev_b32 v32, 16, v42
    v_and_b32 v33, 0xffff0000, v42
    v_lshlrev_b32 v34, 16, v43
    v_and_b32 v35, 0xffff0000, v43
    v_lshlrev_b32 v36, 16, v44
    v_and_b32 v37, 0xffff0000, v44
    v_pk_mul_f32 v[32:33], v[32:33], v[28:29]
    v_pk_mul_f32 v[34:35], v[34:35], v[28:29]
    v_pk_mul_f32 v[36:37], v[36:37], v[28:29]
    v_cvt_pk_bf16_f32 v42, v32, v33
    v_cvt_pk_bf16_f32 v43, v34, v35
    v_cvt_pk_bf16_f32 v44, v36, v37
    v_lshlrev_b32 v32, 16, v42
    v_and_b32 v33, 0xffff0000, v42
    v_lshlrev_b32 v34, 16, v43
    v_and_b32 v35, 0xffff0000, v43
    v_lshlrev_b32 v36, 16, v44
    v_and_b32 v37, 0xffff0000, v44
    v_cvt_pk_f16_f32 v42, v32, v33
    v_cvt_pk_f16_f32 v43, v34, v35
    v_cvt_pk_f16_f32 v44, v36, v37
    ds_write_b16 v6, v42 offset:240
    ds_write_b16_d16_hi v6, v42 offset:260
    ds_write_b16 v6, v43 offset:280
    ds_write_b16_d16_hi v6, v43 offset:300
    ds_write_b16 v6, v44 offset:320
    ds_write_b16_d16_hi v6, v44 offset:340
    v_lshlrev_b32 v32, 16, v17
    v_and_b32 v33, 0xffff0000, v17
    v_lshlrev_b32 v34, 16, v18
    v_and_b32 v35, 0xffff0000, v18
    v_lshlrev_b32 v36, 16, v19
    v_and_b32 v37, 0xffff0000, v19
    v_pk_add_f32 v[32:33], v[32:33], v[26:27] neg_lo:[0,1] neg_hi:[0,1]
    v_pk_add_f32 v[34:35], v[34:35], v[26:27] neg_lo:[0,1] neg_hi:[0,1]
    v_pk_add_f32 v[36:37], v[36:37], v[26:27] neg_lo:[0,1] neg_hi:[0,1]
    v_cvt_pk_bf16_f32 v42, v32, v33
    v_cvt_pk_bf16_f32 v43, v34, v35
    v_cvt_pk_bf16_f32 v44, v36, v37
    v_lshlrev_b32 v32, 16, v42
    v_and_b32 v33, 0xffff0000, v42
    v_lshlrev_b32 v34, 16, v43
    v_and_b32 v35, 0xffff0000, v43
    v_lshlrev_b32 v36, 16, v44
    v_and_b32 v37, 0xffff0000, v44
    v_pk_mul_f32 v[32:33], v[32:33], v[28:29]
    v_pk_mul_f32 v[34:35], v[34:35], v[28:29]
    v_pk_mul_f32 v[36:37], v[36:37], v[28:29]
    v_cvt_pk_bf16_f32 v42, v32, v33
    v_cvt_pk_bf16_f32 v43, v34, v35
    v_cvt_pk_bf16_f32 v44, v36, v37
    v_lshlrev_b32 v32, 16, v42
    v_and_b32 v33, 0xffff0000, v42
    v_lshlrev_b32 v34, 16, v43
    v_and_b32 v35, 0xffff0000, v43
    v_lshlrev_b32 v36, 16, v44
    v_and_b32 v37, 0xffff0000, v44
    v_cvt_pk_f16_f32 v42, v32, v33
    v_cvt_pk_f16_f32 v43, v34, v35
    v_cvt_pk_f16_f32 v44, v36, v37
    ds_write_b16 v6, v42 offset:360
    ds_write_b16_d16_hi v6, v42 offset:380
    ds_write_b16 v6, v43 offset:400
    ds_write_b16_d16_hi v6, v43 offset:420
    ds_write_b16 v6, v44 offset:440
    ds_write_b16_d16_hi v6, v44 offset:460
    v_lshlrev_b32 v32, 16, v20
    v_and_b32 v33, 0xffff0000, v20
    v_lshlrev_b32 v34, 16, v21
    v_and_b32 v35, 0xffff0000, v21
    v_lshlrev_b32 v36, 16, v22
    v_and_b32 v37, 0xffff0000, v22
    v_pk_add_f32 v[32:33], v[32:33], v[26:27] neg_lo:[0,1] neg_hi:[0,1]
    v_pk_add_f32 v[34:35], v[34:35], v[26:27] neg_lo:[0,1] neg_hi:[0,1]
    v_pk_add_f32 v[36:37], v[36:37], v[26:27] neg_lo:[0,1] neg_hi:[0,1]
    v_cvt_pk_bf16_f32 v42, v32, v33
    v_cvt_pk_bf16_f32 v43, v34, v35
    v_cvt_pk_bf16_f32 v44, v36, v37
    v_lshlrev_b32 v32, 16, v42
    v_and_b32 v33, 0xffff0000, v42
    v_lshlrev_b32 v34, 16, v43
    v_and_b32 v35, 0xffff0000, v43
    v_lshlrev_b32 v36, 16, v44
    v_and_b32 v37, 0xffff0000, v44
    v_pk_mul_f32 v[32:33], v[32:33], v[28:29]
    v_pk_mul_f32 v[34:35], v[34:35], v[28:29]
    v_pk_mul_f32 v[36:37], v[36:37], v[28:29]
    v_cvt_pk_bf16_f32 v42, v32, v33
    v_cvt_pk_bf16_f32 v43, v34, v35
    v_cvt_pk_bf16_f32 v44, v36, v37
    v_lshlrev_b32 v32, 16, v42
    v_and_b32 v33, 0xffff0000, v42
    v_lshlrev_b32 v34, 16, v43
    v_and_b32 v35, 0xffff0000, v43
    v_lshlrev_b32 v36, 16, v44
    v_and_b32 v37, 0xffff0000, v44
    v_cvt_pk_f16_f32 v42, v32, v33
    v_cvt_pk_f16_f32 v43, v34, v35
    v_cvt_pk_f16_f32 v44, v36, v37
    ds_write_b16 v6, v42 offset:480
    ds_write_b16_d16_hi v6, v42 offset:500
    ds_write_b16 v6, v43 offset:520
    ds_write_b16_d16_hi v6, v43 offset:540
    ds_write_b16 v6, v44 offset:560
    ds_write_b16_d16_hi v6, v44 offset:580
    v_lshlrev_b32 v32, 16, v23
    v_and_b32 v33, 0xffff0000, v23
    v_lshlrev_b32 v34, 16, v24
    v_and_b32 v35, 0xffff0000, v24
    v_lshlrev_b32 v36, 16, v25
    v_and_b32 v37, 0xffff0000, v25
    v_pk_add_f32 v[32:33], v[32:33], v[26:27] neg_lo:[0,1] neg_hi:[0,1]
    v_pk_add_f32 v[34:35], v[34:35], v[26:27] neg_lo:[0,1] neg_hi:[0,1]
    v_pk_add_f32 v[36:37], v[36:37], v[26:27] neg_lo:[0,1] neg_hi:[0,1]
    v_cvt_pk_bf16_f32 v42, v32, v33
    v_cvt_pk_bf16_f32 v43, v34, v35
    v_cvt_pk_bf16_f32 v44, v36, v37
    v_lshlrev_b32 v32, 16, v42
    v_and_b32 v33, 0xffff0000, v42
    v_lshlrev_b32 v34, 16, v43
    v_and_b32 v35, 0xffff0000, v43
    v_lshlrev_b32 v36, 16, v44
    v_and_b32 v37, 0xffff0000, v44
    v_pk_mul_f32 v[32:33], v[32:33], v[28:29]
    v_pk_mul_f32 v[34:35], v[34:35], v[28:29]
    v_pk_mul_f32 v[36:37], v[36:37], v[28:29]
    v_cvt_pk_bf16_f32 v42, v32, v33
    v_cvt_pk_bf16_f32 v43, v34, v35
    v_cvt_pk_bf16_f32 v44, v36, v37
    v_lshlrev_b32 v32, 16, v42
    v_and_b32 v33, 0xffff0000, v42
    v_lshlrev_b32 v34, 16, v43
    v_and_b32 v35, 0xffff0000, v43
    v_lshlrev_b32 v36, 16, v44
    v_and_b32 v37, 0xffff0000, v44
    v_cvt_pk_f16_f32 v42, v32, v33
    v_cvt_pk_f16_f32 v43, v34, v35
    v_cvt_pk_f16_f32 v44, v36, v37
    ds_write_b16 v6, v42 offset:600
    ds_write_b16_d16_hi v6, v42 offset:620
    ds_write_b16 v6, v43 offset:640
    ds_write_b16_d16_hi v6, v43 offset:660
    ds_write_b16 v6, v44 offset:680
    ds_write_b16_d16_hi v6, v44 offset:700
    v_mov_b32 v36, 1
    s_waitcnt lgkmcnt(0)
    ds_write_b32 v119, v36

    s_cmp_eq_u32 s3, 7
    s_cbranch_scc0 L_kA_uwn2
    s_mov_b32 s77, 0
L_kA_uwl:
    s_waitcnt vmcnt(0)
    v_readfirstlane_b32 s28, v82
    s_add_u32 s77, s77, 1
    s_cmp_lg_u32 s28, 0
    s_cbranch_scc1 L_kA_uwok
    s_cmp_ge_u32 s77, 20000
    s_cbranch_scc1 L_kA_uwok
    buffer_load_dword v82, v84, s[44:47], 0 offen sc1
    s_branch L_kA_uwl

L_kA_uwok:
    s_or_b32 s28, s28, 1
    v_mov_b32 v82, s28
    ds_write_b32 v121, v82
    s_branch L_kA_uwn3
L_kA_uwn2:
    s_waitcnt vmcnt(0)
    s_mov_b32 s77, 0
L_kA_nw:
    ds_read_b32 v7, v121
    s_add_u32 s77, s77, 1
    s_waitcnt lgkmcnt(0)
    v_readfirstlane_b32 s28, v7
    s_cmp_gt_u32 s77, 100000
    s_cbranch_scc1 L_kA_nw_ok
    s_cmp_lg_u32 s28, 0
    s_cbranch_scc0 L_kA_nw

L_kA_nw_ok:
L_kA_uwn3:
    s_lshr_b32 s36, s28, 1
    s_and_b32 s37, s36, 3
    s_lshl_b32 s37, s37, 1
    s_or_b32 s37, s37, 1
    s_lshr_b32 s36, s36, 2
    s_lshl_b32 s36, s36, 4
    s_or_b32 s36, s36, s37

    s_bfe_u32 s37, s36, 196608
    s_bfe_u32 s38, s36, 196611
    s_lshl_b32 s38, s38, 16
    s_or_b32 s32, s37, s38

    s_bfe_u32 s37, s36, 196614
    s_bfe_u32 s38, s36, 196617
    s_lshl_b32 s38, s38, 16
    s_or_b32 s33, s37, s38

    s_bfe_u32 s37, s36, 196620
    s_bfe_u32 s38, s36, 196623
    s_lshl_b32 s38, s38, 16
    s_or_b32 s34, s37, s38

    s_bfe_u32 s37, s36, 196626
    s_bfe_u32 s38, s36, 196629
    s_lshl_b32 s38, s38, 16
    s_or_b32 s35, s37, s38

    s_mov_b32 s77, 0
L_kA_ups:
    ds_read_b32 v7, v120
    s_add_u32 s77, s77, 1
    s_waitcnt lgkmcnt(0)
    v_readfirstlane_b32 s76, v7
    s_cmp_gt_u32 s77, 100000
    s_cbranch_scc1 L_kA_ups_ok
    s_cmp_ge_u32 s76, 1
    s_cbranch_scc0 L_kA_ups

L_kA_ups_ok:
    ds_read2_b32 v[48:49], v40 offset0:0 offset1:1
    ds_read2_b32 v[50:51], v40 offset0:2 offset1:3
    v_add_u32 v40, 2560, v40
    ds_read2_b32 v[52:53], v40 offset0:0 offset1:1
    ds_read2_b32 v[54:55], v40 offset0:2 offset1:3
    v_add_u32 v40, 2560, v40
    ds_read2_b32 v[56:57], v40 offset0:0 offset1:1
    ds_read2_b32 v[58:59], v40 offset0:2 offset1:3
    v_add_u32 v40, 2560, v40
    ds_read2_b32 v[60:61], v40 offset0:0 offset1:1
    ds_read2_b32 v[62:63], v40 offset0:2 offset1:3
    ds_read2_b32 v[64:65], v38 offset0:0 offset1:1
    ds_read2_b32 v[66:67], v38 offset0:2 offset1:3
    s_waitcnt lgkmcnt(8)
    v_and_or_b32 v48, v48, v122, s32
    v_and_or_b32 v49, v49, v122, s33
    v_and_or_b32 v50, v50, v122, s34
    v_and_or_b32 v51, v51, v122, s35
    buffer_store_dwordx4 v[48:51], v41, s[24:27], s66 offen offset:0 sc1
    s_waitcnt lgkmcnt(6)
    v_and_or_b32 v52, v52, v122, s32
    v_and_or_b32 v53, v53, v122, s33
    v_and_or_b32 v54, v54, v122, s34
    v_and_or_b32 v55, v55, v122, s35
    buffer_store_dwordx4 v[52:55], v41, s[24:27], s66 offen offset:2048 sc1
    s_waitcnt lgkmcnt(4)
    v_and_or_b32 v56, v56, v122, s32
    v_and_or_b32 v57, v57, v122, s33
    v_and_or_b32 v58, v58, v122, s34
    v_and_or_b32 v59, v59, v122, s35
    s_add_u32 s66, s66, 4096
    buffer_store_dwordx4 v[56:59], v41, s[24:27], s66 offen offset:0 sc1
    s_waitcnt lgkmcnt(2)
    v_and_or_b32 v60, v60, v122, s32
    v_and_or_b32 v61, v61, v122, s33
    v_and_or_b32 v62, v62, v122, s34
    v_and_or_b32 v63, v63, v122, s35
    buffer_store_dwordx4 v[60:63], v41, s[24:27], s66 offen offset:2048 sc1
    s_waitcnt lgkmcnt(0)
    v_and_or_b32 v64, v64, v122, s32
    v_and_or_b32 v65, v65, v122, s33
    v_and_or_b32 v66, v66, v122, s34
    v_and_or_b32 v67, v67, v122, s35
    s_add_u32 s66, s66, 4096
    s_mov_b32 exec_hi, 0
    buffer_store_dwordx4 v[64:67], v39, s[24:27], s66 offen sc1
    s_mov_b32 exec_hi, -1
    s_cmp_eq_u32 s59, 0
    s_cbranch_scc1 L_kA_extraY
    s_mul_i32 s66, s51, 16
    s_add_u32 s66, s66, 33554432

    s_mov_b32 s77, 0
    s_mov_b64 exec, 15
L_kA_spl:
    buffer_load_dwordx4 v[48:51], v101, s[24:27], s66 offen sc1
    s_waitcnt vmcnt(0)

    v_xor_b32 v48, s32, v48
    v_xor_b32 v49, s33, v49
    v_xor_b32 v50, s34, v50
    v_xor_b32 v51, s35, v51
    v_or3_b32 v72, v48, v49, v50
    v_or_b32 v72, v72, v51
    v_and_b32 v72, 0x70007, v72
    v_cmp_ne_u32 vcc, 0, v72
    s_add_u32 s77, s77, 1
    s_cmp_gt_u32 s77, 8000
    s_cbranch_scc1 L_kA_spl_ok
    s_cbranch_vccz L_kA_spl_ok
    s_sleep 1
    s_branch L_kA_spl

L_kA_spl_ok:
    s_mov_b64 exec, -1
    s_mov_b64 s[4:5], -1
    s_mov_b64 s[6:7], -1
    s_mov_b64 s[8:9], -1
    s_mov_b64 s[10:11], -1
    s_mov_b64 s[12:13], -1
    s_mov_b64 s[14:15], -1
    s_mov_b32 s67, 0
L_kA_sp:
    s_mov_b64 exec, s[4:5]
    buffer_load_dwordx4 v[48:51], v96, s[24:27], s66 offen sc1
    s_mov_b64 exec, s[6:7]
    buffer_load_dwordx4 v[52:55], v97, s[24:27], s66 offen sc1
    s_mov_b64 exec, s[8:9]
    buffer_load_dwordx4 v[56:59], v98, s[24:27], s66 offen sc1
    s_mov_b64 exec, s[10:11]
    buffer_load_dwordx4 v[60:63], v99, s[24:27], s66 offen sc1
    s_mov_b64 exec, s[12:13]
    buffer_load_dwordx4 v[64:67], v100, s[24:27], s66 offen sc1
    s_mov_b64 exec, s[14:15]
    buffer_load_dwordx4 v[68:71], v101, s[24:27], s66 offen sc1
    s_waitcnt vmcnt(0)
    s_mov_b64 exec, s[4:5]
    v_xor_b32 v48, s32, v48
    v_xor_b32 v49, s33, v49
    v_xor_b32 v50, s34, v50
    v_xor_b32 v51, s35, v51
    v_or3_b32 v72, v48, v49, v50
    v_or_b32 v72, v72, v51
    v_and_b32 v72, 0x70007, v72
    v_cmp_ne_u32 s[4:5], 0, v72
    s_mov_b64 exec, s[6:7]
    v_xor_b32 v52, s32, v52
    v_xor_b32 v53, s33, v53
    v_xor_b32 v54, s34, v54
    v_xor_b32 v55, s35, v55
    v_or3_b32 v72, v52, v53, v54
    v_or_b32 v72, v72, v55
    v_and_b32 v72, 0x70007, v72
    v_cmp_ne_u32 s[6:7], 0, v72
    s_mov_b64 exec, s[8:9]
    v_xor_b32 v56, s32, v56
    v_xor_b32 v57, s33, v57
    v_xor_b32 v58, s34, v58
    v_xor_b32 v59, s35, v59
    v_or3_b32 v72, v56, v57, v58
    v_or_b32 v72, v72, v59
    v_and_b32 v72, 0x70007, v72
    v_cmp_ne_u32 s[8:9], 0, v72
    s_mov_b64 exec, s[10:11]
    v_xor_b32 v60, s32, v60
    v_xor_b32 v61, s33, v61
    v_xor_b32 v62, s34, v62
    v_xor_b32 v63, s35, v63
    v_or3_b32 v72, v60, v61, v62
    v_or_b32 v72, v72, v63
    v_and_b32 v72, 0x70007, v72
    v_cmp_ne_u32 s[10:11], 0, v72
    s_mov_b64 exec, s[12:13]
    v_xor_b32 v64, s32, v64
    v_xor_b32 v65, s33, v65
    v_xor_b32 v66, s34, v66
    v_xor_b32 v67, s35, v67
    v_or3_b32 v72, v64, v65, v66
    v_or_b32 v72, v72, v67
    v_and_b32 v72, 0x70007, v72
    v_cmp_ne_u32 s[12:13], 0, v72
    s_mov_b64 exec, s[14:15]
    v_xor_b32 v68, s32, v68
    v_xor_b32 v69, s33, v69
    v_xor_b32 v70, s34, v70
    v_xor_b32 v71, s35, v71
    v_or3_b32 v72, v68, v69, v70
    v_or_b32 v72, v72, v71
    v_and_b32 v72, 0x70007, v72
    v_cmp_ne_u32 s[14:15], 0, v72
    s_or_b64 vcc, s[4:5], s[6:7]
    s_or_b64 vcc, vcc, s[8:9]
    s_or_b64 vcc, vcc, s[10:11]
    s_or_b64 vcc, vcc, s[12:13]
    s_or_b64 vcc, vcc, s[14:15]
    s_cmp_eq_u64 vcc, 0
    s_cbranch_scc1 L_kA_sp_ok
    s_add_u32 s67, s67, 1
    s_cmp_gt_u32 s67, 8000
    s_cbranch_scc1 L_kA_sp_ok

    s_branch L_kA_sp

L_kA_sp_ok:
    s_mov_b64 exec, -1
    ds_write_b128 v102, v[48:51]
    ds_write_b128 v103, v[52:55]
    ds_write_b128 v104, v[56:59]
    ds_write_b128 v105, v[60:63]
    ds_write_b128 v106, v[64:67]
    ds_write_b128 v107, v[68:71]
    s_setprio 0
L_kA_b3:
    s_waitcnt lgkmcnt(0)
    s_barrier
    v_and_b32 v3, 15, v2
    v_lshrrev_b32 v4, 4, v2
    s_cmp_ge_u32 s3, 4
    s_cbranch_scc0 L_kA_main
    v_lshlrev_b32 v36, 4, v2
    v_mov_b32 v32, 0x7c017c01
    v_mov_b32 v33, 0x7c017c01
    v_mov_b32 v34, 0x7c017c01
    v_mov_b32 v35, 0x7c017c01
    s_sub_u32 s77, s3, 4
    s_lshl_b32 s76, s50, 2
    s_add_u32 s76, s76, s77
    s_mul_i32 s76, s76, 9216
    s_add_u32 s76, s76, 42991616

    s_cmp_ge_u32 s2, 128
    s_cbranch_scc1 L_kA_noxr
    s_and_b32 s64, s2, 7
    s_lshl_b32 s64, s64, 4
    s_lshr_b32 s65, s2, 3
    s_add_u32 s64, s64, s65
    s_lshl_b32 s64, s64, 1
    s_lshr_b32 s65, s77, 1
    s_add_u32 s64, s64, s65
    s_lshr_b32 s65, s64, 2
    s_lshl_b32 s65, s65, 5
    s_and_b32 s64, s64, 3
    s_lshl_b32 s64, s64, 2
    s_add_u32 s64, s64, s65
    s_and_b32 s65, s77, 1
    s_lshl_b32 s65, s65, 4
    s_add_u32 s64, s64, s65
    v_add_u32 v5, s64, v4
    v_mul_u32_u24 v5, 1152, v5
    v_mul_u32_u24 v6, 72, v3
    v_add_u32 v5, v5, v6

    buffer_load_dwordx4 v[40:43], v5, s[20:23], 0 offen offset:0
    buffer_load_dwordx4 v[44:47], v5, s[20:23], 0 offen offset:16
    buffer_load_dwordx4 v[48:51], v5, s[20:23], 0 offen offset:32
    buffer_load_dwordx4 v[52:55], v5, s[20:23], 0 offen offset:48
    buffer_load_dwordx2 v[56:57], v5, s[20:23], 0 offen offset:64
    v_mul_u32_u24 v6, 1296, v3
    s_lshl_b32 s65, s77, 3
    v_lshl_add_u32 v6, v4, 1, v6
    v_add_u32 v6, s65, v6
    v_add_u32 v6, 140368, v6

L_kA_noxr:
    buffer_store_dwordx4 v[32:35], v36, s[24:27], s76 offen offset:0 sc1
    buffer_store_dwordx4 v[32:35], v36, s[24:27], s76 offen offset:1024 sc1
    buffer_store_dwordx4 v[32:35], v36, s[24:27], s76 offen offset:2048 sc1
    buffer_store_dwordx4 v[32:35], v36, s[24:27], s76 offen offset:3072 sc1
    s_add_u32 s76, s76, 4096
    buffer_store_dwordx4 v[32:35], v36, s[24:27], s76 offen offset:0 sc1
    buffer_store_dwordx4 v[32:35], v36, s[24:27], s76 offen offset:1024 sc1
    buffer_store_dwordx4 v[32:35], v36, s[24:27], s76 offen offset:2048 sc1
    buffer_store_dwordx4 v[32:35], v36, s[24:27], s76 offen offset:3072 sc1
    s_add_u32 s76, s76, 4096
    buffer_store_dwordx4 v[32:35], v36, s[24:27], s76 offen offset:0 sc1
    s_cmp_ge_u32 s2, 128
    s_cbranch_scc1 L_kA_noxw
    s_waitcnt vmcnt(9)
    ds_write_b16 v6, v40 offset:0
    ds_write_b16_d16_hi v6, v40 offset:36
    ds_write_b16 v6, v41 offset:72
    ds_write_b16_d16_hi v6, v41 offset:108
    ds_write_b16 v6, v42 offset:144
    ds_write_b16_d16_hi v6, v42 offset:180
    ds_write_b16 v6, v43 offset:216
    ds_write_b16_d16_hi v6, v43 offset:252
    ds_write_b16 v6, v44 offset:288
    ds_write_b16_d16_hi v6, v44 offset:324
    ds_write_b16 v6, v45 offset:360
    ds_write_b16_d16_hi v6, v45 offset:396
    ds_write_b16 v6, v46 offset:432
    ds_write_b16_d16_hi v6, v46 offset:468
    ds_write_b16 v6, v47 offset:504
    ds_write_b16_d16_hi v6, v47 offset:540
    ds_write_b16 v6, v48 offset:576
    ds_write_b16_d16_hi v6, v48 offset:612
    ds_write_b16 v6, v49 offset:648
    ds_write_b16_d16_hi v6, v49 offset:684
    ds_write_b16 v6, v50 offset:720
    ds_write_b16_d16_hi v6, v50 offset:756
    ds_write_b16 v6, v51 offset:792
    ds_write_b16_d16_hi v6, v51 offset:828
    ds_write_b16 v6, v52 offset:864
    ds_write_b16_d16_hi v6, v52 offset:900
    ds_write_b16 v6, v53 offset:936
    ds_write_b16_d16_hi v6, v53 offset:972
    ds_write_b16 v6, v54 offset:1008
    ds_write_b16_d16_hi v6, v54 offset:1044
    ds_write_b16 v6, v55 offset:1080
    ds_write_b16_d16_hi v6, v55 offset:1116
    ds_write_b16 v6, v56 offset:1152
    ds_write_b16_d16_hi v6, v56 offset:1188
    ds_write_b16 v6, v57 offset:1224
    ds_write_b16_d16_hi v6, v57 offset:1260
L_kA_noxw:
    s_waitcnt vmcnt(0) lgkmcnt(0)
    s_branch L_kA_main_done
L_kA_main:
    v_lshrrev_b32 v5, 1, v4
    v_and_b32 v6, 1, v4
    v_lshlrev_b32 v5, 4, v5
    v_lshlrev_b32 v6, 3, v6
    v_add_u32 v7, v5, v3
    v_sub_u32 v7, v7, v6
    v_sub_u32 v7, 2048, v7
    v_and_b32 v8, 3, v7
    v_sub_u32 v7, v7, v8
    v_lshlrev_b32 v7, 1, v7
    v_mul_u32_u24 v8, 4160, v8
    v_add_u32 v7, v7, v8
    s_lshl_b32 s62, s3, 7
    s_add_u32 s63, s62, 3648
    v_subrev_u32 v7, s63, v7
    v_lshlrev_b32 v9, 4, v3
    v_sub_u32 v9, v9, v5
    v_add_u32 v9, v9, v6
    v_add_u32 v9, 256, v9
    v_lshlrev_b32 v9, 1, v9
    s_add_u32 s63, s62, 64
    v_subrev_u32 v9, s63, v9
    v_add_u32 v9, 115024, v9
    v_mov_b32 v10, v7
    v_add_u32 v11, 30096, v7
    v_add_u32 v12, 60192, v7

    ds_read_b64 a[0:1], v10 offset:3648
    ds_read_b64 a[2:3], v10 offset:3656
    ds_read_b128 a[64:67], v9 offset:64
    ds_read_b64 a[4:5], v10 offset:3136
    ds_read_b64 a[6:7], v10 offset:3144
    ds_read_b128 a[68:71], v9 offset:576
    ds_read_b64 a[8:9], v10 offset:2624
    ds_read_b64 a[10:11], v10 offset:2632
    ds_read_b128 a[72:75], v9 offset:1088
    ds_read_b64 a[12:13], v10 offset:2112
    ds_read_b64 a[14:15], v10 offset:2120
    ds_read_b128 a[76:79], v9 offset:1600
    ds_read_b64 a[16:17], v10 offset:1600
    ds_read_b64 a[18:19], v10 offset:1608
    ds_read_b128 a[80:83], v9 offset:2112
    ds_read_b64 a[20:21], v10 offset:1088
    ds_read_b64 a[22:23], v10 offset:1096
    ds_read_b128 a[84:87], v9 offset:2624
    ds_read_b64 a[24:25], v10 offset:576
    ds_read_b64 a[26:27], v10 offset:584
    ds_read_b128 a[88:91], v9 offset:3136
    ds_read_b64 a[28:29], v10 offset:64
    ds_read_b64 a[30:31], v10 offset:72
    ds_read_b128 a[92:95], v9 offset:3648
    v_mov_b32 v16, 0
    v_mov_b32 v17, 0
    v_mov_b32 v18, 0
    v_mov_b32 v19, 0
    v_mov_b32 v20, 0
    v_mov_b32 v21, 0
    v_mov_b32 v22, 0
    v_mov_b32 v23, 0
    v_mov_b32 v24, 0
    v_mov_b32 v25, 0
    v_mov_b32 v26, 0
    v_mov_b32 v27, 0
    v_mov_b32 v28, 0
    v_mov_b32 v29, 0
    v_mov_b32 v30, 0
    v_mov_b32 v31, 0
    v_mov_b32 v32, 0
    v_mov_b32 v33, 0
    v_mov_b32 v34, 0
    v_mov_b32 v35, 0
    v_mov_b32 v36, 0
    v_mov_b32 v37, 0
    v_mov_b32 v38, 0
    v_mov_b32 v39, 0
    v_mov_b32 v40, 0
    v_mov_b32 v41, 0
    v_mov_b32 v42, 0
    v_mov_b32 v43, 0
    v_mov_b32 v44, 0
    v_mov_b32 v45, 0
    v_mov_b32 v46, 0
    v_mov_b32 v47, 0
    v_mov_b32 v48, 0
    v_mov_b32 v49, 0
    v_mov_b32 v50, 0
    v_mov_b32 v51, 0
    v_mov_b32 v52, 0
    v_mov_b32 v53, 0
    v_mov_b32 v54, 0
    v_mov_b32 v55, 0
    v_mov_b32 v56, 0
    v_mov_b32 v57, 0
    v_mov_b32 v58, 0
    v_mov_b32 v59, 0
    v_mov_b32 v60, 0
    v_mov_b32 v61, 0
    v_mov_b32 v62, 0
    v_mov_b32 v63, 0
    v_mov_b32 v64, 0
    v_mov_b32 v65, 0
    v_mov_b32 v66, 0
    v_mov_b32 v67, 0
    v_mov_b32 v68, 0
    v_mov_b32 v69, 0
    v_mov_b32 v70, 0
    v_mov_b32 v71, 0
    v_mov_b32 v72, 0
    v_mov_b32 v73, 0
    v_mov_b32 v74, 0
    v_mov_b32 v75, 0
    v_mov_b32 v76, 0
    v_mov_b32 v77, 0
    v_mov_b32 v78, 0
    v_mov_b32 v79, 0
    v_mov_b32 v80, 0
    v_mov_b32 v81, 0
    v_mov_b32 v82, 0
    v_mov_b32 v83, 0
    v_mov_b32 v84, 0
    v_mov_b32 v85, 0
    v_mov_b32 v86, 0
    v_mov_b32 v87, 0
    v_mov_b32 v88, 0
    v_mov_b32 v89, 0
    v_mov_b32 v90, 0
    v_mov_b32 v91, 0
    v_mov_b32 v92, 0
    v_mov_b32 v93, 0
    v_mov_b32 v94, 0
    v_mov_b32 v95, 0
    v_mov_b32 v96, 0
    v_mov_b32 v97, 0
    v_mov_b32 v98, 0
    v_mov_b32 v99, 0
    v_mov_b32 v100, 0
    v_mov_b32 v101, 0
    v_mov_b32 v102, 0
    v_mov_b32 v103, 0
    v_mov_b32 v104, 0
    v_mov_b32 v105, 0
    v_mov_b32 v106, 0
    v_mov_b32 v107, 0
    v_mov_b32 v108, 0
    v_mov_b32 v109, 0
    v_mov_b32 v110, 0
    v_mov_b32 v111, 0
    s_waitcnt lgkmcnt(0)
    v_mfma_f32_16x16x32_f16 v[16:19], a[0:3], a[64:67], v[16:19]
    ds_read_b64 a[32:33], v10 offset:3584
    v_mfma_f32_16x16x32_f16 v[20:23], a[0:3], a[68:71], v[20:23]
    ds_read_b64 a[34:35], v10 offset:3592
    v_mfma_f32_16x16x32_f16 v[20:23], a[4:7], a[64:67], v[20:23]
    ds_read_b128 v[112:115], v9 offset:0
    v_mfma_f32_16x16x32_f16 v[24:27], a[0:3], a[72:75], v[24:27]
    ds_read_b64 a[36:37], v10 offset:3072
    v_mfma_f32_16x16x32_f16 v[24:27], a[4:7], a[68:71], v[24:27]
    ds_read_b64 a[38:39], v10 offset:3080
    v_mfma_f32_16x16x32_f16 v[24:27], a[8:11], a[64:67], v[24:27]
    ds_read_b128 v[116:119], v9 offset:512
    v_mfma_f32_16x16x32_f16 v[28:31], a[0:3], a[76:79], v[28:31]
    ds_read_b64 a[40:41], v10 offset:2560
    v_mfma_f32_16x16x32_f16 v[28:31], a[4:7], a[72:75], v[28:31]
    ds_read_b64 a[42:43], v10 offset:2568
    v_mfma_f32_16x16x32_f16 v[28:31], a[8:11], a[68:71], v[28:31]
    ds_read_b128 v[120:123], v9 offset:1024
    v_mfma_f32_16x16x32_f16 v[28:31], a[12:15], a[64:67], v[28:31]
    ds_read_b64 a[44:45], v10 offset:2048
    v_mfma_f32_16x16x32_f16 v[32:35], a[0:3], a[80:83], v[32:35]
    ds_read_b64 a[46:47], v10 offset:2056
    v_mfma_f32_16x16x32_f16 v[32:35], a[4:7], a[76:79], v[32:35]
    ds_read_b128 v[124:127], v9 offset:1536
    v_mfma_f32_16x16x32_f16 v[32:35], a[8:11], a[72:75], v[32:35]
    ds_read_b64 a[48:49], v10 offset:1536
    v_mfma_f32_16x16x32_f16 v[32:35], a[12:15], a[68:71], v[32:35]
    ds_read_b64 a[50:51], v10 offset:1544
    v_mfma_f32_16x16x32_f16 v[32:35], a[16:19], a[64:67], v[32:35]
    ds_read_b128 v[128:131], v9 offset:2048
    v_mfma_f32_16x16x32_f16 v[36:39], a[0:3], a[84:87], v[36:39]
    ds_read_b64 a[52:53], v10 offset:1024
    v_mfma_f32_16x16x32_f16 v[36:39], a[4:7], a[80:83], v[36:39]
    ds_read_b64 a[54:55], v10 offset:1032
    v_mfma_f32_16x16x32_f16 v[36:39], a[8:11], a[76:79], v[36:39]
    ds_read_b128 v[132:135], v9 offset:2560
    v_mfma_f32_16x16x32_f16 v[36:39], a[12:15], a[72:75], v[36:39]
    ds_read_b64 a[56:57], v10 offset:512
    v_mfma_f32_16x16x32_f16 v[36:39], a[16:19], a[68:71], v[36:39]
    ds_read_b64 a[58:59], v10 offset:520
    v_mfma_f32_16x16x32_f16 v[36:39], a[20:23], a[64:67], v[36:39]
    ds_read_b128 v[136:139], v9 offset:3072
    v_mfma_f32_16x16x32_f16 v[40:43], a[0:3], a[88:91], v[40:43]
    ds_read_b64 a[60:61], v10 offset:0
    v_mfma_f32_16x16x32_f16 v[40:43], a[4:7], a[84:87], v[40:43]
    ds_read_b64 a[62:63], v10 offset:8
    v_mfma_f32_16x16x32_f16 v[40:43], a[8:11], a[80:83], v[40:43]
    ds_read_b128 v[140:143], v9 offset:3584
    v_mfma_f32_16x16x32_f16 v[40:43], a[12:15], a[76:79], v[40:43]
    v_mfma_f32_16x16x32_f16 v[40:43], a[16:19], a[72:75], v[40:43]
    v_mfma_f32_16x16x32_f16 v[40:43], a[20:23], a[68:71], v[40:43]
    v_mfma_f32_16x16x32_f16 v[40:43], a[24:27], a[64:67], v[40:43]
    v_mfma_f32_16x16x32_f16 v[44:47], a[0:3], a[92:95], v[44:47]
    v_mfma_f32_16x16x32_f16 v[44:47], a[4:7], a[88:91], v[44:47]
    v_mfma_f32_16x16x32_f16 v[44:47], a[8:11], a[84:87], v[44:47]
    v_mfma_f32_16x16x32_f16 v[44:47], a[12:15], a[80:83], v[44:47]
    v_mfma_f32_16x16x32_f16 v[44:47], a[16:19], a[76:79], v[44:47]
    v_mfma_f32_16x16x32_f16 v[44:47], a[20:23], a[72:75], v[44:47]
    v_mfma_f32_16x16x32_f16 v[44:47], a[24:27], a[68:71], v[44:47]
    v_mfma_f32_16x16x32_f16 v[44:47], a[28:31], a[64:67], v[44:47]
    s_waitcnt lgkmcnt(0)
    v_mfma_f32_16x16x32_f16 v[16:19], a[32:35], v[112:115], v[16:19]
    ds_read_b64 a[0:1], v11 offset:3648
    v_mfma_f32_16x16x32_f16 v[20:23], a[32:35], v[116:119], v[20:23]
    ds_read_b64 a[2:3], v11 offset:3656
    v_mfma_f32_16x16x32_f16 v[20:23], a[36:39], v[112:115], v[20:23]
    ds_read_b128 a[64:67], v9 offset:4672
    v_mfma_f32_16x16x32_f16 v[24:27], a[32:35], v[120:123], v[24:27]
    ds_read_b64 a[4:5], v11 offset:3136
    v_mfma_f32_16x16x32_f16 v[24:27], a[36:39], v[116:119], v[24:27]
    ds_read_b64 a[6:7], v11 offset:3144
    v_mfma_f32_16x16x32_f16 v[24:27], a[40:43], v[112:115], v[24:27]
    ds_read_b128 a[68:71], v9 offset:5184
    v_mfma_f32_16x16x32_f16 v[28:31], a[32:35], v[124:127], v[28:31]
    ds_read_b64 a[8:9], v11 offset:2624
    v_mfma_f32_16x16x32_f16 v[28:31], a[36:39], v[120:123], v[28:31]
    ds_read_b64 a[10:11], v11 offset:2632
    v_mfma_f32_16x16x32_f16 v[28:31], a[40:43], v[116:119], v[28:31]
    ds_read_b128 a[72:75], v9 offset:5696
    v_mfma_f32_16x16x32_f16 v[28:31], a[44:47], v[112:115], v[28:31]
    ds_read_b64 a[12:13], v11 offset:2112
    v_mfma_f32_16x16x32_f16 v[32:35], a[32:35], v[128:131], v[32:35]
    ds_read_b64 a[14:15], v11 offset:2120
    v_mfma_f32_16x16x32_f16 v[32:35], a[36:39], v[124:127], v[32:35]
    ds_read_b128 a[76:79], v9 offset:6208
    v_mfma_f32_16x16x32_f16 v[32:35], a[40:43], v[120:123], v[32:35]
    ds_read_b64 a[16:17], v11 offset:1600
    v_mfma_f32_16x16x32_f16 v[32:35], a[44:47], v[116:119], v[32:35]
    ds_read_b64 a[18:19], v11 offset:1608
    v_mfma_f32_16x16x32_f16 v[32:35], a[48:51], v[112:115], v[32:35]
    ds_read_b128 a[80:83], v9 offset:6720
    v_mfma_f32_16x16x32_f16 v[36:39], a[32:35], v[132:135], v[36:39]
    ds_read_b64 a[20:21], v11 offset:1088
    v_mfma_f32_16x16x32_f16 v[36:39], a[36:39], v[128:131], v[36:39]
    ds_read_b64 a[22:23], v11 offset:1096
    v_mfma_f32_16x16x32_f16 v[36:39], a[40:43], v[124:127], v[36:39]
    ds_read_b128 a[84:87], v9 offset:7232
    v_mfma_f32_16x16x32_f16 v[36:39], a[44:47], v[120:123], v[36:39]
    ds_read_b64 a[24:25], v11 offset:576
    v_mfma_f32_16x16x32_f16 v[36:39], a[48:51], v[116:119], v[36:39]
    ds_read_b64 a[26:27], v11 offset:584
    v_mfma_f32_16x16x32_f16 v[36:39], a[52:55], v[112:115], v[36:39]
    ds_read_b128 a[88:91], v9 offset:7744
    v_mfma_f32_16x16x32_f16 v[40:43], a[32:35], v[136:139], v[40:43]
    ds_read_b64 a[28:29], v11 offset:64
    v_mfma_f32_16x16x32_f16 v[40:43], a[36:39], v[132:135], v[40:43]
    ds_read_b64 a[30:31], v11 offset:72
    v_mfma_f32_16x16x32_f16 v[40:43], a[40:43], v[128:131], v[40:43]
    ds_read_b128 a[92:95], v9 offset:8256
    v_mfma_f32_16x16x32_f16 v[40:43], a[44:47], v[124:127], v[40:43]
    v_mfma_f32_16x16x32_f16 v[40:43], a[48:51], v[120:123], v[40:43]
    v_mfma_f32_16x16x32_f16 v[40:43], a[52:55], v[116:119], v[40:43]
    v_mfma_f32_16x16x32_f16 v[40:43], a[56:59], v[112:115], v[40:43]
    v_mfma_f32_16x16x32_f16 v[44:47], a[32:35], v[140:143], v[44:47]
    v_mfma_f32_16x16x32_f16 v[44:47], a[36:39], v[136:139], v[44:47]
    v_mfma_f32_16x16x32_f16 v[44:47], a[40:43], v[132:135], v[44:47]
    v_mfma_f32_16x16x32_f16 v[44:47], a[44:47], v[128:131], v[44:47]
    v_mfma_f32_16x16x32_f16 v[44:47], a[48:51], v[124:127], v[44:47]
    v_mfma_f32_16x16x32_f16 v[44:47], a[52:55], v[120:123], v[44:47]
    v_mfma_f32_16x16x32_f16 v[44:47], a[56:59], v[116:119], v[44:47]
    v_mfma_f32_16x16x32_f16 v[44:47], a[60:63], v[112:115], v[44:47]
    s_waitcnt lgkmcnt(0)
    v_mfma_f32_16x16x32_f16 v[48:51], a[0:3], a[64:67], v[48:51]
    ds_read_b64 a[32:33], v11 offset:3584
    v_mfma_f32_16x16x32_f16 v[52:55], a[0:3], a[68:71], v[52:55]
    ds_read_b64 a[34:35], v11 offset:3592
    v_mfma_f32_16x16x32_f16 v[52:55], a[4:7], a[64:67], v[52:55]
    ds_read_b128 v[112:115], v9 offset:4608
    v_mfma_f32_16x16x32_f16 v[56:59], a[0:3], a[72:75], v[56:59]
    ds_read_b64 a[36:37], v11 offset:3072
    v_mfma_f32_16x16x32_f16 v[56:59], a[4:7], a[68:71], v[56:59]
    ds_read_b64 a[38:39], v11 offset:3080
    v_mfma_f32_16x16x32_f16 v[56:59], a[8:11], a[64:67], v[56:59]
    ds_read_b128 v[116:119], v9 offset:5120
    v_mfma_f32_16x16x32_f16 v[60:63], a[0:3], a[76:79], v[60:63]
    ds_read_b64 a[40:41], v11 offset:2560
    v_mfma_f32_16x16x32_f16 v[60:63], a[4:7], a[72:75], v[60:63]
    ds_read_b64 a[42:43], v11 offset:2568
    v_mfma_f32_16x16x32_f16 v[60:63], a[8:11], a[68:71], v[60:63]
    ds_read_b128 v[120:123], v9 offset:5632
    v_mfma_f32_16x16x32_f16 v[60:63], a[12:15], a[64:67], v[60:63]
    ds_read_b64 a[44:45], v11 offset:2048
    v_mfma_f32_16x16x32_f16 v[64:67], a[0:3], a[80:83], v[64:67]
    ds_read_b64 a[46:47], v11 offset:2056
    v_mfma_f32_16x16x32_f16 v[64:67], a[4:7], a[76:79], v[64:67]
    ds_read_b128 v[124:127], v9 offset:6144
    v_mfma_f32_16x16x32_f16 v[64:67], a[8:11], a[72:75], v[64:67]
    ds_read_b64 a[48:49], v11 offset:1536
    v_mfma_f32_16x16x32_f16 v[64:67], a[12:15], a[68:71], v[64:67]
    ds_read_b64 a[50:51], v11 offset:1544
    v_mfma_f32_16x16x32_f16 v[64:67], a[16:19], a[64:67], v[64:67]
    ds_read_b128 v[128:131], v9 offset:6656
    v_mfma_f32_16x16x32_f16 v[68:71], a[0:3], a[84:87], v[68:71]
    ds_read_b64 a[52:53], v11 offset:1024
    v_mfma_f32_16x16x32_f16 v[68:71], a[4:7], a[80:83], v[68:71]
    ds_read_b64 a[54:55], v11 offset:1032
    v_mfma_f32_16x16x32_f16 v[68:71], a[8:11], a[76:79], v[68:71]
    ds_read_b128 v[132:135], v9 offset:7168
    v_mfma_f32_16x16x32_f16 v[68:71], a[12:15], a[72:75], v[68:71]
    ds_read_b64 a[56:57], v11 offset:512
    v_mfma_f32_16x16x32_f16 v[68:71], a[16:19], a[68:71], v[68:71]
    ds_read_b64 a[58:59], v11 offset:520
    v_mfma_f32_16x16x32_f16 v[68:71], a[20:23], a[64:67], v[68:71]
    ds_read_b128 v[136:139], v9 offset:7680
    v_mfma_f32_16x16x32_f16 v[72:75], a[0:3], a[88:91], v[72:75]
    ds_read_b64 a[60:61], v11 offset:0
    v_mfma_f32_16x16x32_f16 v[72:75], a[4:7], a[84:87], v[72:75]
    ds_read_b64 a[62:63], v11 offset:8
    v_mfma_f32_16x16x32_f16 v[72:75], a[8:11], a[80:83], v[72:75]
    ds_read_b128 v[140:143], v9 offset:8192
    v_mfma_f32_16x16x32_f16 v[72:75], a[12:15], a[76:79], v[72:75]
    v_mfma_f32_16x16x32_f16 v[72:75], a[16:19], a[72:75], v[72:75]
    v_mfma_f32_16x16x32_f16 v[72:75], a[20:23], a[68:71], v[72:75]
    v_mfma_f32_16x16x32_f16 v[72:75], a[24:27], a[64:67], v[72:75]
    v_mfma_f32_16x16x32_f16 v[76:79], a[0:3], a[92:95], v[76:79]
    v_mfma_f32_16x16x32_f16 v[76:79], a[4:7], a[88:91], v[76:79]
    v_mfma_f32_16x16x32_f16 v[76:79], a[8:11], a[84:87], v[76:79]
    v_mfma_f32_16x16x32_f16 v[76:79], a[12:15], a[80:83], v[76:79]
    v_mfma_f32_16x16x32_f16 v[76:79], a[16:19], a[76:79], v[76:79]
    v_mfma_f32_16x16x32_f16 v[76:79], a[20:23], a[72:75], v[76:79]
    v_mfma_f32_16x16x32_f16 v[76:79], a[24:27], a[68:71], v[76:79]
    v_mfma_f32_16x16x32_f16 v[76:79], a[28:31], a[64:67], v[76:79]
    s_waitcnt lgkmcnt(0)
    v_mfma_f32_16x16x32_f16 v[48:51], a[32:35], v[112:115], v[48:51]
    ds_read_b64 a[0:1], v12 offset:3648
    v_mfma_f32_16x16x32_f16 v[52:55], a[32:35], v[116:119], v[52:55]
    ds_read_b64 a[2:3], v12 offset:3656
    v_mfma_f32_16x16x32_f16 v[52:55], a[36:39], v[112:115], v[52:55]
    ds_read_b128 a[64:67], v9 offset:9280
    v_mfma_f32_16x16x32_f16 v[56:59], a[32:35], v[120:123], v[56:59]
    ds_read_b64 a[4:5], v12 offset:3136
    v_mfma_f32_16x16x32_f16 v[56:59], a[36:39], v[116:119], v[56:59]
    ds_read_b64 a[6:7], v12 offset:3144
    v_mfma_f32_16x16x32_f16 v[56:59], a[40:43], v[112:115], v[56:59]
    ds_read_b128 a[68:71], v9 offset:9792
    v_mfma_f32_16x16x32_f16 v[60:63], a[32:35], v[124:127], v[60:63]
    ds_read_b64 a[8:9], v12 offset:2624
    v_mfma_f32_16x16x32_f16 v[60:63], a[36:39], v[120:123], v[60:63]
    ds_read_b64 a[10:11], v12 offset:2632
    v_mfma_f32_16x16x32_f16 v[60:63], a[40:43], v[116:119], v[60:63]
    ds_read_b128 a[72:75], v9 offset:10304
    v_mfma_f32_16x16x32_f16 v[60:63], a[44:47], v[112:115], v[60:63]
    ds_read_b64 a[12:13], v12 offset:2112
    v_mfma_f32_16x16x32_f16 v[64:67], a[32:35], v[128:131], v[64:67]
    ds_read_b64 a[14:15], v12 offset:2120
    v_mfma_f32_16x16x32_f16 v[64:67], a[36:39], v[124:127], v[64:67]
    ds_read_b128 a[76:79], v9 offset:10816
    v_mfma_f32_16x16x32_f16 v[64:67], a[40:43], v[120:123], v[64:67]
    ds_read_b64 a[16:17], v12 offset:1600
    v_mfma_f32_16x16x32_f16 v[64:67], a[44:47], v[116:119], v[64:67]
    ds_read_b64 a[18:19], v12 offset:1608
    v_mfma_f32_16x16x32_f16 v[64:67], a[48:51], v[112:115], v[64:67]
    ds_read_b128 a[80:83], v9 offset:11328
    v_mfma_f32_16x16x32_f16 v[68:71], a[32:35], v[132:135], v[68:71]
    ds_read_b64 a[20:21], v12 offset:1088
    v_mfma_f32_16x16x32_f16 v[68:71], a[36:39], v[128:131], v[68:71]
    ds_read_b64 a[22:23], v12 offset:1096
    v_mfma_f32_16x16x32_f16 v[68:71], a[40:43], v[124:127], v[68:71]
    ds_read_b128 a[84:87], v9 offset:11840
    v_mfma_f32_16x16x32_f16 v[68:71], a[44:47], v[120:123], v[68:71]
    ds_read_b64 a[24:25], v12 offset:576
    v_mfma_f32_16x16x32_f16 v[68:71], a[48:51], v[116:119], v[68:71]
    ds_read_b64 a[26:27], v12 offset:584
    v_mfma_f32_16x16x32_f16 v[68:71], a[52:55], v[112:115], v[68:71]
    ds_read_b128 a[88:91], v9 offset:12352
    v_mfma_f32_16x16x32_f16 v[72:75], a[32:35], v[136:139], v[72:75]
    ds_read_b64 a[28:29], v12 offset:64
    v_mfma_f32_16x16x32_f16 v[72:75], a[36:39], v[132:135], v[72:75]
    ds_read_b64 a[30:31], v12 offset:72
    v_mfma_f32_16x16x32_f16 v[72:75], a[40:43], v[128:131], v[72:75]
    ds_read_b128 a[92:95], v9 offset:12864
    v_mfma_f32_16x16x32_f16 v[72:75], a[44:47], v[124:127], v[72:75]
    v_mfma_f32_16x16x32_f16 v[72:75], a[48:51], v[120:123], v[72:75]
    v_mfma_f32_16x16x32_f16 v[72:75], a[52:55], v[116:119], v[72:75]
    v_mfma_f32_16x16x32_f16 v[72:75], a[56:59], v[112:115], v[72:75]
    v_mfma_f32_16x16x32_f16 v[76:79], a[32:35], v[140:143], v[76:79]
    v_mfma_f32_16x16x32_f16 v[76:79], a[36:39], v[136:139], v[76:79]
    v_mfma_f32_16x16x32_f16 v[76:79], a[40:43], v[132:135], v[76:79]
    v_mfma_f32_16x16x32_f16 v[76:79], a[44:47], v[128:131], v[76:79]
    v_mfma_f32_16x16x32_f16 v[76:79], a[48:51], v[124:127], v[76:79]
    v_mfma_f32_16x16x32_f16 v[76:79], a[52:55], v[120:123], v[76:79]
    v_mfma_f32_16x16x32_f16 v[76:79], a[56:59], v[116:119], v[76:79]
    v_mfma_f32_16x16x32_f16 v[76:79], a[60:63], v[112:115], v[76:79]
    s_waitcnt lgkmcnt(0)
    v_mfma_f32_16x16x32_f16 v[80:83], a[0:3], a[64:67], v[80:83]
    ds_read_b64 a[32:33], v12 offset:3584
    v_mfma_f32_16x16x32_f16 v[84:87], a[0:3], a[68:71], v[84:87]
    ds_read_b64 a[34:35], v12 offset:3592
    v_mfma_f32_16x16x32_f16 v[84:87], a[4:7], a[64:67], v[84:87]
    ds_read_b128 v[112:115], v9 offset:9216
    v_mfma_f32_16x16x32_f16 v[88:91], a[0:3], a[72:75], v[88:91]
    ds_read_b64 a[36:37], v12 offset:3072
    v_mfma_f32_16x16x32_f16 v[88:91], a[4:7], a[68:71], v[88:91]
    ds_read_b64 a[38:39], v12 offset:3080
    v_mfma_f32_16x16x32_f16 v[88:91], a[8:11], a[64:67], v[88:91]
    ds_read_b128 v[116:119], v9 offset:9728
    v_mfma_f32_16x16x32_f16 v[92:95], a[0:3], a[76:79], v[92:95]
    ds_read_b64 a[40:41], v12 offset:2560
    v_mfma_f32_16x16x32_f16 v[92:95], a[4:7], a[72:75], v[92:95]
    ds_read_b64 a[42:43], v12 offset:2568
    v_mfma_f32_16x16x32_f16 v[92:95], a[8:11], a[68:71], v[92:95]
    ds_read_b128 v[120:123], v9 offset:10240
    v_mfma_f32_16x16x32_f16 v[92:95], a[12:15], a[64:67], v[92:95]
    ds_read_b64 a[44:45], v12 offset:2048
    v_mfma_f32_16x16x32_f16 v[96:99], a[0:3], a[80:83], v[96:99]
    ds_read_b64 a[46:47], v12 offset:2056
    v_mfma_f32_16x16x32_f16 v[96:99], a[4:7], a[76:79], v[96:99]
    ds_read_b128 v[124:127], v9 offset:10752
    v_mfma_f32_16x16x32_f16 v[96:99], a[8:11], a[72:75], v[96:99]
    ds_read_b64 a[48:49], v12 offset:1536
    v_mfma_f32_16x16x32_f16 v[96:99], a[12:15], a[68:71], v[96:99]
    ds_read_b64 a[50:51], v12 offset:1544
    v_mfma_f32_16x16x32_f16 v[96:99], a[16:19], a[64:67], v[96:99]
    ds_read_b128 v[128:131], v9 offset:11264
    v_mfma_f32_16x16x32_f16 v[100:103], a[0:3], a[84:87], v[100:103]
    ds_read_b64 a[52:53], v12 offset:1024
    v_mfma_f32_16x16x32_f16 v[100:103], a[4:7], a[80:83], v[100:103]
    ds_read_b64 a[54:55], v12 offset:1032
    v_mfma_f32_16x16x32_f16 v[100:103], a[8:11], a[76:79], v[100:103]
    ds_read_b128 v[132:135], v9 offset:11776
    v_mfma_f32_16x16x32_f16 v[100:103], a[12:15], a[72:75], v[100:103]
    ds_read_b64 a[56:57], v12 offset:512
    v_mfma_f32_16x16x32_f16 v[100:103], a[16:19], a[68:71], v[100:103]
    ds_read_b64 a[58:59], v12 offset:520
    v_mfma_f32_16x16x32_f16 v[100:103], a[20:23], a[64:67], v[100:103]
    ds_read_b128 v[136:139], v9 offset:12288
    v_mfma_f32_16x16x32_f16 v[104:107], a[0:3], a[88:91], v[104:107]
    ds_read_b64 a[60:61], v12 offset:0
    v_mfma_f32_16x16x32_f16 v[104:107], a[4:7], a[84:87], v[104:107]
    ds_read_b64 a[62:63], v12 offset:8
    v_mfma_f32_16x16x32_f16 v[104:107], a[8:11], a[80:83], v[104:107]
    ds_read_b128 v[140:143], v9 offset:12800
    v_mfma_f32_16x16x32_f16 v[104:107], a[12:15], a[76:79], v[104:107]
    v_mfma_f32_16x16x32_f16 v[104:107], a[16:19], a[72:75], v[104:107]
    v_mfma_f32_16x16x32_f16 v[104:107], a[20:23], a[68:71], v[104:107]
    v_mfma_f32_16x16x32_f16 v[104:107], a[24:27], a[64:67], v[104:107]
    v_mfma_f32_16x16x32_f16 v[108:111], a[0:3], a[92:95], v[108:111]
    v_mfma_f32_16x16x32_f16 v[108:111], a[4:7], a[88:91], v[108:111]
    v_mfma_f32_16x16x32_f16 v[108:111], a[8:11], a[84:87], v[108:111]
    v_mfma_f32_16x16x32_f16 v[108:111], a[12:15], a[80:83], v[108:111]
    v_mfma_f32_16x16x32_f16 v[108:111], a[16:19], a[76:79], v[108:111]
    v_mfma_f32_16x16x32_f16 v[108:111], a[20:23], a[72:75], v[108:111]
    v_mfma_f32_16x16x32_f16 v[108:111], a[24:27], a[68:71], v[108:111]
    v_mfma_f32_16x16x32_f16 v[108:111], a[28:31], a[64:67], v[108:111]
    s_waitcnt lgkmcnt(0)
    v_mfma_f32_16x16x32_f16 v[80:83], a[32:35], v[112:115], v[80:83]
    v_mfma_f32_16x16x32_f16 v[84:87], a[32:35], v[116:119], v[84:87]
    v_mfma_f32_16x16x32_f16 v[84:87], a[36:39], v[112:115], v[84:87]
    v_mfma_f32_16x16x32_f16 v[88:91], a[32:35], v[120:123], v[88:91]
    v_mfma_f32_16x16x32_f16 v[88:91], a[36:39], v[116:119], v[88:91]
    v_mfma_f32_16x16x32_f16 v[88:91], a[40:43], v[112:115], v[88:91]
    v_mfma_f32_16x16x32_f16 v[92:95], a[32:35], v[124:127], v[92:95]
    v_mfma_f32_16x16x32_f16 v[92:95], a[36:39], v[120:123], v[92:95]
    v_mfma_f32_16x16x32_f16 v[92:95], a[40:43], v[116:119], v[92:95]
    v_mfma_f32_16x16x32_f16 v[92:95], a[44:47], v[112:115], v[92:95]
    v_mfma_f32_16x16x32_f16 v[96:99], a[32:35], v[128:131], v[96:99]
    v_mfma_f32_16x16x32_f16 v[96:99], a[36:39], v[124:127], v[96:99]
    v_mfma_f32_16x16x32_f16 v[96:99], a[40:43], v[120:123], v[96:99]
    v_mfma_f32_16x16x32_f16 v[96:99], a[44:47], v[116:119], v[96:99]
    v_mfma_f32_16x16x32_f16 v[96:99], a[48:51], v[112:115], v[96:99]
    v_mfma_f32_16x16x32_f16 v[100:103], a[32:35], v[132:135], v[100:103]
    v_mfma_f32_16x16x32_f16 v[100:103], a[36:39], v[128:131], v[100:103]
    v_mfma_f32_16x16x32_f16 v[100:103], a[40:43], v[124:127], v[100:103]
    v_mfma_f32_16x16x32_f16 v[100:103], a[44:47], v[120:123], v[100:103]
    v_mfma_f32_16x16x32_f16 v[100:103], a[48:51], v[116:119], v[100:103]
    v_mfma_f32_16x16x32_f16 v[100:103], a[52:55], v[112:115], v[100:103]
    v_mfma_f32_16x16x32_f16 v[104:107], a[32:35], v[136:139], v[104:107]
    v_mfma_f32_16x16x32_f16 v[104:107], a[36:39], v[132:135], v[104:107]
    v_mfma_f32_16x16x32_f16 v[104:107], a[40:43], v[128:131], v[104:107]
    v_mfma_f32_16x16x32_f16 v[104:107], a[44:47], v[124:127], v[104:107]
    v_mfma_f32_16x16x32_f16 v[104:107], a[48:51], v[120:123], v[104:107]
    v_mfma_f32_16x16x32_f16 v[104:107], a[52:55], v[116:119], v[104:107]
    v_mfma_f32_16x16x32_f16 v[104:107], a[56:59], v[112:115], v[104:107]
    v_mfma_f32_16x16x32_f16 v[108:111], a[32:35], v[140:143], v[108:111]
    v_mfma_f32_16x16x32_f16 v[108:111], a[36:39], v[136:139], v[108:111]
    v_mfma_f32_16x16x32_f16 v[108:111], a[40:43], v[132:135], v[108:111]
    v_mfma_f32_16x16x32_f16 v[108:111], a[44:47], v[128:131], v[108:111]
    v_mfma_f32_16x16x32_f16 v[108:111], a[48:51], v[124:127], v[108:111]
    v_mfma_f32_16x16x32_f16 v[108:111], a[52:55], v[120:123], v[108:111]
    v_mfma_f32_16x16x32_f16 v[108:111], a[56:59], v[116:119], v[108:111]
    v_mfma_f32_16x16x32_f16 v[108:111], a[60:63], v[112:115], v[108:111]
    s_nop 7
    s_nop 7
L_kA_main_done:
    s_barrier
    s_cmp_ge_u32 s3, 4
    s_cbranch_scc1 L_kA_red_done
    v_lshlrev_b32 v3, 4, v2
    s_lshl_b32 s62, s3, 13
    v_add_u32 v4, s62, v3
    v_add_u32 v5, 0x10000, v4

    ds_write_b128 v4, v[16:19] offset:0
    ds_write_b128 v4, v[20:23] offset:1024
    ds_write_b128 v4, v[24:27] offset:2048
    ds_write_b128 v4, v[28:31] offset:3072
    ds_write_b128 v4, v[32:35] offset:4096
    ds_write_b128 v4, v[36:39] offset:5120
    ds_write_b128 v4, v[40:43] offset:6144
    ds_write_b128 v4, v[44:47] offset:7168
    ds_write_b128 v4, v[48:51] offset:32768
    ds_write_b128 v4, v[52:55] offset:33792
    ds_write_b128 v4, v[56:59] offset:34816
    ds_write_b128 v4, v[60:63] offset:35840
    ds_write_b128 v4, v[64:67] offset:36864
    ds_write_b128 v4, v[68:71] offset:37888
    ds_write_b128 v4, v[72:75] offset:38912
    ds_write_b128 v4, v[76:79] offset:39936
    ds_write_b128 v5, v[80:83] offset:0
    ds_write_b128 v5, v[84:87] offset:1024
    ds_write_b128 v5, v[88:91] offset:2048
    ds_write_b128 v5, v[92:95] offset:3072
    ds_write_b128 v5, v[96:99] offset:4096
    ds_write_b128 v5, v[100:103] offset:5120
    ds_write_b128 v5, v[104:107] offset:6144
    ds_write_b128 v5, v[108:111] offset:7168
L_kA_red_done:
    v_lshlrev_b32 v3, 4, v2
    s_lshl_b32 s62, s3, 10
    v_add_u32 v4, s62, v3
    v_add_u32 v5, 0x10000, v4
    v_and_b32 v6, 15, v2
    v_lshrrev_b32 v7, 4, v2
    v_lshlrev_b32 v8, 4, v6
    v_lshlrev_b32 v9, 2, v7
    v_add_u32 v8, v8, v9
    s_lshl_b32 s62, s3, 8
    v_add_u32 v8, s62, v8
    v_lshlrev_b32 v8, 1, v8
    v_add_u32 v9, 115536, v8
    v_lshrrev_b32 v11, 1, v6
    v_lshlrev_b32 v11, 2, v11
    v_add_u32 v11, v11, v7
    v_lshlrev_b32 v11, 4, v11
    v_and_b32 v12, 1, v6
    v_lshlrev_b32 v12, 3, v12
    v_add_u32 v11, v11, v12
    s_lshl_b32 s63, s3, 10
    v_add_u32 v11, s63, v11
    v_lshrrev_b32 v10, 5, v2
    v_mul_u32_u24 v10, 4224, v10
    v_and_b32 v14, 31, v2
    v_lshlrev_b32 v14, 4, v14
    v_add_u32 v10, v10, v14
    s_mul_i32 s63, s51, 4224
    s_lshl_b32 s64, s3, 9
    s_add_u32 s63, s63, s64
    s_add_u32 s63, s63, 4194304
    v_mov_b32 v12, 114960

    ds_read_b64 v[112:113], v9 offset:0
    ds_read_b64 v[124:125], v12 offset:0
    ds_read_b64 v[114:115], v9 offset:4608
    ds_read_b64 v[126:127], v12 offset:8
    ds_read_b64 v[116:117], v9 offset:9216
    ds_read_b64 v[128:129], v12 offset:16
    ds_read_b32 v130, v12 offset:24
    s_lshr_b32 s64, s19, 4
    s_add_u32 s64, s64, 0
    s_lshl_b32 s64, s64, 4
    s_lshr_b64 s[64:65], s[54:55], s64
    s_lshl_b32 s56, s64, 16

    s_lshr_b32 s64, s19, 4
    s_add_u32 s64, s64, 1
    s_lshl_b32 s64, s64, 4
    s_lshr_b64 s[64:65], s[54:55], s64
    s_lshl_b32 s57, s64, 16

    s_lshr_b32 s64, s19, 4
    s_add_u32 s64, s64, 2
    s_lshl_b32 s64, s64, 4
    s_lshr_b64 s[64:65], s[54:55], s64
    s_lshl_b32 s58, s64, 16

    s_waitcnt lgkmcnt(0)
    s_barrier
    ds_read_b128 v[16:19], v4 offset:0
    ds_read_b128 v[20:23], v4 offset:8192
    ds_read_b128 v[24:27], v4 offset:16384
    ds_read_b128 v[28:31], v4 offset:24576
    ds_read_b128 v[32:35], v4 offset:32768
    ds_read_b128 v[36:39], v4 offset:40960
    ds_read_b128 v[40:43], v4 offset:49152
    ds_read_b128 v[44:47], v4 offset:57344
    ds_read_b128 v[48:51], v5 offset:0
    ds_read_b128 v[52:55], v5 offset:8192
    ds_read_b128 v[56:59], v5 offset:16384
    ds_read_b128 v[60:63], v5 offset:24576
    v_readfirstlane_b32 s28, v130
    v_max_i32 v124, v124, v125
    v_cvt_f32_f16 v132, v112
    v_mul_f32 v132, s56, v132
    v_cvt_f32_f16_sdwa v133, v112 dst_sel:DWORD dst_unused:UNUSED_PAD src0_sel:WORD_1
    v_mul_f32 v133, s56, v133
    v_cvt_f32_f16 v134, v113
    v_mul_f32 v134, s56, v134
    v_cvt_f32_f16_sdwa v135, v113 dst_sel:DWORD dst_unused:UNUSED_PAD src0_sel:WORD_1
    v_mul_f32 v135, s56, v135
    v_cvt_pk_bf16_f32 v82, v132, v133
    v_lshlrev_b32 v132, 16, v82
    v_and_b32 v133, 0xffff0000, v82
    v_cvt_pk_bf16_f32 v82, v134, v135
    v_lshlrev_b32 v134, 16, v82
    v_and_b32 v135, 0xffff0000, v82
    v_max_i32 v126, v126, v127
    v_cvt_f32_f16 v136, v114
    v_mul_f32 v136, s57, v136
    v_cvt_f32_f16_sdwa v137, v114 dst_sel:DWORD dst_unused:UNUSED_PAD src0_sel:WORD_1
    v_mul_f32 v137, s57, v137
    v_cvt_f32_f16 v138, v115
    v_mul_f32 v138, s57, v138
    v_cvt_f32_f16_sdwa v139, v115 dst_sel:DWORD dst_unused:UNUSED_PAD src0_sel:WORD_1
    v_mul_f32 v139, s57, v139
    v_cvt_pk_bf16_f32 v82, v136, v137
    v_lshlrev_b32 v136, 16, v82
    v_and_b32 v137, 0xffff0000, v82
    v_cvt_pk_bf16_f32 v82, v138, v139
    v_lshlrev_b32 v138, 16, v82
    v_and_b32 v139, 0xffff0000, v82
    v_max_i32 v128, v128, v129
    v_cvt_f32_f16 v140, v116
    v_mul_f32 v140, s58, v140
    v_cvt_f32_f16_sdwa v141, v116 dst_sel:DWORD dst_unused:UNUSED_PAD src0_sel:WORD_1
    v_mul_f32 v141, s58, v141
    v_cvt_f32_f16 v142, v117
    v_mul_f32 v142, s58, v142
    v_cvt_f32_f16_sdwa v143, v117 dst_sel:DWORD dst_unused:UNUSED_PAD src0_sel:WORD_1
    v_mul_f32 v143, s58, v143
    v_cvt_pk_bf16_f32 v82, v140, v141
    v_lshlrev_b32 v140, 16, v82
    v_and_b32 v141, 0xffff0000, v82
    v_cvt_pk_bf16_f32 v82, v142, v143
    v_lshlrev_b32 v142, 16, v82
    v_and_b32 v143, 0xffff0000, v82
    s_waitcnt lgkmcnt(8)
    v_add_f32 v16, v16, v20
    v_add_f32 v24, v24, v28
    v_add_f32 v17, v17, v21
    v_add_f32 v25, v25, v29
    v_add_f32 v18, v18, v22
    v_add_f32 v26, v26, v30
    v_add_f32 v19, v19, v23
    v_add_f32 v27, v27, v31
    v_add_f32 v16, v16, v24
    v_add_f32 v17, v17, v25
    v_add_f32 v18, v18, v26
    v_add_f32 v19, v19, v27
    v_ldexp_f32 v16, v16, v124
    v_ldexp_f32 v17, v17, v124
    v_ldexp_f32 v18, v18, v124
    v_ldexp_f32 v19, v19, v124
    v_cvt_pk_bf16_f32 v82, v16, v17
    v_lshlrev_b32 v16, 16, v82
    v_and_b32 v17, 0xffff0000, v82
    v_cvt_pk_bf16_f32 v82, v18, v19
    v_lshlrev_b32 v18, 16, v82
    v_and_b32 v19, 0xffff0000, v82
    v_add_f32 v16, v132, v16
    v_add_f32 v17, v133, v17
    v_add_f32 v18, v134, v18
    v_add_f32 v19, v135, v19
    v_cvt_pk_bf16_f32 v84, v16, v17
    v_cvt_pk_bf16_f32 v85, v18, v19
    s_waitcnt lgkmcnt(4)
    v_add_f32 v32, v32, v36
    v_add_f32 v40, v40, v44
    v_add_f32 v33, v33, v37
    v_add_f32 v41, v41, v45
    v_add_f32 v34, v34, v38
    v_add_f32 v42, v42, v46
    v_add_f32 v35, v35, v39
    v_add_f32 v43, v43, v47
    v_add_f32 v32, v32, v40
    v_add_f32 v33, v33, v41
    v_add_f32 v34, v34, v42
    v_add_f32 v35, v35, v43
    v_ldexp_f32 v32, v32, v126
    v_ldexp_f32 v33, v33, v126
    v_ldexp_f32 v34, v34, v126
    v_ldexp_f32 v35, v35, v126
    v_cvt_pk_bf16_f32 v82, v32, v33
    v_lshlrev_b32 v32, 16, v82
    v_and_b32 v33, 0xffff0000, v82
    v_cvt_pk_bf16_f32 v82, v34, v35
    v_lshlrev_b32 v34, 16, v82
    v_and_b32 v35, 0xffff0000, v82
    v_add_f32 v32, v136, v32
    v_add_f32 v33, v137, v33
    v_add_f32 v34, v138, v34
    v_add_f32 v35, v139, v35
    v_cvt_pk_bf16_f32 v86, v32, v33
    v_cvt_pk_bf16_f32 v87, v34, v35
    s_waitcnt lgkmcnt(0)
    v_add_f32 v48, v48, v52
    v_add_f32 v56, v56, v60
    v_add_f32 v49, v49, v53
    v_add_f32 v57, v57, v61
    v_add_f32 v50, v50, v54
    v_add_f32 v58, v58, v62
    v_add_f32 v51, v51, v55
    v_add_f32 v59, v59, v63
    v_add_f32 v48, v48, v56
    v_add_f32 v49, v49, v57
    v_add_f32 v50, v50, v58
    v_add_f32 v51, v51, v59
    v_ldexp_f32 v48, v48, v128
    v_ldexp_f32 v49, v49, v128
    v_ldexp_f32 v50, v50, v128
    v_ldexp_f32 v51, v51, v128
    v_cvt_pk_bf16_f32 v82, v48, v49
    v_lshlrev_b32 v48, 16, v82
    v_and_b32 v49, 0xffff0000, v82
    v_cvt_pk_bf16_f32 v82, v50, v51
    v_lshlrev_b32 v50, 16, v82
    v_and_b32 v51, 0xffff0000, v82
    v_add_f32 v48, v140, v48
    v_add_f32 v49, v141, v49
    v_add_f32 v50, v142, v50
    v_add_f32 v51, v143, v51
    v_cvt_pk_bf16_f32 v88, v48, v49
    v_cvt_pk_bf16_f32 v89, v50, v51
    ds_write_b64 v11, v[84:85] offset:0
    ds_write_b64 v11, v[86:87] offset:512
    ds_write_b64 v11, v[88:89] offset:8192
    ds_read_b128 v[92:95], v4
    ds_read_b128 v[96:99], v4 offset:8192
    s_add_u32 s64, s63, 8448
    s_waitcnt lgkmcnt(1)
    buffer_store_dwordx4 v[92:95], v10, s[24:27], s63 offen sc1
    s_mov_b32 exec_hi, 0
    s_waitcnt lgkmcnt(0)
    buffer_store_dwordx4 v[96:99], v10, s[24:27], s64 offen sc1
    s_mov_b32 exec_hi, -1
    s_barrier

    s_branch L_kA_end
L_kA_extra0:
    s_cmp_lt_u32 s3, 4
    s_cbranch_scc1 L_kA_nocpf
    s_getpc_b64 s[72:73]
L_cpc_2:
    s_sub_u32 s72, s72, L_cpc_2-sequential_preLN__ssm_conv_s4d__mixer_token_mlp__prompt_kernel
    s_subb_u32 s73, s73, 0
    s_and_b32 s73, s73, 0xffff
    s_mov_b32 s74, L_all_end-sequential_preLN__ssm_conv_s4d__mixer_token_mlp__prompt_kernel
    s_mov_b32 s75, 0x00020000
    s_lshr_b32 s64, s2, 3
    s_sub_u32 s64, s64, 24
    s_lshl_b32 s64, s64, 1
    s_add_u32 s64, s64, s3
    s_sub_u32 s64, s64, 4
    s_lshl_b32 s64, s64, 13
    v_lshlrev_b32 v5, 7, v2
    buffer_load_dword v159, v5, s[72:75], s64 offen

L_kA_nocpf:
    s_barrier
    v_mov_b32 v121, 114984
    s_mov_b32 s77, 0
L_kA_exnw:
    ds_read_b32 v6, v121
    s_add_u32 s77, s77, 1
    s_waitcnt lgkmcnt(0)
    v_readfirstlane_b32 s28, v6
    s_cmp_gt_u32 s77, 100000
    s_cbranch_scc1 L_kA_exnw_ok
    s_cmp_lg_u32 s28, 0
    s_cbranch_scc0 L_kA_exnw

L_kA_exnw_ok:
L_kA_extraY:
    s_barrier
    s_cmp_ge_u32 s3, 4
    s_cbranch_scc1 L_kA_extra3
    s_mov_b32 s72, s60
    s_and_b32 s73, s61, 0xffff
    s_mov_b32 s74, 18874368
    s_mov_b32 s75, 0x00020000
    s_and_b32 s64, s2, 7
    s_lshr_b32 s65, s2, 3
    s_sub_u32 s65, s65, 24
    s_lshl_b32 s66, s3, 3
    s_add_u32 s66, s66, s65

    s_lshr_b32 s67, s66, 1
    s_lshr_b32 s65, s64, 2
    s_lshl_b32 s65, s65, 4
    s_add_u32 s67, s67, s65
    s_mul_i32 s67, s67, 589824
    s_and_b32 s64, s64, 3
    s_mul_i32 s64, s64, 2304
    s_add_u32 s67, s67, s64
    s_and_b32 s66, s66, 1
    s_mul_i32 s66, s66, 1152
    s_add_u32 s67, s67, s66
    v_mul_u32_u24 v5, 9216, v2

    buffer_load_dword v159, v5, s[72:75], s67 offen offset:0
    buffer_load_dword v159, v5, s[72:75], s67 offen offset:128
    buffer_load_dword v159, v5, s[72:75], s67 offen offset:256
    buffer_load_dword v159, v5, s[72:75], s67 offen offset:384
    buffer_load_dword v159, v5, s[72:75], s67 offen offset:512
    buffer_load_dword v159, v5, s[72:75], s67 offen offset:640
    buffer_load_dword v159, v5, s[72:75], s67 offen offset:768
    buffer_load_dword v159, v5, s[72:75], s67 offen offset:896
    buffer_load_dword v159, v5, s[72:75], s67 offen offset:1024
    s_mov_b32 s72, s60
    s_and_b32 s73, s61, 0xffff
    s_mov_b32 s74, 18874368
    s_mov_b32 s75, 0x00020000
    s_mov_b32 s32, s56
    s_and_b32 s33, s57, 0xffff
    s_mov_b32 s34, 18874368
    s_mov_b32 s35, 0x00020000
    s_sub_u32 s76, s2, 192
    s_lshl_b32 s76, s76, 8
    v_add_u32 v40, s76, v0
    v_lshlrev_b32 v40, 4, v40

    s_waitcnt vmcnt(0)
L_kA_extra3:
L_kA_end:
    s_load_dwordx4 s[48:51], s[0:1], 64
    s_load_dwordx4 s[52:55], s[0:1], 80
    s_load_dwordx2 s[56:57], s[0:1], 96

    s_cmp_ge_u32 s2, 128
    s_cbranch_scc1 L_mlp
    s_and_b32 s17, s2, 7
    s_lshl_b32 s17, s17, 4
    s_lshr_b32 s15, s2, 3
    s_add_u32 s17, s17, s15
    s_lshl_b32 s17, s17, 1
    v_lshrrev_b32 v1, 1, v0
    v_and_b32 v11, 1, v0
    v_mul_u32_u24 v5, 4224, v1
    v_lshl_add_u32 v5, v11, 4, v5
    v_lshlrev_b32 v4, 4, v0
    s_lshl_b32 s5, s17, 4
    s_add_u32 s5, s5, 4194304
    s_add_u32 s6, s5, 1081344
    s_add_u32 s7, s5, 2162688
    s_mov_b32 s8, 0x7f817f81
    v_cmp_gt_u32 s[46:47], 64, v1
    v_mul_u32_u24 v7, 36, v1
    v_lshl_add_u32 v7, v11, 4, v7
    v_add_u32 v7, 140368, v7

    ds_read2_b32 v[60:61], v7 offset0:0 offset1:1
    ds_read2_b32 v[62:63], v7 offset0:2 offset1:3
    v_add_u32 v7, 9216, v7
    ds_read2_b32 v[64:65], v7 offset0:0 offset1:1
    ds_read2_b32 v[66:67], v7 offset0:2 offset1:3
    s_cmp_lt_u32 s3, 2
    s_cbranch_scc0 L_b_nx3
    v_add_u32 v7, 9216, v7
    ds_read2_b32 v[68:69], v7 offset0:0 offset1:1
    ds_read2_b32 v[70:71], v7 offset0:2 offset1:3
L_b_nx3:
    v_lshlrev_b32 v6, 3, v2
    s_lshl_b32 s4, s3, 9
    v_add_u32 v6, s4, v6
    v_and_b32 v8, 15, v2
    v_lshlrev_b32 v10, 2, v8
    v_lshlrev_b32 v8, 3, v8
    s_lshl_b32 s4, s3, 7
    v_add_u32 v9, s4, v8
    v_add_u32 v9, 148480, v9
    v_add_u32 v8, 148480, v8
    v_add_u32 v10, s4, v10
    v_add_u32 v10, 149504, v10
    v_lshlrev_b32 v24, 5, v11
    v_add_u32 v24, s4, v24
    v_add_u32 v24, 149504, v24
    v_lshlrev_b32 v3, 4, v1
    v_mul_u32_u24 v11, 9216, v11
    v_add_u32 v3, v3, v11
    v_mov_b32 v25, 0x3f803f80

    s_waitcnt lgkmcnt(0)
    v_lshlrev_b32 v72, 16, v60
    v_and_b32 v73, 0xffff0000, v60
    v_lshlrev_b32 v74, 16, v61
    v_and_b32 v75, 0xffff0000, v61
    v_lshlrev_b32 v76, 16, v62
    v_and_b32 v77, 0xffff0000, v62
    v_lshlrev_b32 v78, 16, v63
    v_and_b32 v79, 0xffff0000, v63
    v_lshlrev_b32 v80, 16, v64
    v_and_b32 v81, 0xffff0000, v64
    v_lshlrev_b32 v82, 16, v65
    v_and_b32 v83, 0xffff0000, v65
    v_lshlrev_b32 v84, 16, v66
    v_and_b32 v85, 0xffff0000, v66
    v_lshlrev_b32 v86, 16, v67
    v_and_b32 v87, 0xffff0000, v67
    v_lshlrev_b32 v88, 16, v68
    v_and_b32 v89, 0xffff0000, v68
    v_lshlrev_b32 v90, 16, v69
    v_and_b32 v91, 0xffff0000, v69
    v_lshlrev_b32 v92, 16, v70
    v_and_b32 v93, 0xffff0000, v70
    v_lshlrev_b32 v94, 16, v71
    v_and_b32 v95, 0xffff0000, v71
    s_mov_b32 s60, s48
    s_and_b32 s61, s49, 0xffff
    s_mov_b32 s62, 18874368
    s_mov_b32 s63, 0x00020000
    s_mov_b32 s64, 0
    s_mov_b32 s65, 0
    s_cmp_lt_u32 s3, 4
    s_cbranch_scc1 L_b_pre_end
    s_and_b32 s58, s3, 1
    s_mul_i32 s58, s58, 576
    s_cmp_ge_u32 s3, 6
    s_cbranch_scc1 L_b_pre_o
    s_mov_b32 s59, 29826162

    s_add_u32 s66, s58, 0
    v_add_u32 v96, s66, v2
    v_mul_hi_u32 v97, v96, s59
    v_mul_u32_u24 v98, 144, v97
    v_sub_u32 v98, v96, v98
    v_mul_u32_u24 v97, 9216, v97
    v_lshlrev_b32 v98, 4, v98
    v_add_u32 v146, v97, v98

    s_add_u32 s66, s58, 64
    v_add_u32 v96, s66, v2
    v_mul_hi_u32 v97, v96, s59
    v_mul_u32_u24 v98, 144, v97
    v_sub_u32 v98, v96, v98
    v_mul_u32_u24 v97, 9216, v97
    v_lshlrev_b32 v98, 4, v98
    v_add_u32 v147, v97, v98

    s_add_u32 s66, s58, 128
    v_add_u32 v96, s66, v2
    v_mul_hi_u32 v97, v96, s59
    v_mul_u32_u24 v98, 144, v97
    v_sub_u32 v98, v96, v98
    v_mul_u32_u24 v97, 9216, v97
    v_lshlrev_b32 v98, 4, v98
    v_add_u32 v148, v97, v98

    s_add_u32 s66, s58, 192
    v_add_u32 v96, s66, v2
    v_mul_hi_u32 v97, v96, s59
    v_mul_u32_u24 v98, 144, v97
    v_sub_u32 v98, v96, v98
    v_mul_u32_u24 v97, 9216, v97
    v_lshlrev_b32 v98, 4, v98
    v_add_u32 v149, v97, v98

    s_add_u32 s66, s58, 256
    v_add_u32 v96, s66, v2
    v_mul_hi_u32 v97, v96, s59
    v_mul_u32_u24 v98, 144, v97
    v_sub_u32 v98, v96, v98
    v_mul_u32_u24 v97, 9216, v97
    v_lshlrev_b32 v98, 4, v98
    v_add_u32 v150, v97, v98

    s_add_u32 s66, s58, 320
    v_add_u32 v96, s66, v2
    v_mul_hi_u32 v97, v96, s59
    v_mul_u32_u24 v98, 144, v97
    v_sub_u32 v98, v96, v98
    v_mul_u32_u24 v97, 9216, v97
    v_lshlrev_b32 v98, 4, v98
    v_add_u32 v151, v97, v98

    s_add_u32 s66, s58, 384
    v_add_u32 v96, s66, v2
    v_mul_hi_u32 v97, v96, s59
    v_mul_u32_u24 v98, 144, v97
    v_sub_u32 v98, v96, v98
    v_mul_u32_u24 v97, 9216, v97
    v_lshlrev_b32 v98, 4, v98
    v_add_u32 v152, v97, v98

    s_add_u32 s66, s58, 448
    v_add_u32 v96, s66, v2
    v_mul_hi_u32 v97, v96, s59
    v_mul_u32_u24 v98, 144, v97
    v_sub_u32 v98, v96, v98
    v_mul_u32_u24 v97, 9216, v97
    v_lshlrev_b32 v98, 4, v98
    v_add_u32 v153, v97, v98

    s_add_u32 s66, s58, 512
    v_add_u32 v96, s66, v2
    v_mul_hi_u32 v97, v96, s59
    v_mul_u32_u24 v98, 144, v97
    v_sub_u32 v98, v96, v98
    v_mul_u32_u24 v97, 9216, v97
    v_lshlrev_b32 v98, 4, v98
    v_add_u32 v154, v97, v98

    s_branch L_b_pre_end
L_b_pre_o:
    s_mov_b32 s59, 238609295
    s_add_u32 s66, s58, 0
    v_add_u32 v96, s66, v2
    v_mul_hi_u32 v97, v96, s59
    v_mul_u32_u24 v98, 18, v97
    v_sub_u32 v98, v96, v98
    v_mul_u32_u24 v97, 9216, v97
    v_lshlrev_b32 v98, 4, v98
    v_add_u32 v146, v97, v98

    s_add_u32 s66, s58, 64
    v_add_u32 v96, s66, v2
    v_mul_hi_u32 v97, v96, s59
    v_mul_u32_u24 v98, 18, v97
    v_sub_u32 v98, v96, v98
    v_mul_u32_u24 v97, 9216, v97
    v_lshlrev_b32 v98, 4, v98
    v_add_u32 v147, v97, v98

    s_add_u32 s66, s58, 128
    v_add_u32 v96, s66, v2
    v_mul_hi_u32 v97, v96, s59
    v_mul_u32_u24 v98, 18, v97
    v_sub_u32 v98, v96, v98
    v_mul_u32_u24 v97, 9216, v97
    v_lshlrev_b32 v98, 4, v98
    v_add_u32 v148, v97, v98

    s_add_u32 s66, s58, 192
    v_add_u32 v96, s66, v2
    v_mul_hi_u32 v97, v96, s59
    v_mul_u32_u24 v98, 18, v97
    v_sub_u32 v98, v96, v98
    v_mul_u32_u24 v97, 9216, v97
    v_lshlrev_b32 v98, 4, v98
    v_add_u32 v149, v97, v98

    s_add_u32 s66, s58, 256
    v_add_u32 v96, s66, v2
    v_mul_hi_u32 v97, v96, s59
    v_mul_u32_u24 v98, 18, v97
    v_sub_u32 v98, v96, v98
    v_mul_u32_u24 v97, 9216, v97
    v_lshlrev_b32 v98, 4, v98
    v_add_u32 v150, v97, v98

    s_add_u32 s66, s58, 320
    v_add_u32 v96, s66, v2
    v_mul_hi_u32 v97, v96, s59
    v_mul_u32_u24 v98, 18, v97
    v_sub_u32 v98, v96, v98
    v_mul_u32_u24 v97, 9216, v97
    v_lshlrev_b32 v98, 4, v98
    v_add_u32 v151, v97, v98

    s_add_u32 s66, s58, 384
    v_add_u32 v96, s66, v2
    v_mul_hi_u32 v97, v96, s59
    v_mul_u32_u24 v98, 18, v97
    v_sub_u32 v98, v96, v98
    v_mul_u32_u24 v97, 9216, v97
    v_lshlrev_b32 v98, 4, v98
    v_add_u32 v152, v97, v98

    s_add_u32 s66, s58, 448
    v_add_u32 v96, s66, v2
    v_mul_hi_u32 v97, v96, s59
    v_mul_u32_u24 v98, 18, v97
    v_sub_u32 v98, v96, v98
    v_mul_u32_u24 v97, 9216, v97
    v_lshlrev_b32 v98, 4, v98
    v_add_u32 v153, v97, v98

    s_add_u32 s66, s58, 512
    v_add_u32 v96, s66, v2
    v_mul_hi_u32 v97, v96, s59
    v_mul_u32_u24 v98, 18, v97
    v_sub_u32 v98, v96, v98
    v_mul_u32_u24 v97, 9216, v97
    v_lshlrev_b32 v98, 4, v98
    v_add_u32 v154, v97, v98

    s_and_b32 s58, s2, 7
    s_lshr_b32 s59, s2, 3
    s_lshr_b32 s64, s58, 2
    s_mul_i32 s64, s64, 9437184
    s_and_b32 s58, s58, 3
    s_lshl_b32 s58, s58, 3
    s_lshr_b32 s59, s59, 2
    s_add_u32 s58, s58, s59
    s_mul_i32 s58, s58, 288
    s_add_u32 s64, s64, s58
    s_and_b32 s65, s3, 1
    s_mul_i32 s65, s65, 9216
    s_add_u32 s65, s65, 18432

L_b_pre_end:
    s_mov_b64 s[42:43], -1
    s_mov_b64 s[44:45], -1

    s_mov_b32 s9, 0
L_b_zp:
    s_mov_b64 exec, s[42:43]
    buffer_load_dwordx4 v[12:15], v5, s[24:27], s5 offen sc1
    s_mov_b64 exec, s[44:45]
    buffer_load_dwordx4 v[16:19], v5, s[24:27], s6 offen sc1
    s_mov_b64 exec, s[46:47]
    buffer_load_dwordx4 v[20:23], v5, s[24:27], s7 offen sc1
    s_waitcnt vmcnt(0)
    s_mov_b64 exec, s[42:43]
    v_cmp_eq_u32 s[42:43], s8, v12
    v_cmp_eq_u32 vcc, s8, v13
    s_or_b64 s[42:43], s[42:43], vcc
    v_cmp_eq_u32 vcc, s8, v14
    s_or_b64 s[42:43], s[42:43], vcc
    v_cmp_eq_u32 vcc, s8, v15
    s_or_b64 s[42:43], s[42:43], vcc
    s_mov_b64 exec, s[44:45]
    v_cmp_eq_u32 s[44:45], s8, v16
    v_cmp_eq_u32 vcc, s8, v17
    s_or_b64 s[44:45], s[44:45], vcc
    v_cmp_eq_u32 vcc, s8, v18
    s_or_b64 s[44:45], s[44:45], vcc
    v_cmp_eq_u32 vcc, s8, v19
    s_or_b64 s[44:45], s[44:45], vcc
    s_mov_b64 exec, s[46:47]
    v_cmp_eq_u32 s[46:47], s8, v20
    v_cmp_eq_u32 vcc, s8, v21
    s_or_b64 s[46:47], s[46:47], vcc
    v_cmp_eq_u32 vcc, s8, v22
    s_or_b64 s[46:47], s[46:47], vcc
    v_cmp_eq_u32 vcc, s8, v23
    s_or_b64 s[46:47], s[46:47], vcc
    s_or_b64 vcc, s[42:43], s[44:45]
    s_or_b64 vcc, vcc, s[46:47]
    s_cmp_eq_u64 vcc, 0
    s_cbranch_scc1 L_b_zp_ok
    s_add_u32 s9, s9, 1
    s_cmp_gt_u32 s9, 8000
    s_cbranch_scc1 L_b_zp_ok
    s_branch L_b_zp
L_b_zp_ok:
    s_mov_b64 exec, -1
    v_lshlrev_b32 v28, 16, v12
    v_and_b32 v29, 0xffff0000, v12
    v_lshlrev_b32 v30, 16, v13
    v_and_b32 v31, 0xffff0000, v13
    v_lshlrev_b32 v32, 16, v14
    v_and_b32 v33, 0xffff0000, v14
    v_lshlrev_b32 v34, 16, v15
    v_and_b32 v35, 0xffff0000, v15
    v_pk_add_f32 v[28:29], v[28:29], v[72:73]
    v_pk_add_f32 v[30:31], v[30:31], v[74:75]
    v_pk_add_f32 v[32:33], v[32:33], v[76:77]
    v_pk_add_f32 v[34:35], v[34:35], v[78:79]
    v_cvt_pk_bf16_f32 v12, v28, v29
    v_cvt_pk_bf16_f32 v13, v30, v31
    v_cvt_pk_bf16_f32 v14, v32, v33
    v_cvt_pk_bf16_f32 v15, v34, v35
    ds_write_b128 v4, v[12:15] offset:0
    v_lshlrev_b32 v28, 16, v16
    v_and_b32 v29, 0xffff0000, v16
    v_lshlrev_b32 v30, 16, v17
    v_and_b32 v31, 0xffff0000, v17
    v_lshlrev_b32 v32, 16, v18
    v_and_b32 v33, 0xffff0000, v18
    v_lshlrev_b32 v34, 16, v19
    v_and_b32 v35, 0xffff0000, v19
    v_pk_add_f32 v[28:29], v[28:29], v[80:81]
    v_pk_add_f32 v[30:31], v[30:31], v[82:83]
    v_pk_add_f32 v[32:33], v[32:33], v[84:85]
    v_pk_add_f32 v[34:35], v[34:35], v[86:87]
    v_cvt_pk_bf16_f32 v16, v28, v29
    v_cvt_pk_bf16_f32 v17, v30, v31
    v_cvt_pk_bf16_f32 v18, v32, v33
    v_cvt_pk_bf16_f32 v19, v34, v35
    ds_write_b128 v4, v[16:19] offset:8192
    s_cmp_lt_u32 s3, 2
    s_cbranch_scc0 L_b_n3
    v_lshlrev_b32 v28, 16, v20
    v_and_b32 v29, 0xffff0000, v20
    v_lshlrev_b32 v30, 16, v21
    v_and_b32 v31, 0xffff0000, v21
    v_lshlrev_b32 v32, 16, v22
    v_and_b32 v33, 0xffff0000, v22
    v_lshlrev_b32 v34, 16, v23
    v_and_b32 v35, 0xffff0000, v23
    v_pk_add_f32 v[28:29], v[28:29], v[88:89]
    v_pk_add_f32 v[30:31], v[30:31], v[90:91]
    v_pk_add_f32 v[32:33], v[32:33], v[92:93]
    v_pk_add_f32 v[34:35], v[34:35], v[94:95]
    v_cvt_pk_bf16_f32 v20, v28, v29
    v_cvt_pk_bf16_f32 v21, v30, v31
    v_cvt_pk_bf16_f32 v22, v32, v33
    v_cvt_pk_bf16_f32 v23, v34, v35
    ds_write_b128 v4, v[20:23] offset:16384
L_b_n3:
    s_waitcnt lgkmcnt(0)
    s_barrier
    ds_read_b64_tr_b16 v[28:29], v6 offset:0
    ds_read_b64_tr_b16 v[30:31], v6 offset:4096
    ds_read_b64_tr_b16 v[32:33], v6 offset:8192
    ds_read_b64_tr_b16 v[34:35], v6 offset:12288
    v_mov_b32 v36, 0
    v_mov_b32 v37, 0
    v_mov_b32 v40, 0
    v_mov_b32 v41, 0
    s_cmp_lt_u32 s3, 4
    s_cbranch_scc0 L_b_n5
    ds_read_b64_tr_b16 v[36:37], v6 offset:16384

L_b_n5:
    v_mov_b32 v42, 0
    v_mov_b32 v43, 0
    s_waitcnt lgkmcnt(0)
    v_dot2_f32_bf16 v40, v28, v25, v40
    v_dot2_f32_bf16 v41, v28, v28, v41
    v_dot2_f32_bf16 v42, v29, v25, v42
    v_dot2_f32_bf16 v43, v29, v29, v43
    v_dot2_f32_bf16 v40, v30, v25, v40
    v_dot2_f32_bf16 v41, v30, v30, v41
    v_dot2_f32_bf16 v42, v31, v25, v42
    v_dot2_f32_bf16 v43, v31, v31, v43
    v_dot2_f32_bf16 v40, v32, v25, v40
    v_dot2_f32_bf16 v41, v32, v32, v41
    v_dot2_f32_bf16 v42, v33, v25, v42
    v_dot2_f32_bf16 v43, v33, v33, v43
    v_dot2_f32_bf16 v40, v34, v25, v40
    v_dot2_f32_bf16 v41, v34, v34, v41
    v_dot2_f32_bf16 v42, v35, v25, v42
    v_dot2_f32_bf16 v43, v35, v35, v43
    v_dot2_f32_bf16 v40, v36, v25, v40
    v_dot2_f32_bf16 v41, v36, v36, v41
    v_dot2_f32_bf16 v42, v37, v25, v42
    v_dot2_f32_bf16 v43, v37, v37, v43
    s_nop 3
    v_add_f32 v40, v40, v42
    v_add_f32 v41, v41, v43
    s_nop 0
    v_mov_b32 v42, v40
    v_mov_b32 v43, v41
    s_nop 1
    v_permlane16_swap_b32 v40, v42
    v_permlane16_swap_b32 v41, v43
    s_nop 1
    v_add_f32 v40, v40, v42
    v_add_f32 v41, v41, v43

    v_mov_b32 v42, v40
    v_mov_b32 v43, v41
    s_nop 1
    v_permlane32_swap_b32 v40, v42
    v_permlane32_swap_b32 v41, v43
    s_nop 1
    v_add_f32 v40, v40, v42
    v_add_f32 v41, v41, v43

    s_mov_b64 exec, 0xffff
    ds_write_b64 v9, v[40:41]
    s_mov_b64 exec, -1
    s_waitcnt lgkmcnt(0)
    s_barrier

    ds_read_b64 v[28:29], v8 offset:0
    ds_read_b64 v[30:31], v8 offset:128
    ds_read_b64 v[32:33], v8 offset:256
    ds_read_b64 v[34:35], v8 offset:384
    ds_read_b64 v[36:37], v8 offset:512
    ds_read_b64 v[38:39], v8 offset:640
    ds_read_b64 v[40:41], v8 offset:768
    ds_read_b64 v[42:43], v8 offset:896
    s_waitcnt lgkmcnt(0)
    v_pk_add_f32 v[28:29], v[28:29], v[30:31]
    v_pk_add_f32 v[32:33], v[32:33], v[34:35]
    v_pk_add_f32 v[36:37], v[36:37], v[38:39]
    v_pk_add_f32 v[40:41], v[40:41], v[42:43]
    v_pk_add_f32 v[28:29], v[28:29], v[32:33]
    v_pk_add_f32 v[36:37], v[36:37], v[40:41]
    v_pk_add_f32 v[28:29], v[28:29], v[36:37]
    v_mul_f32 v28, 0x3ae38e39, v28
    v_mul_f32 v29, 0x3ae38e39, v29
    v_fma_f32 v29, -v28, v28, v29
    v_max_f32 v29, 0, v29
    v_cvt_pk_bf16_f32 v28, v28, v28
    v_lshlrev_b32 v28, 16, v28
    v_cvt_pk_bf16_f32 v29, v29, v29
    v_lshlrev_b32 v29, 16, v29
    v_add_f32 v29, 0x3727c5ac, v29
    v_cvt_pk_bf16_f32 v29, v29, v29
    v_lshlrev_b32 v29, 16, v29
    v_sqrt_f32 v29, v29
    s_nop 0
    v_cvt_pk_bf16_f32 v29, v29, v29
    v_lshlrev_b32 v29, 16, v29
    v_rcp_f32 v29, v29
    s_mov_b64 exec, 0xffff
    ds_write_b32 v10, v28
    ds_write_b32 v10, v29 offset:64
    s_mov_b64 exec, -1
    ds_read_b128 v[44:47], v24
    ds_read_b128 v[48:51], v24 offset:16
    ds_read_b128 v[52:55], v24 offset:64
    ds_read_b128 v[56:59], v24 offset:80
    s_waitcnt lgkmcnt(0)

    v_lshlrev_b32 v28, 16, v12
    v_and_b32 v29, 0xffff0000, v12
    v_lshlrev_b32 v30, 16, v13
    v_and_b32 v31, 0xffff0000, v13
    v_lshlrev_b32 v32, 16, v14
    v_and_b32 v33, 0xffff0000, v14
    v_lshlrev_b32 v34, 16, v15
    v_and_b32 v35, 0xffff0000, v15
    v_pk_add_f32 v[28:29], v[28:29], v[44:45] neg_lo:[0,1] neg_hi:[0,1]
    v_pk_add_f32 v[30:31], v[30:31], v[46:47] neg_lo:[0,1] neg_hi:[0,1]
    v_pk_add_f32 v[32:33], v[32:33], v[48:49] neg_lo:[0,1] neg_hi:[0,1]
    v_pk_add_f32 v[34:35], v[34:35], v[50:51] neg_lo:[0,1] neg_hi:[0,1]
    v_cvt_pk_bf16_f32 v60, v28, v29
    v_cvt_pk_bf16_f32 v61, v30, v31
    v_cvt_pk_bf16_f32 v62, v32, v33
    v_cvt_pk_bf16_f32 v63, v34, v35
    v_lshlrev_b32 v28, 16, v60
    v_and_b32 v29, 0xffff0000, v60
    v_lshlrev_b32 v30, 16, v61
    v_and_b32 v31, 0xffff0000, v61
    v_lshlrev_b32 v32, 16, v62
    v_and_b32 v33, 0xffff0000, v62
    v_lshlrev_b32 v34, 16, v63
    v_and_b32 v35, 0xffff0000, v63
    v_pk_mul_f32 v[28:29], v[28:29], v[52:53]
    v_pk_mul_f32 v[30:31], v[30:31], v[54:55]
    v_pk_mul_f32 v[32:33], v[32:33], v[56:57]
    v_pk_mul_f32 v[34:35], v[34:35], v[58:59]
    v_cvt_pk_bf16_f32 v60, v28, v29
    v_cvt_pk_bf16_f32 v61, v30, v31
    v_cvt_pk_bf16_f32 v62, v32, v33
    v_cvt_pk_bf16_f32 v63, v34, v35
    s_mul_i32 s4, s17, 9216
    s_add_u32 s5, s4, 7340032
    buffer_store_dwordx4 v[60:63], v3, s[24:27], s5 offen sc1
    s_add_u32 s5, s4, 10485760
    buffer_store_dwordx4 v[12:15], v3, s[24:27], s5 offen sc1
    v_lshlrev_b32 v28, 16, v16
    v_and_b32 v29, 0xffff0000, v16
    v_lshlrev_b32 v30, 16, v17
    v_and_b32 v31, 0xffff0000, v17
    v_lshlrev_b32 v32, 16, v18
    v_and_b32 v33, 0xffff0000, v18
    v_lshlrev_b32 v34, 16, v19
    v_and_b32 v35, 0xffff0000, v19
    v_pk_add_f32 v[28:29], v[28:29], v[44:45] neg_lo:[0,1] neg_hi:[0,1]
    v_pk_add_f32 v[30:31], v[30:31], v[46:47] neg_lo:[0,1] neg_hi:[0,1]
    v_pk_add_f32 v[32:33], v[32:33], v[48:49] neg_lo:[0,1] neg_hi:[0,1]
    v_pk_add_f32 v[34:35], v[34:35], v[50:51] neg_lo:[0,1] neg_hi:[0,1]
    v_cvt_pk_bf16_f32 v64, v28, v29
    v_cvt_pk_bf16_f32 v65, v30, v31
    v_cvt_pk_bf16_f32 v66, v32, v33
    v_cvt_pk_bf16_f32 v67, v34, v35
    v_lshlrev_b32 v28, 16, v64
    v_and_b32 v29, 0xffff0000, v64
    v_lshlrev_b32 v30, 16, v65
    v_and_b32 v31, 0xffff0000, v65
    v_lshlrev_b32 v32, 16, v66
    v_and_b32 v33, 0xffff0000, v66
    v_lshlrev_b32 v34, 16, v67
    v_and_b32 v35, 0xffff0000, v67
    v_pk_mul_f32 v[28:29], v[28:29], v[52:53]
    v_pk_mul_f32 v[30:31], v[30:31], v[54:55]
    v_pk_mul_f32 v[32:33], v[32:33], v[56:57]
    v_pk_mul_f32 v[34:35], v[34:35], v[58:59]
    v_cvt_pk_bf16_f32 v64, v28, v29
    v_cvt_pk_bf16_f32 v65, v30, v31
    v_cvt_pk_bf16_f32 v66, v32, v33
    v_cvt_pk_bf16_f32 v67, v34, v35
    s_mul_i32 s4, s17, 9216
    s_add_u32 s5, s4, 7344128
    buffer_store_dwordx4 v[64:67], v3, s[24:27], s5 offen sc1
    s_add_u32 s5, s4, 10489856
    buffer_store_dwordx4 v[16:19], v3, s[24:27], s5 offen sc1
    s_cmp_lt_u32 s3, 2
    s_cbranch_scc0 L_b_fin
    v_lshlrev_b32 v28, 16, v20
    v_and_b32 v29, 0xffff0000, v20
    v_lshlrev_b32 v30, 16, v21
    v_and_b32 v31, 0xffff0000, v21
    v_lshlrev_b32 v32, 16, v22
    v_and_b32 v33, 0xffff0000, v22
    v_lshlrev_b32 v34, 16, v23
    v_and_b32 v35, 0xffff0000, v23
    v_pk_add_f32 v[28:29], v[28:29], v[44:45] neg_lo:[0,1] neg_hi:[0,1]
    v_pk_add_f32 v[30:31], v[30:31], v[46:47] neg_lo:[0,1] neg_hi:[0,1]
    v_pk_add_f32 v[32:33], v[32:33], v[48:49] neg_lo:[0,1] neg_hi:[0,1]
    v_pk_add_f32 v[34:35], v[34:35], v[50:51] neg_lo:[0,1] neg_hi:[0,1]
    v_cvt_pk_bf16_f32 v68, v28, v29
    v_cvt_pk_bf16_f32 v69, v30, v31
    v_cvt_pk_bf16_f32 v70, v32, v33
    v_cvt_pk_bf16_f32 v71, v34, v35
    v_lshlrev_b32 v28, 16, v68
    v_and_b32 v29, 0xffff0000, v68
    v_lshlrev_b32 v30, 16, v69
    v_and_b32 v31, 0xffff0000, v69
    v_lshlrev_b32 v32, 16, v70
    v_and_b32 v33, 0xffff0000, v70
    v_lshlrev_b32 v34, 16, v71
    v_and_b32 v35, 0xffff0000, v71
    v_pk_mul_f32 v[28:29], v[28:29], v[52:53]
    v_pk_mul_f32 v[30:31], v[30:31], v[54:55]
    v_pk_mul_f32 v[32:33], v[32:33], v[56:57]
    v_pk_mul_f32 v[34:35], v[34:35], v[58:59]
    v_cvt_pk_bf16_f32 v68, v28, v29
    v_cvt_pk_bf16_f32 v69, v30, v31
    v_cvt_pk_bf16_f32 v70, v32, v33
    v_cvt_pk_bf16_f32 v71, v34, v35
    s_mul_i32 s4, s17, 9216
    s_add_u32 s5, s4, 7348224
    buffer_store_dwordx4 v[68:71], v3, s[24:27], s5 offen sc1
    s_add_u32 s5, s4, 10493952
    buffer_store_dwordx4 v[20:23], v3, s[24:27], s5 offen sc1
L_b_fin:
    s_waitcnt vmcnt(0)
    s_barrier
    s_cmp_eq_u32 s3, 0
    s_cbranch_scc0 L_b_noflag
    s_lshl_b32 s14, s17, 6
    s_add_u32 s14, s14, 30408704
    v_lshrrev_b32 v104, 2, v2
    v_mul_u32_u24 v104, 33152, v104
    v_and_b32 v105, 3, v2
    v_lshl_add_u32 v104, v105, 4, v104
    v_mov_b32 v100, s28
    v_mov_b32 v101, s28
    v_mov_b32 v102, s28
    v_mov_b32 v103, s28
    buffer_store_dwordx4 v[100:103], v104, s[24:27], s14 offen sc1

L_b_noflag:
L_mlp:

    s_waitcnt lgkmcnt(0)
    s_mov_b64 s[4:5], s[48:49]
    s_mov_b64 s[6:7], s[50:51]
    s_mov_b64 s[8:9], s[52:53]
    s_mov_b64 s[10:11], s[54:55]
    s_mov_b64 s[44:45], s[70:71]
    s_mov_b64 s[46:47], s[56:57]

    v_lshrrev_b32 v25, 6, v0
    v_and_b32 v0, 63, v0
    s_nop 0
    v_readfirstlane_b32 s24, v25
    s_and_b32 s30, s2, 7
    s_lshr_b32 s31, s2, 3
    s_and_b32 s25, s24, 3
    s_lshr_b32 s26, s24, 2

    s_lshr_b32 s32, s30, 2
    s_and_b32 s33, s30, 3
    s_lshl_b32 s33, s33, 3
    s_lshr_b32 s38, s31, 2
    s_add_u32 s33, s33, s38
    s_and_b32 s34, s31, 3
    s_and_b32 s35, s33, 1
    s_lshr_b32 s36, s30, 1
    s_and_b32 s37, s30, 1
    s_lshl_b32 s37, s37, 3
    s_add_u32 s37, s37, s38

    v_and_b32 v1, 15, v0
    v_lshrrev_b32 v2, 4, v0
    v_lshlrev_b32 v3, 4, v0
    s_waitcnt lgkmcnt(0)

    s_mov_b32 s12, s44
    s_and_b32 s13, s45, 0xffff
    s_mov_b32 s14, 268435456
    s_mov_b32 s15, 0x00020000
    s_mov_b32 s16, s4
    s_and_b32 s17, s5, 0xffff
    s_mov_b32 s18, 18874368
    s_mov_b32 s19, 0x00020000
    s_mov_b32 s20, s6
    s_and_b32 s21, s7, 0xffff
    s_mov_b32 s22, 9216
    s_mov_b32 s23, 0x00020000
    s_mul_i32 s38, s33, 288
    s_lshl_b32 s39, s25, 1
    s_add_u32 s39, s39, s35
    s_lshl_b32 s48, s39, 5
    s_add_u32 s48, s48, s38
    s_cmp_eq_u32 s35, 0
    s_cselect_b32 s49, 256, 0
    s_add_u32 s49, s49, s38
    v_lshlrev_b32 v4, 3, v2
    buffer_load_dwordx2 v[26:27], v4, s[20:23], s48 offen
    buffer_load_dwordx2 v[28:29], v4, s[20:23], s48 offen offset:32
    buffer_load_dwordx2 v[30:31], v4, s[20:23], s49 offen
    s_cmp_ge_u32 s24, 4
    s_cbranch_scc1 L_m_loader

    s_getpc_b64 s[64:65]
L_cpc_3:
    s_sub_u32 s64, s64, L_cpc_3-sequential_preLN__ssm_conv_s4d__mixer_token_mlp__prompt_kernel
    s_subb_u32 s65, s65, 0
    s_and_b32 s65, s65, 0xffff
    s_mov_b32 s66, L_all_end-sequential_preLN__ssm_conv_s4d__mixer_token_mlp__prompt_kernel
    s_mov_b32 s67, 0x00020000
    s_and_b32 s63, s31, 15
    s_lshl_b32 s63, s63, 13
    v_lshlrev_b32 v155, 7, v0

    s_cmp_eq_u32 s24, 0
    s_cbranch_scc0 L_m_nocpf
    buffer_load_dword v156, v155, s[64:67], s63 offen
L_m_nocpf:

    v_mul_u32_u24 v25, 2304, v2
    v_lshlrev_b32 v4, 4, v1
    v_add_u32 v25, v25, v4
    s_lshl_b32 s38, s25, 1

    s_add_u32 s48, s38, 0
    s_cmp_ge_u32 s48, 9
    s_cselect_b32 s49, 9, 0
    s_sub_u32 s48, s48, s49
    s_lshl_b32 s48, s48, 8
    v_add_u32 v5, s48, v25
    v_add_u32 v14, 73728, v5

    s_add_u32 s48, s38, 1
    s_cmp_ge_u32 s48, 9
    s_cselect_b32 s49, 9, 0
    s_sub_u32 s48, s48, s49
    s_lshl_b32 s48, s48, 8
    v_add_u32 v6, s48, v25
    v_add_u32 v15, 73728, v6

    s_add_u32 s48, s38, 2
    s_cmp_ge_u32 s48, 9
    s_cselect_b32 s49, 9, 0
    s_sub_u32 s48, s48, s49
    s_lshl_b32 s48, s48, 8
    v_add_u32 v7, s48, v25
    v_add_u32 v16, 73728, v7

    s_add_u32 s48, s38, 3
    s_cmp_ge_u32 s48, 9
    s_cselect_b32 s49, 9, 0
    s_sub_u32 s48, s48, s49
    s_lshl_b32 s48, s48, 8
    v_add_u32 v8, s48, v25
    v_add_u32 v17, 73728, v8

    s_add_u32 s48, s38, 4
    s_cmp_ge_u32 s48, 9
    s_cselect_b32 s49, 9, 0
    s_sub_u32 s48, s48, s49
    s_lshl_b32 s48, s48, 8
    v_add_u32 v9, s48, v25
    v_add_u32 v18, 73728, v9

    s_add_u32 s48, s38, 5
    s_cmp_ge_u32 s48, 9
    s_cselect_b32 s49, 9, 0
    s_sub_u32 s48, s48, s49
    s_lshl_b32 s48, s48, 8
    v_add_u32 v10, s48, v25
    v_add_u32 v19, 73728, v10

    s_add_u32 s48, s38, 6
    s_cmp_ge_u32 s48, 9
    s_cselect_b32 s49, 9, 0
    s_sub_u32 s48, s48, s49
    s_lshl_b32 s48, s48, 8
    v_add_u32 v11, s48, v25
    v_add_u32 v20, 73728, v11

    s_add_u32 s48, s38, 7
    s_cmp_ge_u32 s48, 9
    s_cselect_b32 s49, 9, 0
    s_sub_u32 s48, s48, s49
    s_lshl_b32 s48, s48, 8
    v_add_u32 v12, s48, v25
    v_add_u32 v21, 73728, v12

    s_add_u32 s48, s38, 8
    s_cmp_ge_u32 s48, 9
    s_cselect_b32 s49, 9, 0
    s_sub_u32 s48, s48, s49
    s_lshl_b32 s48, s48, 8
    v_add_u32 v13, s48, v25
    v_add_u32 v22, 73728, v13

    v_lshrrev_b32 v25, 2, v1
    v_lshlrev_b32 v4, 2, v2
    v_add_u32 v25, v25, v4
    v_mul_u32_u24 v25, 288, v25
    v_and_b32 v4, 3, v1
    v_lshlrev_b32 v4, 3, v4
    v_add_u32 v25, v25, v4
    v_add_u32 v25, 18432, v25
    s_lshl_b32 s48, s39, 5
    v_add_u32 v23, s48, v25
    v_add_u32 v24, 73728, v23
    s_cmp_eq_u32 s35, 0
    s_cselect_b32 s48, 256, 0
    v_add_u32 v116, s48, v25
    v_add_u32 v117, 73728, v116

    s_lshl_b32 s48, s31, 2
    s_add_u32 s48, s48, s25
    s_lshl_b32 s48, s48, 2
    s_mul_i32 s50, s36, 1152
    s_add_u32 s50, s50, s48
    s_add_u32 s50, s50, 256
    s_lshl_b32 s50, s50, 12
    s_and_b32 s49, s30, 1
    s_lshl_b32 s49, s49, 11
    s_add_u32 s50, s50, s49
    v_lshrrev_b32 v121, 4, v0
    v_lshlrev_b32 v121, 12, v121
    v_lshl_add_u32 v121, v1, 7, v121

    s_mov_b32 s52, s8
    s_and_b32 s53, s9, 0xffff
    s_mov_b32 s54, 18874368
    s_mov_b32 s55, 0x00020000
    v_mov_b32 v32, 0
    v_mov_b32 v33, 0
    v_mov_b32 v34, 0
    v_mov_b32 v35, 0
    v_mov_b32 v36, 0
    v_mov_b32 v37, 0
    v_mov_b32 v38, 0
    v_mov_b32 v39, 0
    v_mov_b32 v40, 0
    v_mov_b32 v41, 0
    v_mov_b32 v42, 0
    v_mov_b32 v43, 0
    v_mov_b32 v44, 0
    v_mov_b32 v45, 0
    v_mov_b32 v46, 0
    v_mov_b32 v47, 0
    v_mov_b32 v48, 0
    v_mov_b32 v49, 0
    v_mov_b32 v50, 0
    v_mov_b32 v51, 0
    v_mov_b32 v52, 0
    v_mov_b32 v53, 0
    v_mov_b32 v54, 0
    v_mov_b32 v55, 0
    v_mov_b32 v56, 0
    v_mov_b32 v57, 0
    v_mov_b32 v58, 0
    v_mov_b32 v59, 0
    v_mov_b32 v60, 0
    v_mov_b32 v61, 0
    v_mov_b32 v62, 0
    v_mov_b32 v63, 0
    v_mov_b32 v64, 0
    v_mov_b32 v65, 0
    v_mov_b32 v66, 0
    v_mov_b32 v67, 0
    v_mov_b32 v68, 0
    v_mov_b32 v69, 0
    v_mov_b32 v70, 0
    v_mov_b32 v71, 0
    v_mov_b32 v72, 0
    v_mov_b32 v73, 0
    v_mov_b32 v74, 0
    v_mov_b32 v75, 0
    v_mov_b32 v76, 0
    v_mov_b32 v77, 0
    v_mov_b32 v78, 0
    v_mov_b32 v79, 0
    v_mov_b32 v80, 0
    v_mov_b32 v81, 0
    v_mov_b32 v82, 0
    v_mov_b32 v83, 0
    v_mov_b32 v84, 0
    v_mov_b32 v85, 0
    v_mov_b32 v86, 0
    v_mov_b32 v87, 0
    v_mov_b32 v88, 0
    v_mov_b32 v89, 0
    v_mov_b32 v90, 0
    v_mov_b32 v91, 0
    v_mov_b32 v92, 0
    v_mov_b32 v93, 0
    v_mov_b32 v94, 0
    v_mov_b32 v95, 0
    v_mov_b32 v96, 0
    v_mov_b32 v97, 0
    v_mov_b32 v98, 0
    v_mov_b32 v99, 0
    v_mov_b32 v100, 0
    v_mov_b32 v101, 0
    v_mov_b32 v102, 0
    v_mov_b32 v103, 0
    v_mov_b32 v104, 0
    v_mov_b32 v105, 0
    v_mov_b32 v106, 0
    v_mov_b32 v107, 0
    v_mov_b32 v108, 0
    v_mov_b32 v109, 0
    v_mov_b32 v110, 0
    v_mov_b32 v111, 0
    v_mov_b32 v112, 0
    v_mov_b32 v113, 0
    v_mov_b32 v114, 0
    v_mov_b32 v115, 0
    s_barrier
    ds_read_b64_tr_b16 a[0:1], v23 offset:0
    ds_read_b64_tr_b16 a[2:3], v23 offset:4608
    ds_read_b64_tr_b16 a[4:5], v23 offset:32
    ds_read_b64_tr_b16 a[6:7], v23 offset:4640
    ds_read_b64_tr_b16 a[8:9], v116 offset:0
    ds_read_b64_tr_b16 a[10:11], v116 offset:4608
    ds_read_b128 a[12:15], v5 offset:0
    ds_read_b128 a[16:19], v6 offset:0
    ds_read_b128 a[20:23], v7 offset:0
    ds_read_b128 a[24:27], v8 offset:0
    ds_read_b128 a[28:31], v9 offset:0
    ds_read_b128 a[32:35], v10 offset:0
    ds_read_b128 a[36:39], v11 offset:0
    ds_read_b128 a[40:43], v12 offset:0
    ds_read_b128 a[44:47], v13 offset:0
    s_waitcnt lgkmcnt(8)
    v_mfma_f32_16x16x32_bf16 v[32:35], a[0:3], a[12:15], v[32:35]
    ds_read_b64_tr_b16 a[48:49], v23 offset:9216
    v_mfma_f32_16x16x32_bf16 v[36:39], a[4:7], a[12:15], v[36:39]
    ds_read_b64_tr_b16 a[50:51], v23 offset:13824
    v_mfma_f32_16x16x32_bf16 v[104:107], a[8:11], a[12:15], v[104:107]
    ds_read_b64_tr_b16 a[52:53], v23 offset:9248
    s_waitcnt lgkmcnt(10)
    v_mfma_f32_16x16x32_bf16 v[40:43], a[0:3], a[16:19], v[40:43]
    ds_read_b64_tr_b16 a[54:55], v23 offset:13856
    v_mfma_f32_16x16x32_bf16 v[44:47], a[4:7], a[16:19], v[44:47]
    ds_read_b64_tr_b16 a[56:57], v116 offset:9216
    v_mfma_f32_16x16x32_bf16 v[108:111], a[8:11], a[16:19], v[108:111]
    ds_read_b64_tr_b16 a[58:59], v116 offset:13824
    s_waitcnt lgkmcnt(12)
    v_mfma_f32_16x16x32_bf16 v[48:51], a[0:3], a[20:23], v[48:51]
    ds_read_b128 a[60:63], v5 offset:9216
    v_mfma_f32_16x16x32_bf16 v[52:55], a[4:7], a[20:23], v[52:55]
    ds_read_b128 a[64:67], v6 offset:9216
    v_mfma_f32_16x16x32_bf16 v[112:115], a[8:11], a[20:23], v[112:115]
    ds_read_b128 a[68:71], v7 offset:9216
    s_waitcnt lgkmcnt(14)
    v_mfma_f32_16x16x32_bf16 v[56:59], a[0:3], a[24:27], v[56:59]
    ds_read_b128 a[72:75], v8 offset:9216
    v_mfma_f32_16x16x32_bf16 v[60:63], a[4:7], a[24:27], v[60:63]
    ds_read_b128 a[76:79], v9 offset:9216
    s_waitcnt lgkmcnt(15)
    v_mfma_f32_16x16x32_bf16 v[64:67], a[0:3], a[28:31], v[64:67]
    ds_read_b128 a[80:83], v10 offset:9216
    v_mfma_f32_16x16x32_bf16 v[68:71], a[4:7], a[28:31], v[68:71]
    ds_read_b128 a[84:87], v11 offset:9216
    s_waitcnt lgkmcnt(15)
    v_mfma_f32_16x16x32_bf16 v[72:75], a[0:3], a[32:35], v[72:75]
    ds_read_b128 a[88:91], v12 offset:9216
    v_mfma_f32_16x16x32_bf16 v[76:79], a[4:7], a[32:35], v[76:79]
    ds_read_b128 a[92:95], v13 offset:9216
    v_mfma_f32_16x16x32_bf16 v[80:83], a[0:3], a[36:39], v[80:83]
    v_mfma_f32_16x16x32_bf16 v[84:87], a[4:7], a[36:39], v[84:87]
    s_waitcnt lgkmcnt(15)
    v_mfma_f32_16x16x32_bf16 v[88:91], a[0:3], a[40:43], v[88:91]
    v_mfma_f32_16x16x32_bf16 v[92:95], a[4:7], a[40:43], v[92:95]
    v_mfma_f32_16x16x32_bf16 v[96:99], a[0:3], a[44:47], v[96:99]
    v_mfma_f32_16x16x32_bf16 v[100:103], a[4:7], a[44:47], v[100:103]
    s_waitcnt lgkmcnt(0)
    s_barrier
    v_mfma_f32_16x16x32_bf16 v[32:35], a[48:51], a[60:63], v[32:35]
    ds_read_b64_tr_b16 a[0:1], v23 offset:36864
    v_mfma_f32_16x16x32_bf16 v[36:39], a[52:55], a[60:63], v[36:39]
    ds_read_b64_tr_b16 a[2:3], v23 offset:41472
    v_mfma_f32_16x16x32_bf16 v[104:107], a[56:59], a[60:63], v[104:107]
    ds_read_b64_tr_b16 a[4:5], v23 offset:36896
    v_mfma_f32_16x16x32_bf16 v[40:43], a[48:51], a[64:67], v[40:43]
    ds_read_b64_tr_b16 a[6:7], v23 offset:41504
    v_mfma_f32_16x16x32_bf16 v[44:47], a[52:55], a[64:67], v[44:47]
    ds_read_b64_tr_b16 a[8:9], v116 offset:36864
    v_mfma_f32_16x16x32_bf16 v[108:111], a[56:59], a[64:67], v[108:111]
    ds_read_b64_tr_b16 a[10:11], v116 offset:41472
    v_mfma_f32_16x16x32_bf16 v[48:51], a[48:51], a[68:71], v[48:51]
    ds_read_b128 a[12:15], v5 offset:36864
    v_mfma_f32_16x16x32_bf16 v[52:55], a[52:55], a[68:71], v[52:55]
    ds_read_b128 a[16:19], v6 offset:36864
    v_mfma_f32_16x16x32_bf16 v[112:115], a[56:59], a[68:71], v[112:115]
    ds_read_b128 a[20:23], v7 offset:36864
    v_mfma_f32_16x16x32_bf16 v[56:59], a[48:51], a[72:75], v[56:59]
    ds_read_b128 a[24:27], v8 offset:36864
    v_mfma_f32_16x16x32_bf16 v[60:63], a[52:55], a[72:75], v[60:63]
    ds_read_b128 a[28:31], v9 offset:36864
    v_mfma_f32_16x16x32_bf16 v[64:67], a[48:51], a[76:79], v[64:67]
    ds_read_b128 a[32:35], v10 offset:36864
    v_mfma_f32_16x16x32_bf16 v[68:71], a[52:55], a[76:79], v[68:71]
    ds_read_b128 a[36:39], v11 offset:36864
    v_mfma_f32_16x16x32_bf16 v[72:75], a[48:51], a[80:83], v[72:75]
    ds_read_b128 a[40:43], v12 offset:36864
    v_mfma_f32_16x16x32_bf16 v[76:79], a[52:55], a[80:83], v[76:79]
    ds_read_b128 a[44:47], v13 offset:36864
    v_mfma_f32_16x16x32_bf16 v[80:83], a[48:51], a[84:87], v[80:83]
    v_mfma_f32_16x16x32_bf16 v[84:87], a[52:55], a[84:87], v[84:87]
    v_mfma_f32_16x16x32_bf16 v[88:91], a[48:51], a[88:91], v[88:91]
    v_mfma_f32_16x16x32_bf16 v[92:95], a[52:55], a[88:91], v[92:95]
    v_mfma_f32_16x16x32_bf16 v[96:99], a[48:51], a[92:95], v[96:99]
    v_mfma_f32_16x16x32_bf16 v[100:103], a[52:55], a[92:95], v[100:103]
    s_waitcnt lgkmcnt(8)
    v_mfma_f32_16x16x32_bf16 v[32:35], a[0:3], a[12:15], v[32:35]
    ds_read_b64_tr_b16 a[48:49], v23 offset:46080
    v_mfma_f32_16x16x32_bf16 v[36:39], a[4:7], a[12:15], v[36:39]
    ds_read_b64_tr_b16 a[50:51], v23 offset:50688
    v_mfma_f32_16x16x32_bf16 v[104:107], a[8:11], a[12:15], v[104:107]
    ds_read_b64_tr_b16 a[52:53], v23 offset:46112
    s_waitcnt lgkmcnt(10)
    v_mfma_f32_16x16x32_bf16 v[40:43], a[0:3], a[16:19], v[40:43]
    ds_read_b64_tr_b16 a[54:55], v23 offset:50720
    v_mfma_f32_16x16x32_bf16 v[44:47], a[4:7], a[16:19], v[44:47]
    ds_read_b64_tr_b16 a[56:57], v116 offset:46080
    v_mfma_f32_16x16x32_bf16 v[108:111], a[8:11], a[16:19], v[108:111]
    ds_read_b64_tr_b16 a[58:59], v116 offset:50688
    s_waitcnt lgkmcnt(12)
    v_mfma_f32_16x16x32_bf16 v[48:51], a[0:3], a[20:23], v[48:51]
    ds_read_b128 a[60:63], v5 offset:46080
    v_mfma_f32_16x16x32_bf16 v[52:55], a[4:7], a[20:23], v[52:55]
    ds_read_b128 a[64:67], v6 offset:46080
    v_mfma_f32_16x16x32_bf16 v[112:115], a[8:11], a[20:23], v[112:115]
    ds_read_b128 a[68:71], v7 offset:46080
    s_waitcnt lgkmcnt(14)
    v_mfma_f32_16x16x32_bf16 v[56:59], a[0:3], a[24:27], v[56:59]
    ds_read_b128 a[72:75], v8 offset:46080
    v_mfma_f32_16x16x32_bf16 v[60:63], a[4:7], a[24:27], v[60:63]
    ds_read_b128 a[76:79], v9 offset:46080
    s_waitcnt lgkmcnt(15)
    v_mfma_f32_16x16x32_bf16 v[64:67], a[0:3], a[28:31], v[64:67]
    ds_read_b128 a[80:83], v10 offset:46080
    v_mfma_f32_16x16x32_bf16 v[68:71], a[4:7], a[28:31], v[68:71]
    ds_read_b128 a[84:87], v11 offset:46080
    s_waitcnt lgkmcnt(15)
    v_mfma_f32_16x16x32_bf16 v[72:75], a[0:3], a[32:35], v[72:75]
    ds_read_b128 a[88:91], v12 offset:46080
    v_mfma_f32_16x16x32_bf16 v[76:79], a[4:7], a[32:35], v[76:79]
    ds_read_b128 a[92:95], v13 offset:46080
    v_mfma_f32_16x16x32_bf16 v[80:83], a[0:3], a[36:39], v[80:83]
    v_mfma_f32_16x16x32_bf16 v[84:87], a[4:7], a[36:39], v[84:87]
    s_waitcnt lgkmcnt(15)
    v_mfma_f32_16x16x32_bf16 v[88:91], a[0:3], a[40:43], v[88:91]
    v_mfma_f32_16x16x32_bf16 v[92:95], a[4:7], a[40:43], v[92:95]
    v_mfma_f32_16x16x32_bf16 v[96:99], a[0:3], a[44:47], v[96:99]
    v_mfma_f32_16x16x32_bf16 v[100:103], a[4:7], a[44:47], v[100:103]
    s_waitcnt lgkmcnt(0)
    s_barrier
    v_mfma_f32_16x16x32_bf16 v[32:35], a[48:51], a[60:63], v[32:35]
    ds_read_b64_tr_b16 a[0:1], v24 offset:0
    v_mfma_f32_16x16x32_bf16 v[36:39], a[52:55], a[60:63], v[36:39]
    ds_read_b64_tr_b16 a[2:3], v24 offset:4608
    v_mfma_f32_16x16x32_bf16 v[104:107], a[56:59], a[60:63], v[104:107]
    ds_read_b64_tr_b16 a[4:5], v24 offset:32
    v_mfma_f32_16x16x32_bf16 v[40:43], a[48:51], a[64:67], v[40:43]
    ds_read_b64_tr_b16 a[6:7], v24 offset:4640
    v_mfma_f32_16x16x32_bf16 v[44:47], a[52:55], a[64:67], v[44:47]
    ds_read_b64_tr_b16 a[8:9], v117 offset:0
    v_mfma_f32_16x16x32_bf16 v[108:111], a[56:59], a[64:67], v[108:111]
    ds_read_b64_tr_b16 a[10:11], v117 offset:4608
    v_mfma_f32_16x16x32_bf16 v[48:51], a[48:51], a[68:71], v[48:51]
    ds_read_b128 a[12:15], v14 offset:0
    v_mfma_f32_16x16x32_bf16 v[52:55], a[52:55], a[68:71], v[52:55]
    ds_read_b128 a[16:19], v15 offset:0
    v_mfma_f32_16x16x32_bf16 v[112:115], a[56:59], a[68:71], v[112:115]
    ds_read_b128 a[20:23], v16 offset:0
    v_mfma_f32_16x16x32_bf16 v[56:59], a[48:51], a[72:75], v[56:59]
    ds_read_b128 a[24:27], v17 offset:0
    v_mfma_f32_16x16x32_bf16 v[60:63], a[52:55], a[72:75], v[60:63]
    ds_read_b128 a[28:31], v18 offset:0
    v_mfma_f32_16x16x32_bf16 v[64:67], a[48:51], a[76:79], v[64:67]
    ds_read_b128 a[32:35], v19 offset:0
    v_mfma_f32_16x16x32_bf16 v[68:71], a[52:55], a[76:79], v[68:71]
    ds_read_b128 a[36:39], v20 offset:0
    v_mfma_f32_16x16x32_bf16 v[72:75], a[48:51], a[80:83], v[72:75]
    ds_read_b128 a[40:43], v21 offset:0
    v_mfma_f32_16x16x32_bf16 v[76:79], a[52:55], a[80:83], v[76:79]
    ds_read_b128 a[44:47], v22 offset:0
    v_mfma_f32_16x16x32_bf16 v[80:83], a[48:51], a[84:87], v[80:83]
    v_mfma_f32_16x16x32_bf16 v[84:87], a[52:55], a[84:87], v[84:87]
    v_mfma_f32_16x16x32_bf16 v[88:91], a[48:51], a[88:91], v[88:91]
    v_mfma_f32_16x16x32_bf16 v[92:95], a[52:55], a[88:91], v[92:95]
    v_mfma_f32_16x16x32_bf16 v[96:99], a[48:51], a[92:95], v[96:99]
    v_mfma_f32_16x16x32_bf16 v[100:103], a[52:55], a[92:95], v[100:103]
    s_waitcnt lgkmcnt(8)
    v_mfma_f32_16x16x32_bf16 v[32:35], a[0:3], a[12:15], v[32:35]
    ds_read_b64_tr_b16 a[48:49], v24 offset:9216
    v_mfma_f32_16x16x32_bf16 v[36:39], a[4:7], a[12:15], v[36:39]
    ds_read_b64_tr_b16 a[50:51], v24 offset:13824
    v_mfma_f32_16x16x32_bf16 v[104:107], a[8:11], a[12:15], v[104:107]
    ds_read_b64_tr_b16 a[52:53], v24 offset:9248
    s_waitcnt lgkmcnt(10)
    v_mfma_f32_16x16x32_bf16 v[40:43], a[0:3], a[16:19], v[40:43]
    ds_read_b64_tr_b16 a[54:55], v24 offset:13856
    v_mfma_f32_16x16x32_bf16 v[44:47], a[4:7], a[16:19], v[44:47]
    ds_read_b64_tr_b16 a[56:57], v117 offset:9216
    v_mfma_f32_16x16x32_bf16 v[108:111], a[8:11], a[16:19], v[108:111]
    ds_read_b64_tr_b16 a[58:59], v117 offset:13824
    s_waitcnt lgkmcnt(12)
    v_mfma_f32_16x16x32_bf16 v[48:51], a[0:3], a[20:23], v[48:51]
    ds_read_b128 a[60:63], v14 offset:9216
    v_mfma_f32_16x16x32_bf16 v[52:55], a[4:7], a[20:23], v[52:55]
    ds_read_b128 a[64:67], v15 offset:9216
    v_mfma_f32_16x16x32_bf16 v[112:115], a[8:11], a[20:23], v[112:115]
    ds_read_b128 a[68:71], v16 offset:9216
    s_waitcnt lgkmcnt(14)
    v_mfma_f32_16x16x32_bf16 v[56:59], a[0:3], a[24:27], v[56:59]
    ds_read_b128 a[72:75], v17 offset:9216
    v_mfma_f32_16x16x32_bf16 v[60:63], a[4:7], a[24:27], v[60:63]
    ds_read_b128 a[76:79], v18 offset:9216
    s_waitcnt lgkmcnt(15)
    v_mfma_f32_16x16x32_bf16 v[64:67], a[0:3], a[28:31], v[64:67]
    ds_read_b128 a[80:83], v19 offset:9216
    v_mfma_f32_16x16x32_bf16 v[68:71], a[4:7], a[28:31], v[68:71]
    ds_read_b128 a[84:87], v20 offset:9216
    s_waitcnt lgkmcnt(15)
    v_mfma_f32_16x16x32_bf16 v[72:75], a[0:3], a[32:35], v[72:75]
    ds_read_b128 a[88:91], v21 offset:9216
    v_mfma_f32_16x16x32_bf16 v[76:79], a[4:7], a[32:35], v[76:79]
    ds_read_b128 a[92:95], v22 offset:9216
    v_mfma_f32_16x16x32_bf16 v[80:83], a[0:3], a[36:39], v[80:83]
    v_mfma_f32_16x16x32_bf16 v[84:87], a[4:7], a[36:39], v[84:87]
    s_waitcnt lgkmcnt(15)
    v_mfma_f32_16x16x32_bf16 v[88:91], a[0:3], a[40:43], v[88:91]
    v_mfma_f32_16x16x32_bf16 v[92:95], a[4:7], a[40:43], v[92:95]
    v_mfma_f32_16x16x32_bf16 v[96:99], a[0:3], a[44:47], v[96:99]
    v_mfma_f32_16x16x32_bf16 v[100:103], a[4:7], a[44:47], v[100:103]
    s_waitcnt lgkmcnt(0)
    s_barrier
    v_mfma_f32_16x16x32_bf16 v[32:35], a[48:51], a[60:63], v[32:35]
    ds_read_b64_tr_b16 a[0:1], v24 offset:36864
    v_mfma_f32_16x16x32_bf16 v[36:39], a[52:55], a[60:63], v[36:39]
    ds_read_b64_tr_b16 a[2:3], v24 offset:41472
    v_mfma_f32_16x16x32_bf16 v[104:107], a[56:59], a[60:63], v[104:107]
    ds_read_b64_tr_b16 a[4:5], v24 offset:36896
    v_mfma_f32_16x16x32_bf16 v[40:43], a[48:51], a[64:67], v[40:43]
    ds_read_b64_tr_b16 a[6:7], v24 offset:41504
    v_mfma_f32_16x16x32_bf16 v[44:47], a[52:55], a[64:67], v[44:47]
    ds_read_b64_tr_b16 a[8:9], v117 offset:36864
    v_mfma_f32_16x16x32_bf16 v[108:111], a[56:59], a[64:67], v[108:111]
    ds_read_b64_tr_b16 a[10:11], v117 offset:41472
    v_mfma_f32_16x16x32_bf16 v[48:51], a[48:51], a[68:71], v[48:51]
    ds_read_b128 a[12:15], v14 offset:36864
    v_mfma_f32_16x16x32_bf16 v[52:55], a[52:55], a[68:71], v[52:55]
    ds_read_b128 a[16:19], v15 offset:36864
    v_mfma_f32_16x16x32_bf16 v[112:115], a[56:59], a[68:71], v[112:115]
    ds_read_b128 a[20:23], v16 offset:36864
    v_mfma_f32_16x16x32_bf16 v[56:59], a[48:51], a[72:75], v[56:59]
    ds_read_b128 a[24:27], v17 offset:36864
    v_mfma_f32_16x16x32_bf16 v[60:63], a[52:55], a[72:75], v[60:63]
    ds_read_b128 a[28:31], v18 offset:36864
    v_mfma_f32_16x16x32_bf16 v[64:67], a[48:51], a[76:79], v[64:67]
    ds_read_b128 a[32:35], v19 offset:36864
    v_mfma_f32_16x16x32_bf16 v[68:71], a[52:55], a[76:79], v[68:71]
    ds_read_b128 a[36:39], v20 offset:36864
    v_mfma_f32_16x16x32_bf16 v[72:75], a[48:51], a[80:83], v[72:75]
    ds_read_b128 a[40:43], v21 offset:36864
    v_mfma_f32_16x16x32_bf16 v[76:79], a[52:55], a[80:83], v[76:79]
    ds_read_b128 a[44:47], v22 offset:36864
    v_mfma_f32_16x16x32_bf16 v[80:83], a[48:51], a[84:87], v[80:83]
    v_mfma_f32_16x16x32_bf16 v[84:87], a[52:55], a[84:87], v[84:87]
    v_mfma_f32_16x16x32_bf16 v[88:91], a[48:51], a[88:91], v[88:91]
    v_mfma_f32_16x16x32_bf16 v[92:95], a[52:55], a[88:91], v[92:95]
    v_mfma_f32_16x16x32_bf16 v[96:99], a[48:51], a[92:95], v[96:99]
    v_mfma_f32_16x16x32_bf16 v[100:103], a[52:55], a[92:95], v[100:103]
    s_waitcnt lgkmcnt(8)
    v_mfma_f32_16x16x32_bf16 v[32:35], a[0:3], a[12:15], v[32:35]
    ds_read_b64_tr_b16 a[48:49], v24 offset:46080
    v_mfma_f32_16x16x32_bf16 v[36:39], a[4:7], a[12:15], v[36:39]
    ds_read_b64_tr_b16 a[50:51], v24 offset:50688
    v_mfma_f32_16x16x32_bf16 v[104:107], a[8:11], a[12:15], v[104:107]
    ds_read_b64_tr_b16 a[52:53], v24 offset:46112
    s_waitcnt lgkmcnt(10)
    v_mfma_f32_16x16x32_bf16 v[40:43], a[0:3], a[16:19], v[40:43]
    ds_read_b64_tr_b16 a[54:55], v24 offset:50720
    v_mfma_f32_16x16x32_bf16 v[44:47], a[4:7], a[16:19], v[44:47]
    ds_read_b64_tr_b16 a[56:57], v117 offset:46080
    v_mfma_f32_16x16x32_bf16 v[108:111], a[8:11], a[16:19], v[108:111]
    ds_read_b64_tr_b16 a[58:59], v117 offset:50688
    s_waitcnt lgkmcnt(12)
    v_mfma_f32_16x16x32_bf16 v[48:51], a[0:3], a[20:23], v[48:51]
    ds_read_b128 a[60:63], v14 offset:46080
    v_mfma_f32_16x16x32_bf16 v[52:55], a[4:7], a[20:23], v[52:55]
    ds_read_b128 a[64:67], v15 offset:46080
    v_mfma_f32_16x16x32_bf16 v[112:115], a[8:11], a[20:23], v[112:115]
    ds_read_b128 a[68:71], v16 offset:46080
    s_waitcnt lgkmcnt(14)
    v_mfma_f32_16x16x32_bf16 v[56:59], a[0:3], a[24:27], v[56:59]
    ds_read_b128 a[72:75], v17 offset:46080
    v_mfma_f32_16x16x32_bf16 v[60:63], a[4:7], a[24:27], v[60:63]
    ds_read_b128 a[76:79], v18 offset:46080
    s_waitcnt lgkmcnt(15)
    v_mfma_f32_16x16x32_bf16 v[64:67], a[0:3], a[28:31], v[64:67]
    ds_read_b128 a[80:83], v19 offset:46080
    v_mfma_f32_16x16x32_bf16 v[68:71], a[4:7], a[28:31], v[68:71]
    ds_read_b128 a[84:87], v20 offset:46080
    s_waitcnt lgkmcnt(15)
    v_mfma_f32_16x16x32_bf16 v[72:75], a[0:3], a[32:35], v[72:75]
    ds_read_b128 a[88:91], v21 offset:46080
    v_mfma_f32_16x16x32_bf16 v[76:79], a[4:7], a[32:35], v[76:79]
    ds_read_b128 a[92:95], v22 offset:46080
    v_mfma_f32_16x16x32_bf16 v[80:83], a[0:3], a[36:39], v[80:83]
    v_mfma_f32_16x16x32_bf16 v[84:87], a[4:7], a[36:39], v[84:87]
    s_waitcnt lgkmcnt(15)
    v_mfma_f32_16x16x32_bf16 v[88:91], a[0:3], a[40:43], v[88:91]
    v_mfma_f32_16x16x32_bf16 v[92:95], a[4:7], a[40:43], v[92:95]
    v_mfma_f32_16x16x32_bf16 v[96:99], a[0:3], a[44:47], v[96:99]
    v_mfma_f32_16x16x32_bf16 v[100:103], a[4:7], a[44:47], v[100:103]
    s_waitcnt lgkmcnt(0)
    s_barrier
    v_mfma_f32_16x16x32_bf16 v[32:35], a[48:51], a[60:63], v[32:35]
    ds_read_b64_tr_b16 a[0:1], v23 offset:0
    v_mfma_f32_16x16x32_bf16 v[36:39], a[52:55], a[60:63], v[36:39]
    ds_read_b64_tr_b16 a[2:3], v23 offset:4608
    v_mfma_f32_16x16x32_bf16 v[104:107], a[56:59], a[60:63], v[104:107]
    ds_read_b64_tr_b16 a[4:5], v23 offset:32
    v_mfma_f32_16x16x32_bf16 v[40:43], a[48:51], a[64:67], v[40:43]
    ds_read_b64_tr_b16 a[6:7], v23 offset:4640
    v_mfma_f32_16x16x32_bf16 v[44:47], a[52:55], a[64:67], v[44:47]
    ds_read_b64_tr_b16 a[8:9], v116 offset:0
    v_mfma_f32_16x16x32_bf16 v[108:111], a[56:59], a[64:67], v[108:111]
    ds_read_b64_tr_b16 a[10:11], v116 offset:4608
    v_mfma_f32_16x16x32_bf16 v[48:51], a[48:51], a[68:71], v[48:51]
    ds_read_b128 a[12:15], v5 offset:0
    v_mfma_f32_16x16x32_bf16 v[52:55], a[52:55], a[68:71], v[52:55]
    ds_read_b128 a[16:19], v6 offset:0
    v_mfma_f32_16x16x32_bf16 v[112:115], a[56:59], a[68:71], v[112:115]
    ds_read_b128 a[20:23], v7 offset:0
    v_mfma_f32_16x16x32_bf16 v[56:59], a[48:51], a[72:75], v[56:59]
    ds_read_b128 a[24:27], v8 offset:0
    v_mfma_f32_16x16x32_bf16 v[60:63], a[52:55], a[72:75], v[60:63]
    ds_read_b128 a[28:31], v9 offset:0
    v_mfma_f32_16x16x32_bf16 v[64:67], a[48:51], a[76:79], v[64:67]
    ds_read_b128 a[32:35], v10 offset:0
    v_mfma_f32_16x16x32_bf16 v[68:71], a[52:55], a[76:79], v[68:71]
    ds_read_b128 a[36:39], v11 offset:0
    v_mfma_f32_16x16x32_bf16 v[72:75], a[48:51], a[80:83], v[72:75]
    ds_read_b128 a[40:43], v12 offset:0
    v_mfma_f32_16x16x32_bf16 v[76:79], a[52:55], a[80:83], v[76:79]
    ds_read_b128 a[44:47], v13 offset:0
    v_mfma_f32_16x16x32_bf16 v[80:83], a[48:51], a[84:87], v[80:83]
    v_mfma_f32_16x16x32_bf16 v[84:87], a[52:55], a[84:87], v[84:87]
    v_mfma_f32_16x16x32_bf16 v[88:91], a[48:51], a[88:91], v[88:91]
    v_mfma_f32_16x16x32_bf16 v[92:95], a[52:55], a[88:91], v[92:95]
    v_mfma_f32_16x16x32_bf16 v[96:99], a[48:51], a[92:95], v[96:99]
    v_mfma_f32_16x16x32_bf16 v[100:103], a[52:55], a[92:95], v[100:103]
    s_waitcnt lgkmcnt(8)
    v_mfma_f32_16x16x32_bf16 v[32:35], a[0:3], a[12:15], v[32:35]
    ds_read_b64_tr_b16 a[48:49], v23 offset:9216
    v_mfma_f32_16x16x32_bf16 v[36:39], a[4:7], a[12:15], v[36:39]
    ds_read_b64_tr_b16 a[50:51], v23 offset:13824
    v_mfma_f32_16x16x32_bf16 v[104:107], a[8:11], a[12:15], v[104:107]
    ds_read_b64_tr_b16 a[52:53], v23 offset:9248
    s_waitcnt lgkmcnt(10)
    v_mfma_f32_16x16x32_bf16 v[40:43], a[0:3], a[16:19], v[40:43]
    ds_read_b64_tr_b16 a[54:55], v23 offset:13856
    v_mfma_f32_16x16x32_bf16 v[44:47], a[4:7], a[16:19], v[44:47]
    ds_read_b64_tr_b16 a[56:57], v116 offset:9216
    v_mfma_f32_16x16x32_bf16 v[108:111], a[8:11], a[16:19], v[108:111]
    ds_read_b64_tr_b16 a[58:59], v116 offset:13824
    s_waitcnt lgkmcnt(12)
    v_mfma_f32_16x16x32_bf16 v[48:51], a[0:3], a[20:23], v[48:51]
    ds_read_b128 a[60:63], v5 offset:9216
    v_mfma_f32_16x16x32_bf16 v[52:55], a[4:7], a[20:23], v[52:55]
    ds_read_b128 a[64:67], v6 offset:9216
    v_mfma_f32_16x16x32_bf16 v[112:115], a[8:11], a[20:23], v[112:115]
    ds_read_b128 a[68:71], v7 offset:9216
    s_waitcnt lgkmcnt(14)
    v_mfma_f32_16x16x32_bf16 v[56:59], a[0:3], a[24:27], v[56:59]
    ds_read_b128 a[72:75], v8 offset:9216
    v_mfma_f32_16x16x32_bf16 v[60:63], a[4:7], a[24:27], v[60:63]
    ds_read_b128 a[76:79], v9 offset:9216
    s_waitcnt lgkmcnt(15)
    v_mfma_f32_16x16x32_bf16 v[64:67], a[0:3], a[28:31], v[64:67]
    ds_read_b128 a[80:83], v10 offset:9216
    v_mfma_f32_16x16x32_bf16 v[68:71], a[4:7], a[28:31], v[68:71]
    ds_read_b128 a[84:87], v11 offset:9216
    s_waitcnt lgkmcnt(15)
    v_mfma_f32_16x16x32_bf16 v[72:75], a[0:3], a[32:35], v[72:75]
    ds_read_b128 a[88:91], v12 offset:9216
    v_mfma_f32_16x16x32_bf16 v[76:79], a[4:7], a[32:35], v[76:79]
    ds_read_b128 a[92:95], v13 offset:9216
    v_mfma_f32_16x16x32_bf16 v[80:83], a[0:3], a[36:39], v[80:83]
    v_mfma_f32_16x16x32_bf16 v[84:87], a[4:7], a[36:39], v[84:87]
    s_waitcnt lgkmcnt(15)
    v_mfma_f32_16x16x32_bf16 v[88:91], a[0:3], a[40:43], v[88:91]
    v_mfma_f32_16x16x32_bf16 v[92:95], a[4:7], a[40:43], v[92:95]
    v_mfma_f32_16x16x32_bf16 v[96:99], a[0:3], a[44:47], v[96:99]
    v_mfma_f32_16x16x32_bf16 v[100:103], a[4:7], a[44:47], v[100:103]
    s_waitcnt lgkmcnt(0)
    s_barrier
    v_mfma_f32_16x16x32_bf16 v[32:35], a[48:51], a[60:63], v[32:35]
    ds_read_b64_tr_b16 a[0:1], v23 offset:36864
    v_mfma_f32_16x16x32_bf16 v[36:39], a[52:55], a[60:63], v[36:39]
    ds_read_b64_tr_b16 a[2:3], v23 offset:41472
    v_mfma_f32_16x16x32_bf16 v[104:107], a[56:59], a[60:63], v[104:107]
    ds_read_b64_tr_b16 a[4:5], v23 offset:36896
    v_mfma_f32_16x16x32_bf16 v[40:43], a[48:51], a[64:67], v[40:43]
    ds_read_b64_tr_b16 a[6:7], v23 offset:41504
    v_mfma_f32_16x16x32_bf16 v[44:47], a[52:55], a[64:67], v[44:47]
    ds_read_b64_tr_b16 a[8:9], v116 offset:36864
    v_mfma_f32_16x16x32_bf16 v[108:111], a[56:59], a[64:67], v[108:111]
    ds_read_b64_tr_b16 a[10:11], v116 offset:41472
    v_mfma_f32_16x16x32_bf16 v[48:51], a[48:51], a[68:71], v[48:51]
    ds_read_b128 a[12:15], v5 offset:36864
    v_mfma_f32_16x16x32_bf16 v[52:55], a[52:55], a[68:71], v[52:55]
    ds_read_b128 a[16:19], v6 offset:36864
    v_mfma_f32_16x16x32_bf16 v[112:115], a[56:59], a[68:71], v[112:115]
    ds_read_b128 a[20:23], v7 offset:36864
    v_mfma_f32_16x16x32_bf16 v[56:59], a[48:51], a[72:75], v[56:59]
    ds_read_b128 a[24:27], v8 offset:36864
    v_mfma_f32_16x16x32_bf16 v[60:63], a[52:55], a[72:75], v[60:63]
    ds_read_b128 a[28:31], v9 offset:36864
    v_mfma_f32_16x16x32_bf16 v[64:67], a[48:51], a[76:79], v[64:67]
    ds_read_b128 a[32:35], v10 offset:36864
    v_mfma_f32_16x16x32_bf16 v[68:71], a[52:55], a[76:79], v[68:71]
    ds_read_b128 a[36:39], v11 offset:36864
    v_mfma_f32_16x16x32_bf16 v[72:75], a[48:51], a[80:83], v[72:75]
    ds_read_b128 a[40:43], v12 offset:36864
    v_mfma_f32_16x16x32_bf16 v[76:79], a[52:55], a[80:83], v[76:79]
    ds_read_b128 a[44:47], v13 offset:36864
    v_mfma_f32_16x16x32_bf16 v[80:83], a[48:51], a[84:87], v[80:83]
    v_mfma_f32_16x16x32_bf16 v[84:87], a[52:55], a[84:87], v[84:87]
    v_mfma_f32_16x16x32_bf16 v[88:91], a[48:51], a[88:91], v[88:91]
    v_mfma_f32_16x16x32_bf16 v[92:95], a[52:55], a[88:91], v[92:95]
    v_mfma_f32_16x16x32_bf16 v[96:99], a[48:51], a[92:95], v[96:99]
    v_mfma_f32_16x16x32_bf16 v[100:103], a[52:55], a[92:95], v[100:103]
    s_waitcnt lgkmcnt(8)
    v_mfma_f32_16x16x32_bf16 v[32:35], a[0:3], a[12:15], v[32:35]
    ds_read_b64_tr_b16 a[48:49], v23 offset:46080
    v_mfma_f32_16x16x32_bf16 v[36:39], a[4:7], a[12:15], v[36:39]
    ds_read_b64_tr_b16 a[50:51], v23 offset:50688
    v_mfma_f32_16x16x32_bf16 v[104:107], a[8:11], a[12:15], v[104:107]
    ds_read_b64_tr_b16 a[52:53], v23 offset:46112
    s_waitcnt lgkmcnt(10)
    v_mfma_f32_16x16x32_bf16 v[40:43], a[0:3], a[16:19], v[40:43]
    ds_read_b64_tr_b16 a[54:55], v23 offset:50720
    v_mfma_f32_16x16x32_bf16 v[44:47], a[4:7], a[16:19], v[44:47]
    ds_read_b64_tr_b16 a[56:57], v116 offset:46080
    v_mfma_f32_16x16x32_bf16 v[108:111], a[8:11], a[16:19], v[108:111]
    ds_read_b64_tr_b16 a[58:59], v116 offset:50688
    s_waitcnt lgkmcnt(12)
    v_mfma_f32_16x16x32_bf16 v[48:51], a[0:3], a[20:23], v[48:51]
    ds_read_b128 a[60:63], v5 offset:46080
    v_mfma_f32_16x16x32_bf16 v[52:55], a[4:7], a[20:23], v[52:55]
    ds_read_b128 a[64:67], v6 offset:46080
    v_mfma_f32_16x16x32_bf16 v[112:115], a[8:11], a[20:23], v[112:115]
    ds_read_b128 a[68:71], v7 offset:46080
    s_waitcnt lgkmcnt(14)
    v_mfma_f32_16x16x32_bf16 v[56:59], a[0:3], a[24:27], v[56:59]
    ds_read_b128 a[72:75], v8 offset:46080
    v_mfma_f32_16x16x32_bf16 v[60:63], a[4:7], a[24:27], v[60:63]
    ds_read_b128 a[76:79], v9 offset:46080
    s_waitcnt lgkmcnt(15)
    v_mfma_f32_16x16x32_bf16 v[64:67], a[0:3], a[28:31], v[64:67]
    ds_read_b128 a[80:83], v10 offset:46080
    v_mfma_f32_16x16x32_bf16 v[68:71], a[4:7], a[28:31], v[68:71]
    ds_read_b128 a[84:87], v11 offset:46080
    s_waitcnt lgkmcnt(15)
    v_mfma_f32_16x16x32_bf16 v[72:75], a[0:3], a[32:35], v[72:75]
    ds_read_b128 a[88:91], v12 offset:46080
    v_mfma_f32_16x16x32_bf16 v[76:79], a[4:7], a[32:35], v[76:79]
    ds_read_b128 a[92:95], v13 offset:46080
    v_mfma_f32_16x16x32_bf16 v[80:83], a[0:3], a[36:39], v[80:83]
    v_mfma_f32_16x16x32_bf16 v[84:87], a[4:7], a[36:39], v[84:87]
    s_waitcnt lgkmcnt(15)
    v_mfma_f32_16x16x32_bf16 v[88:91], a[0:3], a[40:43], v[88:91]
    v_mfma_f32_16x16x32_bf16 v[92:95], a[4:7], a[40:43], v[92:95]
    v_mfma_f32_16x16x32_bf16 v[96:99], a[0:3], a[44:47], v[96:99]
    v_mfma_f32_16x16x32_bf16 v[100:103], a[4:7], a[44:47], v[100:103]
    s_waitcnt lgkmcnt(0)
    s_barrier
    v_mfma_f32_16x16x32_bf16 v[32:35], a[48:51], a[60:63], v[32:35]
    ds_read_b64_tr_b16 a[0:1], v24 offset:0
    v_mfma_f32_16x16x32_bf16 v[36:39], a[52:55], a[60:63], v[36:39]
    ds_read_b64_tr_b16 a[2:3], v24 offset:4608
    v_mfma_f32_16x16x32_bf16 v[104:107], a[56:59], a[60:63], v[104:107]
    ds_read_b64_tr_b16 a[4:5], v24 offset:32
    v_mfma_f32_16x16x32_bf16 v[40:43], a[48:51], a[64:67], v[40:43]
    ds_read_b64_tr_b16 a[6:7], v24 offset:4640
    v_mfma_f32_16x16x32_bf16 v[44:47], a[52:55], a[64:67], v[44:47]
    ds_read_b64_tr_b16 a[8:9], v117 offset:0
    v_mfma_f32_16x16x32_bf16 v[108:111], a[56:59], a[64:67], v[108:111]
    ds_read_b64_tr_b16 a[10:11], v117 offset:4608
    v_mfma_f32_16x16x32_bf16 v[48:51], a[48:51], a[68:71], v[48:51]
    ds_read_b128 a[12:15], v14 offset:0
    v_mfma_f32_16x16x32_bf16 v[52:55], a[52:55], a[68:71], v[52:55]
    ds_read_b128 a[16:19], v15 offset:0
    v_mfma_f32_16x16x32_bf16 v[112:115], a[56:59], a[68:71], v[112:115]
    ds_read_b128 a[20:23], v16 offset:0
    v_mfma_f32_16x16x32_bf16 v[56:59], a[48:51], a[72:75], v[56:59]
    ds_read_b128 a[24:27], v17 offset:0
    v_mfma_f32_16x16x32_bf16 v[60:63], a[52:55], a[72:75], v[60:63]
    ds_read_b128 a[28:31], v18 offset:0
    v_mfma_f32_16x16x32_bf16 v[64:67], a[48:51], a[76:79], v[64:67]
    ds_read_b128 a[32:35], v19 offset:0
    v_mfma_f32_16x16x32_bf16 v[68:71], a[52:55], a[76:79], v[68:71]
    ds_read_b128 a[36:39], v20 offset:0
    v_mfma_f32_16x16x32_bf16 v[72:75], a[48:51], a[80:83], v[72:75]
    ds_read_b128 a[40:43], v21 offset:0
    v_mfma_f32_16x16x32_bf16 v[76:79], a[52:55], a[80:83], v[76:79]
    ds_read_b128 a[44:47], v22 offset:0
    v_mfma_f32_16x16x32_bf16 v[80:83], a[48:51], a[84:87], v[80:83]
    v_mfma_f32_16x16x32_bf16 v[84:87], a[52:55], a[84:87], v[84:87]
    v_mfma_f32_16x16x32_bf16 v[88:91], a[48:51], a[88:91], v[88:91]
    v_mfma_f32_16x16x32_bf16 v[92:95], a[52:55], a[88:91], v[92:95]
    v_mfma_f32_16x16x32_bf16 v[96:99], a[48:51], a[92:95], v[96:99]
    v_mfma_f32_16x16x32_bf16 v[100:103], a[52:55], a[92:95], v[100:103]
    s_waitcnt lgkmcnt(8)
    v_mfma_f32_16x16x32_bf16 v[32:35], a[0:3], a[12:15], v[32:35]
    ds_read_b64_tr_b16 a[48:49], v24 offset:9216
    v_mfma_f32_16x16x32_bf16 v[36:39], a[4:7], a[12:15], v[36:39]
    ds_read_b64_tr_b16 a[50:51], v24 offset:13824
    v_mfma_f32_16x16x32_bf16 v[104:107], a[8:11], a[12:15], v[104:107]
    ds_read_b64_tr_b16 a[52:53], v24 offset:9248
    s_waitcnt lgkmcnt(10)
    v_mfma_f32_16x16x32_bf16 v[40:43], a[0:3], a[16:19], v[40:43]
    ds_read_b64_tr_b16 a[54:55], v24 offset:13856
    v_mfma_f32_16x16x32_bf16 v[44:47], a[4:7], a[16:19], v[44:47]
    ds_read_b64_tr_b16 a[56:57], v117 offset:9216
    v_mfma_f32_16x16x32_bf16 v[108:111], a[8:11], a[16:19], v[108:111]
    ds_read_b64_tr_b16 a[58:59], v117 offset:13824
    s_waitcnt lgkmcnt(12)
    v_mfma_f32_16x16x32_bf16 v[48:51], a[0:3], a[20:23], v[48:51]
    ds_read_b128 a[60:63], v14 offset:9216
    v_mfma_f32_16x16x32_bf16 v[52:55], a[4:7], a[20:23], v[52:55]
    ds_read_b128 a[64:67], v15 offset:9216
    v_mfma_f32_16x16x32_bf16 v[112:115], a[8:11], a[20:23], v[112:115]
    ds_read_b128 a[68:71], v16 offset:9216
    s_waitcnt lgkmcnt(14)
    v_mfma_f32_16x16x32_bf16 v[56:59], a[0:3], a[24:27], v[56:59]
    ds_read_b128 a[72:75], v17 offset:9216
    v_mfma_f32_16x16x32_bf16 v[60:63], a[4:7], a[24:27], v[60:63]
    ds_read_b128 a[76:79], v18 offset:9216
    s_waitcnt lgkmcnt(15)
    v_mfma_f32_16x16x32_bf16 v[64:67], a[0:3], a[28:31], v[64:67]
    ds_read_b128 a[80:83], v19 offset:9216
    v_mfma_f32_16x16x32_bf16 v[68:71], a[4:7], a[28:31], v[68:71]
    ds_read_b128 a[84:87], v20 offset:9216
    s_waitcnt lgkmcnt(15)
    v_mfma_f32_16x16x32_bf16 v[72:75], a[0:3], a[32:35], v[72:75]
    ds_read_b128 a[88:91], v21 offset:9216
    v_mfma_f32_16x16x32_bf16 v[76:79], a[4:7], a[32:35], v[76:79]
    ds_read_b128 a[92:95], v22 offset:9216
    v_mfma_f32_16x16x32_bf16 v[80:83], a[0:3], a[36:39], v[80:83]
    v_mfma_f32_16x16x32_bf16 v[84:87], a[4:7], a[36:39], v[84:87]
    s_waitcnt lgkmcnt(15)
    v_mfma_f32_16x16x32_bf16 v[88:91], a[0:3], a[40:43], v[88:91]
    v_mfma_f32_16x16x32_bf16 v[92:95], a[4:7], a[40:43], v[92:95]
    v_mfma_f32_16x16x32_bf16 v[96:99], a[0:3], a[44:47], v[96:99]
    v_mfma_f32_16x16x32_bf16 v[100:103], a[4:7], a[44:47], v[100:103]
    s_waitcnt lgkmcnt(0)
    s_barrier
    v_mfma_f32_16x16x32_bf16 v[32:35], a[48:51], a[60:63], v[32:35]
    ds_read_b64_tr_b16 a[0:1], v24 offset:36864
    v_mfma_f32_16x16x32_bf16 v[36:39], a[52:55], a[60:63], v[36:39]
    ds_read_b64_tr_b16 a[2:3], v24 offset:41472
    v_mfma_f32_16x16x32_bf16 v[104:107], a[56:59], a[60:63], v[104:107]
    ds_read_b64_tr_b16 a[4:5], v24 offset:36896
    v_mfma_f32_16x16x32_bf16 v[40:43], a[48:51], a[64:67], v[40:43]
    ds_read_b64_tr_b16 a[6:7], v24 offset:41504
    v_mfma_f32_16x16x32_bf16 v[44:47], a[52:55], a[64:67], v[44:47]
    ds_read_b64_tr_b16 a[8:9], v117 offset:36864
    v_mfma_f32_16x16x32_bf16 v[108:111], a[56:59], a[64:67], v[108:111]
    ds_read_b64_tr_b16 a[10:11], v117 offset:41472
    v_mfma_f32_16x16x32_bf16 v[48:51], a[48:51], a[68:71], v[48:51]
    ds_read_b128 a[12:15], v14 offset:36864
    v_mfma_f32_16x16x32_bf16 v[52:55], a[52:55], a[68:71], v[52:55]
    ds_read_b128 a[16:19], v15 offset:36864
    v_mfma_f32_16x16x32_bf16 v[112:115], a[56:59], a[68:71], v[112:115]
    ds_read_b128 a[20:23], v16 offset:36864
    v_mfma_f32_16x16x32_bf16 v[56:59], a[48:51], a[72:75], v[56:59]
    ds_read_b128 a[24:27], v17 offset:36864
    v_mfma_f32_16x16x32_bf16 v[60:63], a[52:55], a[72:75], v[60:63]
    ds_read_b128 a[28:31], v18 offset:36864
    v_mfma_f32_16x16x32_bf16 v[64:67], a[48:51], a[76:79], v[64:67]
    ds_read_b128 a[32:35], v19 offset:36864
    v_mfma_f32_16x16x32_bf16 v[68:71], a[52:55], a[76:79], v[68:71]
    ds_read_b128 a[36:39], v20 offset:36864
    v_mfma_f32_16x16x32_bf16 v[72:75], a[48:51], a[80:83], v[72:75]
    ds_read_b128 a[40:43], v21 offset:36864
    v_mfma_f32_16x16x32_bf16 v[76:79], a[52:55], a[80:83], v[76:79]
    ds_read_b128 a[44:47], v22 offset:36864
    v_mfma_f32_16x16x32_bf16 v[80:83], a[48:51], a[84:87], v[80:83]
    v_mfma_f32_16x16x32_bf16 v[84:87], a[52:55], a[84:87], v[84:87]
    v_mfma_f32_16x16x32_bf16 v[88:91], a[48:51], a[88:91], v[88:91]
    v_mfma_f32_16x16x32_bf16 v[92:95], a[52:55], a[88:91], v[92:95]
    v_mfma_f32_16x16x32_bf16 v[96:99], a[48:51], a[92:95], v[96:99]
    v_mfma_f32_16x16x32_bf16 v[100:103], a[52:55], a[92:95], v[100:103]
    s_waitcnt lgkmcnt(8)
    v_mfma_f32_16x16x32_bf16 v[32:35], a[0:3], a[12:15], v[32:35]
    ds_read_b64_tr_b16 a[48:49], v24 offset:46080
    v_mfma_f32_16x16x32_bf16 v[36:39], a[4:7], a[12:15], v[36:39]
    ds_read_b64_tr_b16 a[50:51], v24 offset:50688
    v_mfma_f32_16x16x32_bf16 v[104:107], a[8:11], a[12:15], v[104:107]
    ds_read_b64_tr_b16 a[52:53], v24 offset:46112
    s_waitcnt lgkmcnt(10)
    v_mfma_f32_16x16x32_bf16 v[40:43], a[0:3], a[16:19], v[40:43]
    ds_read_b64_tr_b16 a[54:55], v24 offset:50720
    v_mfma_f32_16x16x32_bf16 v[44:47], a[4:7], a[16:19], v[44:47]
    ds_read_b64_tr_b16 a[56:57], v117 offset:46080
    v_mfma_f32_16x16x32_bf16 v[108:111], a[8:11], a[16:19], v[108:111]
    ds_read_b64_tr_b16 a[58:59], v117 offset:50688
    s_waitcnt lgkmcnt(12)
    v_mfma_f32_16x16x32_bf16 v[48:51], a[0:3], a[20:23], v[48:51]
    ds_read_b128 a[60:63], v14 offset:46080
    v_mfma_f32_16x16x32_bf16 v[52:55], a[4:7], a[20:23], v[52:55]
    ds_read_b128 a[64:67], v15 offset:46080
    v_mfma_f32_16x16x32_bf16 v[112:115], a[8:11], a[20:23], v[112:115]
    ds_read_b128 a[68:71], v16 offset:46080
    s_waitcnt lgkmcnt(14)
    v_mfma_f32_16x16x32_bf16 v[56:59], a[0:3], a[24:27], v[56:59]
    ds_read_b128 a[72:75], v17 offset:46080
    v_mfma_f32_16x16x32_bf16 v[60:63], a[4:7], a[24:27], v[60:63]
    ds_read_b128 a[76:79], v18 offset:46080
    s_waitcnt lgkmcnt(15)
    v_mfma_f32_16x16x32_bf16 v[64:67], a[0:3], a[28:31], v[64:67]
    ds_read_b128 a[80:83], v19 offset:46080
    v_mfma_f32_16x16x32_bf16 v[68:71], a[4:7], a[28:31], v[68:71]
    ds_read_b128 a[84:87], v20 offset:46080
    s_waitcnt lgkmcnt(15)
    v_mfma_f32_16x16x32_bf16 v[72:75], a[0:3], a[32:35], v[72:75]
    ds_read_b128 a[88:91], v21 offset:46080
    v_mfma_f32_16x16x32_bf16 v[76:79], a[4:7], a[32:35], v[76:79]
    ds_read_b128 a[92:95], v22 offset:46080
    v_mfma_f32_16x16x32_bf16 v[80:83], a[0:3], a[36:39], v[80:83]
    v_mfma_f32_16x16x32_bf16 v[84:87], a[4:7], a[36:39], v[84:87]
    s_waitcnt lgkmcnt(15)
    v_mfma_f32_16x16x32_bf16 v[88:91], a[0:3], a[40:43], v[88:91]
    v_mfma_f32_16x16x32_bf16 v[92:95], a[4:7], a[40:43], v[92:95]
    v_mfma_f32_16x16x32_bf16 v[96:99], a[0:3], a[44:47], v[96:99]
    v_mfma_f32_16x16x32_bf16 v[100:103], a[4:7], a[44:47], v[100:103]
    s_waitcnt lgkmcnt(0)
    s_barrier
    v_mfma_f32_16x16x32_bf16 v[32:35], a[48:51], a[60:63], v[32:35]
    ds_read_b64_tr_b16 a[0:1], v23 offset:0
    v_mfma_f32_16x16x32_bf16 v[36:39], a[52:55], a[60:63], v[36:39]
    ds_read_b64_tr_b16 a[2:3], v23 offset:4608
    v_mfma_f32_16x16x32_bf16 v[104:107], a[56:59], a[60:63], v[104:107]
    ds_read_b64_tr_b16 a[4:5], v23 offset:32
    v_mfma_f32_16x16x32_bf16 v[40:43], a[48:51], a[64:67], v[40:43]
    ds_read_b64_tr_b16 a[6:7], v23 offset:4640
    v_mfma_f32_16x16x32_bf16 v[44:47], a[52:55], a[64:67], v[44:47]
    ds_read_b64_tr_b16 a[8:9], v116 offset:0
    v_mfma_f32_16x16x32_bf16 v[108:111], a[56:59], a[64:67], v[108:111]
    ds_read_b64_tr_b16 a[10:11], v116 offset:4608
    v_mfma_f32_16x16x32_bf16 v[48:51], a[48:51], a[68:71], v[48:51]
    ds_read_b128 a[12:15], v5 offset:0
    v_mfma_f32_16x16x32_bf16 v[52:55], a[52:55], a[68:71], v[52:55]
    ds_read_b128 a[16:19], v6 offset:0
    v_mfma_f32_16x16x32_bf16 v[112:115], a[56:59], a[68:71], v[112:115]
    ds_read_b128 a[20:23], v7 offset:0
    v_mfma_f32_16x16x32_bf16 v[56:59], a[48:51], a[72:75], v[56:59]
    ds_read_b128 a[24:27], v8 offset:0
    v_mfma_f32_16x16x32_bf16 v[60:63], a[52:55], a[72:75], v[60:63]
    ds_read_b128 a[28:31], v9 offset:0
    v_mfma_f32_16x16x32_bf16 v[64:67], a[48:51], a[76:79], v[64:67]
    ds_read_b128 a[32:35], v10 offset:0
    v_mfma_f32_16x16x32_bf16 v[68:71], a[52:55], a[76:79], v[68:71]
    ds_read_b128 a[36:39], v11 offset:0
    v_mfma_f32_16x16x32_bf16 v[72:75], a[48:51], a[80:83], v[72:75]
    ds_read_b128 a[40:43], v12 offset:0
    v_mfma_f32_16x16x32_bf16 v[76:79], a[52:55], a[80:83], v[76:79]
    ds_read_b128 a[44:47], v13 offset:0
    v_mfma_f32_16x16x32_bf16 v[80:83], a[48:51], a[84:87], v[80:83]
    v_mfma_f32_16x16x32_bf16 v[84:87], a[52:55], a[84:87], v[84:87]
    v_mfma_f32_16x16x32_bf16 v[88:91], a[48:51], a[88:91], v[88:91]
    v_mfma_f32_16x16x32_bf16 v[92:95], a[52:55], a[88:91], v[92:95]
    v_mfma_f32_16x16x32_bf16 v[96:99], a[48:51], a[92:95], v[96:99]
    v_mfma_f32_16x16x32_bf16 v[100:103], a[52:55], a[92:95], v[100:103]
    s_waitcnt lgkmcnt(8)
    v_mfma_f32_16x16x32_bf16 v[32:35], a[0:3], a[12:15], v[32:35]
    ds_read_b64_tr_b16 a[48:49], v23 offset:9216
    v_mfma_f32_16x16x32_bf16 v[36:39], a[4:7], a[12:15], v[36:39]
    ds_read_b64_tr_b16 a[50:51], v23 offset:13824
    v_mfma_f32_16x16x32_bf16 v[104:107], a[8:11], a[12:15], v[104:107]
    ds_read_b64_tr_b16 a[52:53], v23 offset:9248
    s_waitcnt lgkmcnt(10)
    v_mfma_f32_16x16x32_bf16 v[40:43], a[0:3], a[16:19], v[40:43]
    ds_read_b64_tr_b16 a[54:55], v23 offset:13856
    v_mfma_f32_16x16x32_bf16 v[44:47], a[4:7], a[16:19], v[44:47]
    ds_read_b64_tr_b16 a[56:57], v116 offset:9216
    v_mfma_f32_16x16x32_bf16 v[108:111], a[8:11], a[16:19], v[108:111]
    ds_read_b64_tr_b16 a[58:59], v116 offset:13824
    s_waitcnt lgkmcnt(12)
    v_mfma_f32_16x16x32_bf16 v[48:51], a[0:3], a[20:23], v[48:51]
    ds_read_b128 a[60:63], v5 offset:9216
    v_mfma_f32_16x16x32_bf16 v[52:55], a[4:7], a[20:23], v[52:55]
    ds_read_b128 a[64:67], v6 offset:9216
    v_mfma_f32_16x16x32_bf16 v[112:115], a[8:11], a[20:23], v[112:115]
    ds_read_b128 a[68:71], v7 offset:9216
    s_waitcnt lgkmcnt(14)
    v_mfma_f32_16x16x32_bf16 v[56:59], a[0:3], a[24:27], v[56:59]
    ds_read_b128 a[72:75], v8 offset:9216
    v_mfma_f32_16x16x32_bf16 v[60:63], a[4:7], a[24:27], v[60:63]
    ds_read_b128 a[76:79], v9 offset:9216
    s_cmp_eq_u32 s24, 0
    s_cbranch_scc0 L_m_nocpf2
    buffer_load_dword v156, v155, s[64:67], s63 offen
L_m_nocpf2:
    s_waitcnt lgkmcnt(15)
    v_mfma_f32_16x16x32_bf16 v[64:67], a[0:3], a[28:31], v[64:67]
    ds_read_b128 a[80:83], v10 offset:9216
    v_mfma_f32_16x16x32_bf16 v[68:71], a[4:7], a[28:31], v[68:71]
    ds_read_b128 a[84:87], v11 offset:9216
    s_waitcnt lgkmcnt(15)
    v_mfma_f32_16x16x32_bf16 v[72:75], a[0:3], a[32:35], v[72:75]
    ds_read_b128 a[88:91], v12 offset:9216
    v_mfma_f32_16x16x32_bf16 v[76:79], a[4:7], a[32:35], v[76:79]
    ds_read_b128 a[92:95], v13 offset:9216
    v_mfma_f32_16x16x32_bf16 v[80:83], a[0:3], a[36:39], v[80:83]
    v_mfma_f32_16x16x32_bf16 v[84:87], a[4:7], a[36:39], v[84:87]
    s_waitcnt lgkmcnt(15)
    v_mfma_f32_16x16x32_bf16 v[88:91], a[0:3], a[40:43], v[88:91]
    v_mfma_f32_16x16x32_bf16 v[92:95], a[4:7], a[40:43], v[92:95]
    v_mfma_f32_16x16x32_bf16 v[96:99], a[0:3], a[44:47], v[96:99]
    v_mfma_f32_16x16x32_bf16 v[100:103], a[4:7], a[44:47], v[100:103]
    s_waitcnt lgkmcnt(0)
    s_barrier
    v_mfma_f32_16x16x32_bf16 v[32:35], a[48:51], a[60:63], v[32:35]
    ds_read_b64_tr_b16 a[0:1], v23 offset:36864
    v_mfma_f32_16x16x32_bf16 v[36:39], a[52:55], a[60:63], v[36:39]
    ds_read_b64_tr_b16 a[2:3], v23 offset:41472
    v_mfma_f32_16x16x32_bf16 v[104:107], a[56:59], a[60:63], v[104:107]
    ds_read_b64_tr_b16 a[4:5], v23 offset:36896
    v_mfma_f32_16x16x32_bf16 v[40:43], a[48:51], a[64:67], v[40:43]
    ds_read_b64_tr_b16 a[6:7], v23 offset:41504
    v_mfma_f32_16x16x32_bf16 v[44:47], a[52:55], a[64:67], v[44:47]
    ds_read_b64_tr_b16 a[8:9], v116 offset:36864
    v_mfma_f32_16x16x32_bf16 v[108:111], a[56:59], a[64:67], v[108:111]
    ds_read_b64_tr_b16 a[10:11], v116 offset:41472
    v_mfma_f32_16x16x32_bf16 v[48:51], a[48:51], a[68:71], v[48:51]
    ds_read_b128 a[12:15], v5 offset:36864
    v_mfma_f32_16x16x32_bf16 v[52:55], a[52:55], a[68:71], v[52:55]
    ds_read_b128 a[16:19], v6 offset:36864
    v_mfma_f32_16x16x32_bf16 v[112:115], a[56:59], a[68:71], v[112:115]
    ds_read_b128 a[20:23], v7 offset:36864
    v_mfma_f32_16x16x32_bf16 v[56:59], a[48:51], a[72:75], v[56:59]
    ds_read_b128 a[24:27], v8 offset:36864
    v_mfma_f32_16x16x32_bf16 v[60:63], a[52:55], a[72:75], v[60:63]
    ds_read_b128 a[28:31], v9 offset:36864
    v_mfma_f32_16x16x32_bf16 v[64:67], a[48:51], a[76:79], v[64:67]
    ds_read_b128 a[32:35], v10 offset:36864
    v_mfma_f32_16x16x32_bf16 v[68:71], a[52:55], a[76:79], v[68:71]
    ds_read_b128 a[36:39], v11 offset:36864
    v_mfma_f32_16x16x32_bf16 v[72:75], a[48:51], a[80:83], v[72:75]
    ds_read_b128 a[40:43], v12 offset:36864
    v_mfma_f32_16x16x32_bf16 v[76:79], a[52:55], a[80:83], v[76:79]
    ds_read_b128 a[44:47], v13 offset:36864
    v_mfma_f32_16x16x32_bf16 v[80:83], a[48:51], a[84:87], v[80:83]
    v_mfma_f32_16x16x32_bf16 v[84:87], a[52:55], a[84:87], v[84:87]
    v_mfma_f32_16x16x32_bf16 v[88:91], a[48:51], a[88:91], v[88:91]
    v_mfma_f32_16x16x32_bf16 v[92:95], a[52:55], a[88:91], v[92:95]
    v_mfma_f32_16x16x32_bf16 v[96:99], a[48:51], a[92:95], v[96:99]
    v_mfma_f32_16x16x32_bf16 v[100:103], a[52:55], a[92:95], v[100:103]
    s_waitcnt lgkmcnt(8)
    v_mfma_f32_16x16x32_bf16 v[32:35], a[0:3], a[12:15], v[32:35]
    ds_read_b64_tr_b16 a[48:49], v23 offset:46080
    v_mfma_f32_16x16x32_bf16 v[36:39], a[4:7], a[12:15], v[36:39]
    ds_read_b64_tr_b16 a[50:51], v23 offset:50688
    v_mfma_f32_16x16x32_bf16 v[104:107], a[8:11], a[12:15], v[104:107]
    ds_read_b64_tr_b16 a[52:53], v23 offset:46112
    s_waitcnt lgkmcnt(10)
    v_mfma_f32_16x16x32_bf16 v[40:43], a[0:3], a[16:19], v[40:43]
    ds_read_b64_tr_b16 a[54:55], v23 offset:50720
    v_mfma_f32_16x16x32_bf16 v[44:47], a[4:7], a[16:19], v[44:47]
    ds_read_b64_tr_b16 a[56:57], v116 offset:46080
    v_mfma_f32_16x16x32_bf16 v[108:111], a[8:11], a[16:19], v[108:111]
    ds_read_b64_tr_b16 a[58:59], v116 offset:50688
    s_waitcnt lgkmcnt(12)
    v_mfma_f32_16x16x32_bf16 v[48:51], a[0:3], a[20:23], v[48:51]
    ds_read_b128 a[60:63], v5 offset:46080
    v_mfma_f32_16x16x32_bf16 v[52:55], a[4:7], a[20:23], v[52:55]
    ds_read_b128 a[64:67], v6 offset:46080
    v_mfma_f32_16x16x32_bf16 v[112:115], a[8:11], a[20:23], v[112:115]
    ds_read_b128 a[68:71], v7 offset:46080
    s_waitcnt lgkmcnt(14)
    v_mfma_f32_16x16x32_bf16 v[56:59], a[0:3], a[24:27], v[56:59]
    ds_read_b128 a[72:75], v8 offset:46080
    v_mfma_f32_16x16x32_bf16 v[60:63], a[4:7], a[24:27], v[60:63]
    ds_read_b128 a[76:79], v9 offset:46080
    s_waitcnt lgkmcnt(15)
    v_mfma_f32_16x16x32_bf16 v[64:67], a[0:3], a[28:31], v[64:67]
    ds_read_b128 a[80:83], v10 offset:46080
    v_mfma_f32_16x16x32_bf16 v[68:71], a[4:7], a[28:31], v[68:71]
    ds_read_b128 a[84:87], v11 offset:46080
    s_waitcnt lgkmcnt(15)
    v_mfma_f32_16x16x32_bf16 v[72:75], a[0:3], a[32:35], v[72:75]
    ds_read_b128 a[88:91], v12 offset:46080
    v_mfma_f32_16x16x32_bf16 v[76:79], a[4:7], a[32:35], v[76:79]
    ds_read_b128 a[92:95], v13 offset:46080
    v_mfma_f32_16x16x32_bf16 v[80:83], a[0:3], a[36:39], v[80:83]
    v_mfma_f32_16x16x32_bf16 v[84:87], a[4:7], a[36:39], v[84:87]
    s_waitcnt lgkmcnt(15)
    v_mfma_f32_16x16x32_bf16 v[88:91], a[0:3], a[40:43], v[88:91]
    v_mfma_f32_16x16x32_bf16 v[92:95], a[4:7], a[40:43], v[92:95]
    v_mfma_f32_16x16x32_bf16 v[96:99], a[0:3], a[44:47], v[96:99]
    v_mfma_f32_16x16x32_bf16 v[100:103], a[4:7], a[44:47], v[100:103]
    s_waitcnt lgkmcnt(0)
    s_barrier
    v_mfma_f32_16x16x32_bf16 v[32:35], a[48:51], a[60:63], v[32:35]
    ds_read_b64_tr_b16 a[0:1], v24 offset:0
    v_mfma_f32_16x16x32_bf16 v[36:39], a[52:55], a[60:63], v[36:39]
    ds_read_b64_tr_b16 a[2:3], v24 offset:4608
    v_mfma_f32_16x16x32_bf16 v[104:107], a[56:59], a[60:63], v[104:107]
    ds_read_b64_tr_b16 a[4:5], v24 offset:32
    v_mfma_f32_16x16x32_bf16 v[40:43], a[48:51], a[64:67], v[40:43]
    ds_read_b64_tr_b16 a[6:7], v24 offset:4640
    v_mfma_f32_16x16x32_bf16 v[44:47], a[52:55], a[64:67], v[44:47]
    ds_read_b64_tr_b16 a[8:9], v117 offset:0
    v_mfma_f32_16x16x32_bf16 v[108:111], a[56:59], a[64:67], v[108:111]
    ds_read_b64_tr_b16 a[10:11], v117 offset:4608
    v_mfma_f32_16x16x32_bf16 v[48:51], a[48:51], a[68:71], v[48:51]
    ds_read_b128 a[12:15], v14 offset:0
    v_mfma_f32_16x16x32_bf16 v[52:55], a[52:55], a[68:71], v[52:55]
    ds_read_b128 a[16:19], v15 offset:0
    v_mfma_f32_16x16x32_bf16 v[112:115], a[56:59], a[68:71], v[112:115]
    ds_read_b128 a[20:23], v16 offset:0
    v_mfma_f32_16x16x32_bf16 v[56:59], a[48:51], a[72:75], v[56:59]
    ds_read_b128 a[24:27], v17 offset:0
    v_mfma_f32_16x16x32_bf16 v[60:63], a[52:55], a[72:75], v[60:63]
    ds_read_b128 a[28:31], v18 offset:0
    v_mfma_f32_16x16x32_bf16 v[64:67], a[48:51], a[76:79], v[64:67]
    ds_read_b128 a[32:35], v19 offset:0
    v_mfma_f32_16x16x32_bf16 v[68:71], a[52:55], a[76:79], v[68:71]
    ds_read_b128 a[36:39], v20 offset:0
    v_mfma_f32_16x16x32_bf16 v[72:75], a[48:51], a[80:83], v[72:75]
    ds_read_b128 a[40:43], v21 offset:0
    v_mfma_f32_16x16x32_bf16 v[76:79], a[52:55], a[80:83], v[76:79]
    ds_read_b128 a[44:47], v22 offset:0
    v_mfma_f32_16x16x32_bf16 v[80:83], a[48:51], a[84:87], v[80:83]
    v_mfma_f32_16x16x32_bf16 v[84:87], a[52:55], a[84:87], v[84:87]
    v_mfma_f32_16x16x32_bf16 v[88:91], a[48:51], a[88:91], v[88:91]
    v_mfma_f32_16x16x32_bf16 v[92:95], a[52:55], a[88:91], v[92:95]
    v_mfma_f32_16x16x32_bf16 v[96:99], a[48:51], a[92:95], v[96:99]
    v_mfma_f32_16x16x32_bf16 v[100:103], a[52:55], a[92:95], v[100:103]
    s_waitcnt lgkmcnt(8)
    v_mfma_f32_16x16x32_bf16 v[32:35], a[0:3], a[12:15], v[32:35]
    ds_read_b64_tr_b16 a[48:49], v24 offset:9216
    v_mfma_f32_16x16x32_bf16 v[36:39], a[4:7], a[12:15], v[36:39]
    ds_read_b64_tr_b16 a[50:51], v24 offset:13824
    v_mfma_f32_16x16x32_bf16 v[104:107], a[8:11], a[12:15], v[104:107]
    ds_read_b64_tr_b16 a[52:53], v24 offset:9248
    s_waitcnt lgkmcnt(10)
    v_mfma_f32_16x16x32_bf16 v[40:43], a[0:3], a[16:19], v[40:43]
    ds_read_b64_tr_b16 a[54:55], v24 offset:13856
    v_mfma_f32_16x16x32_bf16 v[44:47], a[4:7], a[16:19], v[44:47]
    ds_read_b64_tr_b16 a[56:57], v117 offset:9216
    v_mfma_f32_16x16x32_bf16 v[108:111], a[8:11], a[16:19], v[108:111]
    ds_read_b64_tr_b16 a[58:59], v117 offset:13824
    s_waitcnt lgkmcnt(12)
    v_mfma_f32_16x16x32_bf16 v[48:51], a[0:3], a[20:23], v[48:51]
    ds_read_b128 a[60:63], v14 offset:9216
    v_mfma_f32_16x16x32_bf16 v[52:55], a[4:7], a[20:23], v[52:55]
    ds_read_b128 a[64:67], v15 offset:9216
    v_mfma_f32_16x16x32_bf16 v[112:115], a[8:11], a[20:23], v[112:115]
    ds_read_b128 a[68:71], v16 offset:9216
    s_waitcnt lgkmcnt(14)
    v_mfma_f32_16x16x32_bf16 v[56:59], a[0:3], a[24:27], v[56:59]
    ds_read_b128 a[72:75], v17 offset:9216
    v_mfma_f32_16x16x32_bf16 v[60:63], a[4:7], a[24:27], v[60:63]
    ds_read_b128 a[76:79], v18 offset:9216
    s_waitcnt lgkmcnt(15)
    v_mfma_f32_16x16x32_bf16 v[64:67], a[0:3], a[28:31], v[64:67]
    ds_read_b128 a[80:83], v19 offset:9216
    v_mfma_f32_16x16x32_bf16 v[68:71], a[4:7], a[28:31], v[68:71]
    ds_read_b128 a[84:87], v20 offset:9216
    s_waitcnt lgkmcnt(15)
    v_mfma_f32_16x16x32_bf16 v[72:75], a[0:3], a[32:35], v[72:75]
    ds_read_b128 a[88:91], v21 offset:9216
    v_mfma_f32_16x16x32_bf16 v[76:79], a[4:7], a[32:35], v[76:79]
    ds_read_b128 a[92:95], v22 offset:9216
    v_mfma_f32_16x16x32_bf16 v[80:83], a[0:3], a[36:39], v[80:83]
    v_mfma_f32_16x16x32_bf16 v[84:87], a[4:7], a[36:39], v[84:87]
    s_waitcnt lgkmcnt(15)
    v_mfma_f32_16x16x32_bf16 v[88:91], a[0:3], a[40:43], v[88:91]
    v_mfma_f32_16x16x32_bf16 v[92:95], a[4:7], a[40:43], v[92:95]
    v_mfma_f32_16x16x32_bf16 v[96:99], a[0:3], a[44:47], v[96:99]
    v_mfma_f32_16x16x32_bf16 v[100:103], a[4:7], a[44:47], v[100:103]
    s_waitcnt lgkmcnt(0)
    s_barrier
    v_mfma_f32_16x16x32_bf16 v[32:35], a[48:51], a[60:63], v[32:35]
    ds_read_b64_tr_b16 a[0:1], v24 offset:36864
    v_mfma_f32_16x16x32_bf16 v[36:39], a[52:55], a[60:63], v[36:39]
    ds_read_b64_tr_b16 a[2:3], v24 offset:41472
    v_mfma_f32_16x16x32_bf16 v[104:107], a[56:59], a[60:63], v[104:107]
    ds_read_b64_tr_b16 a[4:5], v24 offset:36896
    v_mfma_f32_16x16x32_bf16 v[40:43], a[48:51], a[64:67], v[40:43]
    ds_read_b64_tr_b16 a[6:7], v24 offset:41504
    v_mfma_f32_16x16x32_bf16 v[44:47], a[52:55], a[64:67], v[44:47]
    ds_read_b64_tr_b16 a[8:9], v117 offset:36864
    v_mfma_f32_16x16x32_bf16 v[108:111], a[56:59], a[64:67], v[108:111]
    ds_read_b64_tr_b16 a[10:11], v117 offset:41472
    v_mfma_f32_16x16x32_bf16 v[48:51], a[48:51], a[68:71], v[48:51]
    ds_read_b128 a[12:15], v14 offset:36864
    v_mfma_f32_16x16x32_bf16 v[52:55], a[52:55], a[68:71], v[52:55]
    ds_read_b128 a[16:19], v15 offset:36864
    v_mfma_f32_16x16x32_bf16 v[112:115], a[56:59], a[68:71], v[112:115]
    ds_read_b128 a[20:23], v16 offset:36864
    v_mfma_f32_16x16x32_bf16 v[56:59], a[48:51], a[72:75], v[56:59]
    ds_read_b128 a[24:27], v17 offset:36864
    v_mfma_f32_16x16x32_bf16 v[60:63], a[52:55], a[72:75], v[60:63]
    ds_read_b128 a[28:31], v18 offset:36864
    v_mfma_f32_16x16x32_bf16 v[64:67], a[48:51], a[76:79], v[64:67]
    ds_read_b128 a[32:35], v19 offset:36864
    v_mfma_f32_16x16x32_bf16 v[68:71], a[52:55], a[76:79], v[68:71]
    ds_read_b128 a[36:39], v20 offset:36864
    v_mfma_f32_16x16x32_bf16 v[72:75], a[48:51], a[80:83], v[72:75]
    ds_read_b128 a[40:43], v21 offset:36864
    v_mfma_f32_16x16x32_bf16 v[76:79], a[52:55], a[80:83], v[76:79]
    ds_read_b128 a[44:47], v22 offset:36864
    v_mfma_f32_16x16x32_bf16 v[80:83], a[48:51], a[84:87], v[80:83]
    v_mfma_f32_16x16x32_bf16 v[84:87], a[52:55], a[84:87], v[84:87]
    v_mfma_f32_16x16x32_bf16 v[88:91], a[48:51], a[88:91], v[88:91]
    v_mfma_f32_16x16x32_bf16 v[92:95], a[52:55], a[88:91], v[92:95]
    v_mfma_f32_16x16x32_bf16 v[96:99], a[48:51], a[92:95], v[96:99]
    v_mfma_f32_16x16x32_bf16 v[100:103], a[52:55], a[92:95], v[100:103]
    s_waitcnt lgkmcnt(8)
    v_mfma_f32_16x16x32_bf16 v[32:35], a[0:3], a[12:15], v[32:35]
    ds_read_b64_tr_b16 a[48:49], v24 offset:46080
    v_mfma_f32_16x16x32_bf16 v[36:39], a[4:7], a[12:15], v[36:39]
    ds_read_b64_tr_b16 a[50:51], v24 offset:50688
    v_mfma_f32_16x16x32_bf16 v[104:107], a[8:11], a[12:15], v[104:107]
    ds_read_b64_tr_b16 a[52:53], v24 offset:46112
    s_waitcnt lgkmcnt(10)
    v_mfma_f32_16x16x32_bf16 v[40:43], a[0:3], a[16:19], v[40:43]
    ds_read_b64_tr_b16 a[54:55], v24 offset:50720
    v_mfma_f32_16x16x32_bf16 v[44:47], a[4:7], a[16:19], v[44:47]
    ds_read_b64_tr_b16 a[56:57], v117 offset:46080
    v_mfma_f32_16x16x32_bf16 v[108:111], a[8:11], a[16:19], v[108:111]
    ds_read_b64_tr_b16 a[58:59], v117 offset:50688
    s_waitcnt lgkmcnt(12)
    v_mfma_f32_16x16x32_bf16 v[48:51], a[0:3], a[20:23], v[48:51]
    ds_read_b128 a[60:63], v14 offset:46080
    v_mfma_f32_16x16x32_bf16 v[52:55], a[4:7], a[20:23], v[52:55]
    ds_read_b128 a[64:67], v15 offset:46080
    v_mfma_f32_16x16x32_bf16 v[112:115], a[8:11], a[20:23], v[112:115]
    ds_read_b128 a[68:71], v16 offset:46080
    s_waitcnt lgkmcnt(14)
    v_mfma_f32_16x16x32_bf16 v[56:59], a[0:3], a[24:27], v[56:59]
    ds_read_b128 a[72:75], v17 offset:46080
    v_mfma_f32_16x16x32_bf16 v[60:63], a[4:7], a[24:27], v[60:63]
    ds_read_b128 a[76:79], v18 offset:46080
    s_waitcnt lgkmcnt(15)
    v_mfma_f32_16x16x32_bf16 v[64:67], a[0:3], a[28:31], v[64:67]
    ds_read_b128 a[80:83], v19 offset:46080
    v_mfma_f32_16x16x32_bf16 v[68:71], a[4:7], a[28:31], v[68:71]
    ds_read_b128 a[84:87], v20 offset:46080
    s_waitcnt lgkmcnt(15)
    v_mfma_f32_16x16x32_bf16 v[72:75], a[0:3], a[32:35], v[72:75]
    ds_read_b128 a[88:91], v21 offset:46080
    v_mfma_f32_16x16x32_bf16 v[76:79], a[4:7], a[32:35], v[76:79]
    ds_read_b128 a[92:95], v22 offset:46080
    v_mfma_f32_16x16x32_bf16 v[80:83], a[0:3], a[36:39], v[80:83]
    v_mfma_f32_16x16x32_bf16 v[84:87], a[4:7], a[36:39], v[84:87]
    s_waitcnt lgkmcnt(15)
    v_mfma_f32_16x16x32_bf16 v[88:91], a[0:3], a[40:43], v[88:91]
    v_mfma_f32_16x16x32_bf16 v[92:95], a[4:7], a[40:43], v[92:95]
    v_mfma_f32_16x16x32_bf16 v[96:99], a[0:3], a[44:47], v[96:99]
    v_mfma_f32_16x16x32_bf16 v[100:103], a[4:7], a[44:47], v[100:103]
    s_waitcnt lgkmcnt(0)
    s_barrier
    v_mfma_f32_16x16x32_bf16 v[32:35], a[48:51], a[60:63], v[32:35]
    ds_read_b64_tr_b16 a[0:1], v23 offset:0
    v_mfma_f32_16x16x32_bf16 v[36:39], a[52:55], a[60:63], v[36:39]
    ds_read_b64_tr_b16 a[2:3], v23 offset:4608
    v_mfma_f32_16x16x32_bf16 v[104:107], a[56:59], a[60:63], v[104:107]
    ds_read_b64_tr_b16 a[4:5], v23 offset:32
    v_mfma_f32_16x16x32_bf16 v[40:43], a[48:51], a[64:67], v[40:43]
    ds_read_b64_tr_b16 a[6:7], v23 offset:4640
    v_mfma_f32_16x16x32_bf16 v[44:47], a[52:55], a[64:67], v[44:47]
    ds_read_b64_tr_b16 a[8:9], v116 offset:0
    v_mfma_f32_16x16x32_bf16 v[108:111], a[56:59], a[64:67], v[108:111]
    ds_read_b64_tr_b16 a[10:11], v116 offset:4608
    v_mfma_f32_16x16x32_bf16 v[48:51], a[48:51], a[68:71], v[48:51]
    ds_read_b128 a[12:15], v5 offset:0
    v_mfma_f32_16x16x32_bf16 v[52:55], a[52:55], a[68:71], v[52:55]
    ds_read_b128 a[16:19], v6 offset:0
    v_mfma_f32_16x16x32_bf16 v[112:115], a[56:59], a[68:71], v[112:115]
    ds_read_b128 a[20:23], v7 offset:0
    v_mfma_f32_16x16x32_bf16 v[56:59], a[48:51], a[72:75], v[56:59]
    ds_read_b128 a[24:27], v8 offset:0
    v_mfma_f32_16x16x32_bf16 v[60:63], a[52:55], a[72:75], v[60:63]
    ds_read_b128 a[28:31], v9 offset:0
    v_mfma_f32_16x16x32_bf16 v[64:67], a[48:51], a[76:79], v[64:67]
    ds_read_b128 a[32:35], v10 offset:0
    v_mfma_f32_16x16x32_bf16 v[68:71], a[52:55], a[76:79], v[68:71]
    ds_read_b128 a[36:39], v11 offset:0
    v_mfma_f32_16x16x32_bf16 v[72:75], a[48:51], a[80:83], v[72:75]
    ds_read_b128 a[40:43], v12 offset:0
    v_mfma_f32_16x16x32_bf16 v[76:79], a[52:55], a[80:83], v[76:79]
    ds_read_b128 a[44:47], v13 offset:0
    v_mfma_f32_16x16x32_bf16 v[80:83], a[48:51], a[84:87], v[80:83]
    v_mfma_f32_16x16x32_bf16 v[84:87], a[52:55], a[84:87], v[84:87]
    v_mfma_f32_16x16x32_bf16 v[88:91], a[48:51], a[88:91], v[88:91]
    v_mfma_f32_16x16x32_bf16 v[92:95], a[52:55], a[88:91], v[92:95]
    v_mfma_f32_16x16x32_bf16 v[96:99], a[48:51], a[92:95], v[96:99]
    v_mfma_f32_16x16x32_bf16 v[100:103], a[52:55], a[92:95], v[100:103]
    s_waitcnt lgkmcnt(8)
    v_mfma_f32_16x16x32_bf16 v[32:35], a[0:3], a[12:15], v[32:35]
    ds_read_b64_tr_b16 a[48:49], v23 offset:9216
    v_mfma_f32_16x16x32_bf16 v[36:39], a[4:7], a[12:15], v[36:39]
    ds_read_b64_tr_b16 a[50:51], v23 offset:13824
    v_mfma_f32_16x16x32_bf16 v[104:107], a[8:11], a[12:15], v[104:107]
    ds_read_b64_tr_b16 a[52:53], v23 offset:9248
    s_waitcnt lgkmcnt(10)
    v_mfma_f32_16x16x32_bf16 v[40:43], a[0:3], a[16:19], v[40:43]
    ds_read_b64_tr_b16 a[54:55], v23 offset:13856
    v_mfma_f32_16x16x32_bf16 v[44:47], a[4:7], a[16:19], v[44:47]
    ds_read_b64_tr_b16 a[56:57], v116 offset:9216
    v_mfma_f32_16x16x32_bf16 v[108:111], a[8:11], a[16:19], v[108:111]
    ds_read_b64_tr_b16 a[58:59], v116 offset:13824
    s_waitcnt lgkmcnt(12)
    v_mfma_f32_16x16x32_bf16 v[48:51], a[0:3], a[20:23], v[48:51]
    ds_read_b128 a[60:63], v5 offset:9216
    v_mfma_f32_16x16x32_bf16 v[52:55], a[4:7], a[20:23], v[52:55]
    ds_read_b128 a[64:67], v6 offset:9216
    v_mfma_f32_16x16x32_bf16 v[112:115], a[8:11], a[20:23], v[112:115]
    ds_read_b128 a[68:71], v7 offset:9216
    s_waitcnt lgkmcnt(14)
    v_mfma_f32_16x16x32_bf16 v[56:59], a[0:3], a[24:27], v[56:59]
    ds_read_b128 a[72:75], v8 offset:9216
    v_mfma_f32_16x16x32_bf16 v[60:63], a[4:7], a[24:27], v[60:63]
    ds_read_b128 a[76:79], v9 offset:9216
    s_waitcnt lgkmcnt(15)
    v_mfma_f32_16x16x32_bf16 v[64:67], a[0:3], a[28:31], v[64:67]
    ds_read_b128 a[80:83], v10 offset:9216
    v_mfma_f32_16x16x32_bf16 v[68:71], a[4:7], a[28:31], v[68:71]
    ds_read_b128 a[84:87], v11 offset:9216
    s_waitcnt lgkmcnt(15)
    v_mfma_f32_16x16x32_bf16 v[72:75], a[0:3], a[32:35], v[72:75]
    ds_read_b128 a[88:91], v12 offset:9216
    v_mfma_f32_16x16x32_bf16 v[76:79], a[4:7], a[32:35], v[76:79]
    ds_read_b128 a[92:95], v13 offset:9216
    v_mfma_f32_16x16x32_bf16 v[80:83], a[0:3], a[36:39], v[80:83]
    v_mfma_f32_16x16x32_bf16 v[84:87], a[4:7], a[36:39], v[84:87]
    s_waitcnt lgkmcnt(15)
    v_mfma_f32_16x16x32_bf16 v[88:91], a[0:3], a[40:43], v[88:91]
    v_mfma_f32_16x16x32_bf16 v[92:95], a[4:7], a[40:43], v[92:95]
    v_mfma_f32_16x16x32_bf16 v[96:99], a[0:3], a[44:47], v[96:99]
    v_mfma_f32_16x16x32_bf16 v[100:103], a[4:7], a[44:47], v[100:103]
    s_waitcnt lgkmcnt(0)
    s_barrier
    v_mfma_f32_16x16x32_bf16 v[32:35], a[48:51], a[60:63], v[32:35]
    ds_read_b64_tr_b16 a[0:1], v23 offset:36864
    v_mfma_f32_16x16x32_bf16 v[36:39], a[52:55], a[60:63], v[36:39]
    ds_read_b64_tr_b16 a[2:3], v23 offset:41472
    v_mfma_f32_16x16x32_bf16 v[104:107], a[56:59], a[60:63], v[104:107]
    ds_read_b64_tr_b16 a[4:5], v23 offset:36896
    v_mfma_f32_16x16x32_bf16 v[40:43], a[48:51], a[64:67], v[40:43]
    ds_read_b64_tr_b16 a[6:7], v23 offset:41504
    v_mfma_f32_16x16x32_bf16 v[44:47], a[52:55], a[64:67], v[44:47]
    ds_read_b64_tr_b16 a[8:9], v116 offset:36864
    v_mfma_f32_16x16x32_bf16 v[108:111], a[56:59], a[64:67], v[108:111]
    ds_read_b64_tr_b16 a[10:11], v116 offset:41472
    v_mfma_f32_16x16x32_bf16 v[48:51], a[48:51], a[68:71], v[48:51]
    ds_read_b128 a[12:15], v5 offset:36864
    v_mfma_f32_16x16x32_bf16 v[52:55], a[52:55], a[68:71], v[52:55]
    ds_read_b128 a[16:19], v6 offset:36864
    v_mfma_f32_16x16x32_bf16 v[112:115], a[56:59], a[68:71], v[112:115]
    ds_read_b128 a[20:23], v7 offset:36864
    v_mfma_f32_16x16x32_bf16 v[56:59], a[48:51], a[72:75], v[56:59]
    ds_read_b128 a[24:27], v8 offset:36864
    v_mfma_f32_16x16x32_bf16 v[60:63], a[52:55], a[72:75], v[60:63]
    ds_read_b128 a[28:31], v9 offset:36864
    v_mfma_f32_16x16x32_bf16 v[64:67], a[48:51], a[76:79], v[64:67]
    ds_read_b128 a[32:35], v10 offset:36864
    v_mfma_f32_16x16x32_bf16 v[68:71], a[52:55], a[76:79], v[68:71]
    ds_read_b128 a[36:39], v11 offset:36864
    v_mfma_f32_16x16x32_bf16 v[72:75], a[48:51], a[80:83], v[72:75]
    ds_read_b128 a[40:43], v12 offset:36864
    v_mfma_f32_16x16x32_bf16 v[76:79], a[52:55], a[80:83], v[76:79]
    ds_read_b128 a[44:47], v13 offset:36864
    v_mfma_f32_16x16x32_bf16 v[80:83], a[48:51], a[84:87], v[80:83]
    v_mfma_f32_16x16x32_bf16 v[84:87], a[52:55], a[84:87], v[84:87]
    v_mfma_f32_16x16x32_bf16 v[88:91], a[48:51], a[88:91], v[88:91]
    v_mfma_f32_16x16x32_bf16 v[92:95], a[52:55], a[88:91], v[92:95]
    v_mfma_f32_16x16x32_bf16 v[96:99], a[48:51], a[92:95], v[96:99]
    v_mfma_f32_16x16x32_bf16 v[100:103], a[52:55], a[92:95], v[100:103]
    s_waitcnt lgkmcnt(8)
    v_mfma_f32_16x16x32_bf16 v[32:35], a[0:3], a[12:15], v[32:35]
    ds_read_b64_tr_b16 a[48:49], v23 offset:46080
    v_mfma_f32_16x16x32_bf16 v[36:39], a[4:7], a[12:15], v[36:39]
    ds_read_b64_tr_b16 a[50:51], v23 offset:50688
    v_mfma_f32_16x16x32_bf16 v[104:107], a[8:11], a[12:15], v[104:107]
    ds_read_b64_tr_b16 a[52:53], v23 offset:46112
    s_waitcnt lgkmcnt(10)
    v_mfma_f32_16x16x32_bf16 v[40:43], a[0:3], a[16:19], v[40:43]
    ds_read_b64_tr_b16 a[54:55], v23 offset:50720
    v_mfma_f32_16x16x32_bf16 v[44:47], a[4:7], a[16:19], v[44:47]
    ds_read_b64_tr_b16 a[56:57], v116 offset:46080
    v_mfma_f32_16x16x32_bf16 v[108:111], a[8:11], a[16:19], v[108:111]
    ds_read_b64_tr_b16 a[58:59], v116 offset:50688
    s_waitcnt lgkmcnt(12)
    v_mfma_f32_16x16x32_bf16 v[48:51], a[0:3], a[20:23], v[48:51]
    ds_read_b128 a[60:63], v5 offset:46080
    v_mfma_f32_16x16x32_bf16 v[52:55], a[4:7], a[20:23], v[52:55]
    ds_read_b128 a[64:67], v6 offset:46080
    v_mfma_f32_16x16x32_bf16 v[112:115], a[8:11], a[20:23], v[112:115]
    ds_read_b128 a[68:71], v7 offset:46080
    s_waitcnt lgkmcnt(14)
    v_mfma_f32_16x16x32_bf16 v[56:59], a[0:3], a[24:27], v[56:59]
    ds_read_b128 a[72:75], v8 offset:46080
    v_mfma_f32_16x16x32_bf16 v[60:63], a[4:7], a[24:27], v[60:63]
    ds_read_b128 a[76:79], v9 offset:46080
    buffer_load_dword v157, v121, s[52:55], s50 offen
    s_add_u32 s50, s50, 2097152
    s_waitcnt lgkmcnt(15)
    v_mfma_f32_16x16x32_bf16 v[64:67], a[0:3], a[28:31], v[64:67]
    ds_read_b128 a[80:83], v10 offset:46080
    v_mfma_f32_16x16x32_bf16 v[68:71], a[4:7], a[28:31], v[68:71]
    ds_read_b128 a[84:87], v11 offset:46080
    s_waitcnt lgkmcnt(15)
    v_mfma_f32_16x16x32_bf16 v[72:75], a[0:3], a[32:35], v[72:75]
    ds_read_b128 a[88:91], v12 offset:46080
    v_mfma_f32_16x16x32_bf16 v[76:79], a[4:7], a[32:35], v[76:79]
    ds_read_b128 a[92:95], v13 offset:46080
    v_mfma_f32_16x16x32_bf16 v[80:83], a[0:3], a[36:39], v[80:83]
    v_mfma_f32_16x16x32_bf16 v[84:87], a[4:7], a[36:39], v[84:87]
    s_waitcnt lgkmcnt(15)
    v_mfma_f32_16x16x32_bf16 v[88:91], a[0:3], a[40:43], v[88:91]
    v_mfma_f32_16x16x32_bf16 v[92:95], a[4:7], a[40:43], v[92:95]
    v_mfma_f32_16x16x32_bf16 v[96:99], a[0:3], a[44:47], v[96:99]
    v_mfma_f32_16x16x32_bf16 v[100:103], a[4:7], a[44:47], v[100:103]
    s_waitcnt lgkmcnt(0)
    s_barrier
    v_mfma_f32_16x16x32_bf16 v[32:35], a[48:51], a[60:63], v[32:35]
    ds_read_b64_tr_b16 a[0:1], v24 offset:0
    v_mfma_f32_16x16x32_bf16 v[36:39], a[52:55], a[60:63], v[36:39]
    ds_read_b64_tr_b16 a[2:3], v24 offset:4608
    v_mfma_f32_16x16x32_bf16 v[104:107], a[56:59], a[60:63], v[104:107]
    ds_read_b64_tr_b16 a[4:5], v24 offset:32
    v_mfma_f32_16x16x32_bf16 v[40:43], a[48:51], a[64:67], v[40:43]
    ds_read_b64_tr_b16 a[6:7], v24 offset:4640
    v_mfma_f32_16x16x32_bf16 v[44:47], a[52:55], a[64:67], v[44:47]
    ds_read_b64_tr_b16 a[8:9], v117 offset:0
    v_mfma_f32_16x16x32_bf16 v[108:111], a[56:59], a[64:67], v[108:111]
    ds_read_b64_tr_b16 a[10:11], v117 offset:4608
    v_mfma_f32_16x16x32_bf16 v[48:51], a[48:51], a[68:71], v[48:51]
    ds_read_b128 a[12:15], v14 offset:0
    v_mfma_f32_16x16x32_bf16 v[52:55], a[52:55], a[68:71], v[52:55]
    ds_read_b128 a[16:19], v15 offset:0
    v_mfma_f32_16x16x32_bf16 v[112:115], a[56:59], a[68:71], v[112:115]
    ds_read_b128 a[20:23], v16 offset:0
    v_mfma_f32_16x16x32_bf16 v[56:59], a[48:51], a[72:75], v[56:59]
    ds_read_b128 a[24:27], v17 offset:0
    v_mfma_f32_16x16x32_bf16 v[60:63], a[52:55], a[72:75], v[60:63]
    ds_read_b128 a[28:31], v18 offset:0
    v_mfma_f32_16x16x32_bf16 v[64:67], a[48:51], a[76:79], v[64:67]
    ds_read_b128 a[32:35], v19 offset:0
    v_mfma_f32_16x16x32_bf16 v[68:71], a[52:55], a[76:79], v[68:71]
    ds_read_b128 a[36:39], v20 offset:0
    v_mfma_f32_16x16x32_bf16 v[72:75], a[48:51], a[80:83], v[72:75]
    ds_read_b128 a[40:43], v21 offset:0
    v_mfma_f32_16x16x32_bf16 v[76:79], a[52:55], a[80:83], v[76:79]
    ds_read_b128 a[44:47], v22 offset:0
    v_mfma_f32_16x16x32_bf16 v[80:83], a[48:51], a[84:87], v[80:83]
    v_mfma_f32_16x16x32_bf16 v[84:87], a[52:55], a[84:87], v[84:87]
    v_mfma_f32_16x16x32_bf16 v[88:91], a[48:51], a[88:91], v[88:91]
    v_mfma_f32_16x16x32_bf16 v[92:95], a[52:55], a[88:91], v[92:95]
    v_mfma_f32_16x16x32_bf16 v[96:99], a[48:51], a[92:95], v[96:99]
    v_mfma_f32_16x16x32_bf16 v[100:103], a[52:55], a[92:95], v[100:103]
    s_waitcnt lgkmcnt(8)
    v_mfma_f32_16x16x32_bf16 v[32:35], a[0:3], a[12:15], v[32:35]
    ds_read_b64_tr_b16 a[48:49], v24 offset:9216
    v_mfma_f32_16x16x32_bf16 v[36:39], a[4:7], a[12:15], v[36:39]
    ds_read_b64_tr_b16 a[50:51], v24 offset:13824
    v_mfma_f32_16x16x32_bf16 v[104:107], a[8:11], a[12:15], v[104:107]
    ds_read_b64_tr_b16 a[52:53], v24 offset:9248
    s_waitcnt lgkmcnt(10)
    v_mfma_f32_16x16x32_bf16 v[40:43], a[0:3], a[16:19], v[40:43]
    ds_read_b64_tr_b16 a[54:55], v24 offset:13856
    v_mfma_f32_16x16x32_bf16 v[44:47], a[4:7], a[16:19], v[44:47]
    ds_read_b64_tr_b16 a[56:57], v117 offset:9216
    v_mfma_f32_16x16x32_bf16 v[108:111], a[8:11], a[16:19], v[108:111]
    ds_read_b64_tr_b16 a[58:59], v117 offset:13824
    s_waitcnt lgkmcnt(12)
    v_mfma_f32_16x16x32_bf16 v[48:51], a[0:3], a[20:23], v[48:51]
    ds_read_b128 a[60:63], v14 offset:9216
    v_mfma_f32_16x16x32_bf16 v[52:55], a[4:7], a[20:23], v[52:55]
    ds_read_b128 a[64:67], v15 offset:9216
    v_mfma_f32_16x16x32_bf16 v[112:115], a[8:11], a[20:23], v[112:115]
    ds_read_b128 a[68:71], v16 offset:9216
    s_waitcnt lgkmcnt(14)
    v_mfma_f32_16x16x32_bf16 v[56:59], a[0:3], a[24:27], v[56:59]
    ds_read_b128 a[72:75], v17 offset:9216
    v_mfma_f32_16x16x32_bf16 v[60:63], a[4:7], a[24:27], v[60:63]
    ds_read_b128 a[76:79], v18 offset:9216
    s_waitcnt lgkmcnt(15)
    v_mfma_f32_16x16x32_bf16 v[64:67], a[0:3], a[28:31], v[64:67]
    ds_read_b128 a[80:83], v19 offset:9216
    v_mfma_f32_16x16x32_bf16 v[68:71], a[4:7], a[28:31], v[68:71]
    ds_read_b128 a[84:87], v20 offset:9216
    s_waitcnt lgkmcnt(15)
    v_mfma_f32_16x16x32_bf16 v[72:75], a[0:3], a[32:35], v[72:75]
    ds_read_b128 a[88:91], v21 offset:9216
    v_mfma_f32_16x16x32_bf16 v[76:79], a[4:7], a[32:35], v[76:79]
    ds_read_b128 a[92:95], v22 offset:9216
    v_mfma_f32_16x16x32_bf16 v[80:83], a[0:3], a[36:39], v[80:83]
    v_mfma_f32_16x16x32_bf16 v[84:87], a[4:7], a[36:39], v[84:87]
    s_waitcnt lgkmcnt(15)
    v_mfma_f32_16x16x32_bf16 v[88:91], a[0:3], a[40:43], v[88:91]
    v_mfma_f32_16x16x32_bf16 v[92:95], a[4:7], a[40:43], v[92:95]
    v_mfma_f32_16x16x32_bf16 v[96:99], a[0:3], a[44:47], v[96:99]
    v_mfma_f32_16x16x32_bf16 v[100:103], a[4:7], a[44:47], v[100:103]
    s_waitcnt lgkmcnt(0)
    s_barrier
    v_mfma_f32_16x16x32_bf16 v[32:35], a[48:51], a[60:63], v[32:35]
    ds_read_b64_tr_b16 a[0:1], v24 offset:36864
    v_mfma_f32_16x16x32_bf16 v[36:39], a[52:55], a[60:63], v[36:39]
    ds_read_b64_tr_b16 a[2:3], v24 offset:41472
    v_mfma_f32_16x16x32_bf16 v[104:107], a[56:59], a[60:63], v[104:107]
    ds_read_b64_tr_b16 a[4:5], v24 offset:36896
    v_mfma_f32_16x16x32_bf16 v[40:43], a[48:51], a[64:67], v[40:43]
    ds_read_b64_tr_b16 a[6:7], v24 offset:41504
    v_mfma_f32_16x16x32_bf16 v[44:47], a[52:55], a[64:67], v[44:47]
    ds_read_b64_tr_b16 a[8:9], v117 offset:36864
    v_mfma_f32_16x16x32_bf16 v[108:111], a[56:59], a[64:67], v[108:111]
    ds_read_b64_tr_b16 a[10:11], v117 offset:41472
    v_mfma_f32_16x16x32_bf16 v[48:51], a[48:51], a[68:71], v[48:51]
    ds_read_b128 a[12:15], v14 offset:36864
    v_mfma_f32_16x16x32_bf16 v[52:55], a[52:55], a[68:71], v[52:55]
    ds_read_b128 a[16:19], v15 offset:36864
    v_mfma_f32_16x16x32_bf16 v[112:115], a[56:59], a[68:71], v[112:115]
    ds_read_b128 a[20:23], v16 offset:36864
    v_mfma_f32_16x16x32_bf16 v[56:59], a[48:51], a[72:75], v[56:59]
    ds_read_b128 a[24:27], v17 offset:36864
    v_mfma_f32_16x16x32_bf16 v[60:63], a[52:55], a[72:75], v[60:63]
    ds_read_b128 a[28:31], v18 offset:36864
    v_mfma_f32_16x16x32_bf16 v[64:67], a[48:51], a[76:79], v[64:67]
    ds_read_b128 a[32:35], v19 offset:36864
    v_mfma_f32_16x16x32_bf16 v[68:71], a[52:55], a[76:79], v[68:71]
    ds_read_b128 a[36:39], v20 offset:36864
    v_mfma_f32_16x16x32_bf16 v[72:75], a[48:51], a[80:83], v[72:75]
    ds_read_b128 a[40:43], v21 offset:36864
    v_mfma_f32_16x16x32_bf16 v[76:79], a[52:55], a[80:83], v[76:79]
    ds_read_b128 a[44:47], v22 offset:36864
    v_mfma_f32_16x16x32_bf16 v[80:83], a[48:51], a[84:87], v[80:83]
    v_mfma_f32_16x16x32_bf16 v[84:87], a[52:55], a[84:87], v[84:87]
    v_mfma_f32_16x16x32_bf16 v[88:91], a[48:51], a[88:91], v[88:91]
    v_mfma_f32_16x16x32_bf16 v[92:95], a[52:55], a[88:91], v[92:95]
    v_mfma_f32_16x16x32_bf16 v[96:99], a[48:51], a[92:95], v[96:99]
    v_mfma_f32_16x16x32_bf16 v[100:103], a[52:55], a[92:95], v[100:103]
    s_waitcnt lgkmcnt(8)
    v_mfma_f32_16x16x32_bf16 v[32:35], a[0:3], a[12:15], v[32:35]
    ds_read_b64_tr_b16 a[48:49], v24 offset:46080
    v_mfma_f32_16x16x32_bf16 v[36:39], a[4:7], a[12:15], v[36:39]
    ds_read_b64_tr_b16 a[50:51], v24 offset:50688
    v_mfma_f32_16x16x32_bf16 v[104:107], a[8:11], a[12:15], v[104:107]
    ds_read_b64_tr_b16 a[52:53], v24 offset:46112
    s_waitcnt lgkmcnt(10)
    v_mfma_f32_16x16x32_bf16 v[40:43], a[0:3], a[16:19], v[40:43]
    ds_read_b64_tr_b16 a[54:55], v24 offset:50720
    v_mfma_f32_16x16x32_bf16 v[44:47], a[4:7], a[16:19], v[44:47]
    ds_read_b64_tr_b16 a[56:57], v117 offset:46080
    v_mfma_f32_16x16x32_bf16 v[108:111], a[8:11], a[16:19], v[108:111]
    ds_read_b64_tr_b16 a[58:59], v117 offset:50688
    s_waitcnt lgkmcnt(12)
    v_mfma_f32_16x16x32_bf16 v[48:51], a[0:3], a[20:23], v[48:51]
    ds_read_b128 a[60:63], v14 offset:46080
    v_mfma_f32_16x16x32_bf16 v[52:55], a[4:7], a[20:23], v[52:55]
    ds_read_b128 a[64:67], v15 offset:46080
    v_mfma_f32_16x16x32_bf16 v[112:115], a[8:11], a[20:23], v[112:115]
    ds_read_b128 a[68:71], v16 offset:46080
    s_waitcnt lgkmcnt(14)
    v_mfma_f32_16x16x32_bf16 v[56:59], a[0:3], a[24:27], v[56:59]
    ds_read_b128 a[72:75], v17 offset:46080
    v_mfma_f32_16x16x32_bf16 v[60:63], a[4:7], a[24:27], v[60:63]
    ds_read_b128 a[76:79], v18 offset:46080
    s_waitcnt lgkmcnt(15)
    v_mfma_f32_16x16x32_bf16 v[64:67], a[0:3], a[28:31], v[64:67]
    ds_read_b128 a[80:83], v19 offset:46080
    v_mfma_f32_16x16x32_bf16 v[68:71], a[4:7], a[28:31], v[68:71]
    ds_read_b128 a[84:87], v20 offset:46080
    s_waitcnt lgkmcnt(15)
    v_mfma_f32_16x16x32_bf16 v[72:75], a[0:3], a[32:35], v[72:75]
    ds_read_b128 a[88:91], v21 offset:46080
    v_mfma_f32_16x16x32_bf16 v[76:79], a[4:7], a[32:35], v[76:79]
    ds_read_b128 a[92:95], v22 offset:46080
    v_mfma_f32_16x16x32_bf16 v[80:83], a[0:3], a[36:39], v[80:83]
    v_mfma_f32_16x16x32_bf16 v[84:87], a[4:7], a[36:39], v[84:87]
    s_waitcnt lgkmcnt(15)
    v_mfma_f32_16x16x32_bf16 v[88:91], a[0:3], a[40:43], v[88:91]
    v_mfma_f32_16x16x32_bf16 v[92:95], a[4:7], a[40:43], v[92:95]
    v_mfma_f32_16x16x32_bf16 v[96:99], a[0:3], a[44:47], v[96:99]
    v_mfma_f32_16x16x32_bf16 v[100:103], a[4:7], a[44:47], v[100:103]
    s_waitcnt lgkmcnt(0)
    s_barrier
    v_mfma_f32_16x16x32_bf16 v[32:35], a[48:51], a[60:63], v[32:35]
    v_mfma_f32_16x16x32_bf16 v[36:39], a[52:55], a[60:63], v[36:39]
    v_mfma_f32_16x16x32_bf16 v[104:107], a[56:59], a[60:63], v[104:107]
    v_mfma_f32_16x16x32_bf16 v[40:43], a[48:51], a[64:67], v[40:43]
    v_mfma_f32_16x16x32_bf16 v[44:47], a[52:55], a[64:67], v[44:47]
    v_mfma_f32_16x16x32_bf16 v[108:111], a[56:59], a[64:67], v[108:111]
    v_mfma_f32_16x16x32_bf16 v[48:51], a[48:51], a[68:71], v[48:51]
    v_mfma_f32_16x16x32_bf16 v[52:55], a[52:55], a[68:71], v[52:55]
    v_mfma_f32_16x16x32_bf16 v[112:115], a[56:59], a[68:71], v[112:115]
    v_mfma_f32_16x16x32_bf16 v[56:59], a[48:51], a[72:75], v[56:59]
    v_mfma_f32_16x16x32_bf16 v[60:63], a[52:55], a[72:75], v[60:63]
    v_mfma_f32_16x16x32_bf16 v[64:67], a[48:51], a[76:79], v[64:67]
    v_mfma_f32_16x16x32_bf16 v[68:71], a[52:55], a[76:79], v[68:71]
    v_mfma_f32_16x16x32_bf16 v[72:75], a[48:51], a[80:83], v[72:75]
    v_mfma_f32_16x16x32_bf16 v[76:79], a[52:55], a[80:83], v[76:79]
    v_mfma_f32_16x16x32_bf16 v[80:83], a[48:51], a[84:87], v[80:83]
    v_mfma_f32_16x16x32_bf16 v[84:87], a[52:55], a[84:87], v[84:87]
    v_mfma_f32_16x16x32_bf16 v[88:91], a[48:51], a[88:91], v[88:91]
    v_mfma_f32_16x16x32_bf16 v[92:95], a[52:55], a[88:91], v[92:95]
    v_mfma_f32_16x16x32_bf16 v[96:99], a[48:51], a[92:95], v[96:99]
    v_mfma_f32_16x16x32_bf16 v[100:103], a[52:55], a[92:95], v[100:103]
    s_nop 7
    s_nop 7
    s_lshl_b32 s38, s33, 2
    s_add_u32 s38, s38, s34
    s_lshl_b32 s38, s38, 1
    s_xor_b32 s39, s32, 1
    s_add_u32 s39, s38, s39
    s_add_u32 s38, s38, s32
    s_lshl_b32 s39, s39, 2
    s_add_u32 s39, s39, s25
    s_lshl_b32 s38, s38, 2
    s_add_u32 s38, s38, s25
    s_mul_i32 s54, s39, 6144
    s_add_u32 s54, s54, 20971520
    s_mul_i32 s55, s38, 6144
    s_add_u32 s55, s55, 20971520
    s_lshl_b32 s56, s39, 7
    s_add_u32 s56, s56, 31457280
    s_lshl_b32 s57, s38, 7
    s_add_u32 s57, s57, 31457280
    s_mul_i32 s38, s33, 9
    s_lshl_b32 s39, s25, 1
    s_add_u32 s39, s39, s35
    s_add_u32 s38, s38, s39
    s_lshr_b32 s38, s38, 1
    s_mul_i32 s58, s38, 36864
    s_mul_i32 s39, s34, 2304
    s_add_u32 s39, s39, 13631488
    s_add_u32 s58, s58, s39
    s_mul_i32 s38, s33, 9
    s_cmp_eq_u32 s35, 0
    s_cselect_b32 s59, 8, 0
    s_add_u32 s38, s38, s59
    s_and_b32 s59, s38, 1
    s_lshl_b32 s59, s59, 3
    s_lshr_b32 s38, s38, 1
    s_mul_i32 s38, s38, 36864
    s_add_u32 s59, s59, s38
    s_add_u32 s59, s59, s39
    v_mul_u32_u24 v4, 9216, v2
    v_lshlrev_b32 v5, 4, v1
    v_add_u32 v4, v4, v5
    v_mov_b32 v24, 0xc0135761

    v_mov_b32 v20, 0xbdd2d3e8
    v_mov_b32 v22, 1.0
    v_lshlrev_b32 v8, 16, v26
    v_and_b32 v9, 0xffff0000, v26
    v_lshlrev_b32 v10, 16, v27
    v_and_b32 v11, 0xffff0000, v27

    v_lshlrev_b32 v12, 16, v28
    v_and_b32 v13, 0xffff0000, v28
    v_lshlrev_b32 v14, 16, v29
    v_and_b32 v15, 0xffff0000, v29

    v_lshlrev_b32 v16, 16, v30
    v_and_b32 v17, 0xffff0000, v30
    v_lshlrev_b32 v18, 16, v31
    v_and_b32 v19, 0xffff0000, v31

    v_mov_b32 v6, 0
    s_mul_i32 s38, s25, 5120
    s_cmp_eq_u32 s25, 3
    s_cselect_b32 s38, 34816, s38
    s_add_u32 s38, s38, 69632
    v_add_u32 v6, s38, v3
    s_cmp_eq_u32 s32, 0
    s_cbranch_scc0 L_m_t1_k1
    v_cvt_pk_f16_f32 v116, v72, v73
    v_cvt_pk_f16_f32 v117, v74, v75
    v_cvt_pk_f16_f32 v118, v76, v77
    v_cvt_pk_f16_f32 v119, v78, v79
    buffer_store_dwordx4 v[116:119], v3, s[12:15], s54 offen offset:0 sc1
    v_cvt_pk_f16_f32 v120, v80, v81
    v_cvt_pk_f16_f32 v121, v82, v83
    v_cvt_pk_f16_f32 v122, v84, v85
    v_cvt_pk_f16_f32 v123, v86, v87
    buffer_store_dwordx4 v[120:123], v3, s[12:15], s54 offen offset:1024 sc1
    v_cvt_pk_f16_f32 v124, v88, v89
    v_cvt_pk_f16_f32 v125, v90, v91
    v_cvt_pk_f16_f32 v126, v92, v93
    v_cvt_pk_f16_f32 v127, v94, v95
    buffer_store_dwordx4 v[124:127], v3, s[12:15], s54 offen offset:2048 sc1
    v_cvt_pk_f16_f32 v128, v96, v97
    v_cvt_pk_f16_f32 v129, v98, v99
    v_cvt_pk_f16_f32 v130, v100, v101
    v_cvt_pk_f16_f32 v131, v102, v103
    buffer_store_dwordx4 v[128:131], v3, s[12:15], s54 offen offset:3072 sc1
    v_cvt_pk_f16_f32 v132, v104, v105
    v_cvt_pk_f16_f32 v133, v106, v107
    v_cvt_pk_f16_f32 v134, v108, v109
    v_cvt_pk_f16_f32 v135, v110, v111
    s_add_u32 s48, s54, 4096
    buffer_store_dwordx4 v[132:135], v3, s[12:15], s48 offen offset:0 sc1
    ds_write_b128 v6, v[48:51] offset:0
    ds_write_b128 v6, v[52:55] offset:1024
    ds_write_b128 v6, v[56:59] offset:2048
    ds_write_b128 v6, v[60:63] offset:3072
    ds_write_b128 v6, v[68:71] offset:4096
    s_waitcnt lgkmcnt(0)
    s_barrier
    s_waitcnt vmcnt(0)
    v_mov_b32 v140, s28
    v_mov_b32 v141, s28
    v_mov_b32 v142, s28
    v_mov_b32 v143, s28
    s_mov_b64 exec, 15
    buffer_store_dwordx4 v[140:143], v3, s[12:15], s56 offen sc1
    s_mov_b64 exec, -1
    v_mov_b32 v6, 0
    s_mov_b32 s49, 0
    buffer_load_dword v152, v6, s[12:15], s57 offen sc1
L_m_p1c0:
    s_waitcnt vmcnt(0)
    v_readfirstlane_b32 s48, v152
    s_cmp_eq_u32 s48, s28
    s_cbranch_scc1 L_m_p1c0_ok
    s_sleep 1
    buffer_load_dword v152, v6, s[12:15], s57 offen sc1
    s_add_u32 s49, s49, 1
    s_cmp_gt_u32 s49, 8000
    s_cbranch_scc0 L_m_p1c0

L_m_p1c0_ok:
    buffer_load_dwordx4 v[116:119], v3, s[12:15], s55 offen offset:0 sc1
    buffer_load_dwordx4 v[120:123], v3, s[12:15], s55 offen offset:1024 sc1
    s_add_u32 s48, s55, 4096
    buffer_load_dwordx2 v[124:125], v3, s[12:15], s48 offen offset:0 sc1
    s_cmp_eq_u32 s25, 3
    s_cbranch_scc0 L_m_ns2r_0False
    buffer_load_dwordx2 v[126:127], v3, s[12:15], s48 offen offset:1024 sc1
L_m_ns2r_0False:
    s_waitcnt vmcnt(2)
    v_fma_mix_f32 v32, v116, 1.0, v32 op_sel:[0,0,0] op_sel_hi:[1,0,0]
    v_fma_mix_f32 v33, v116, 1.0, v33 op_sel:[1,0,0] op_sel_hi:[1,0,0]
    v_fma_mix_f32 v34, v117, 1.0, v34 op_sel:[0,0,0] op_sel_hi:[1,0,0]
    v_fma_mix_f32 v35, v117, 1.0, v35 op_sel:[1,0,0] op_sel_hi:[1,0,0]
    v_cvt_pk_bf16_f32 v140, v32, v33
    v_cvt_pk_bf16_f32 v141, v34, v35
    v_lshlrev_b32 v32, 16, v140
    v_and_b32 v33, 0xffff0000, v140
    v_lshlrev_b32 v34, 16, v141
    v_and_b32 v35, 0xffff0000, v141
    v_pk_add_f32 v[32:33], v[32:33], v[8:9]
    v_pk_add_f32 v[34:35], v[34:35], v[10:11]
    v_cvt_pk_bf16_f32 v140, v32, v33
    v_cvt_pk_bf16_f32 v141, v34, v35
    v_lshlrev_b32 v32, 16, v140
    v_and_b32 v33, 0xffff0000, v140
    v_lshlrev_b32 v34, 16, v141
    v_and_b32 v35, 0xffff0000, v141
    v_pk_mul_f32 v[140:141], v[32:33], v[32:33]
    v_pk_mul_f32 v[142:143], v[34:35], v[34:35]
    v_pk_fma_f32 v[140:141], v[140:141], v[20:21], v[24:25] op_sel_hi:[1,0,0]
    v_pk_fma_f32 v[142:143], v[142:143], v[20:21], v[24:25] op_sel_hi:[1,0,0]
    v_pk_mul_f32 v[140:141], v[140:141], v[32:33]
    v_pk_mul_f32 v[142:143], v[142:143], v[34:35]
    v_exp_f32 v140, v140
    v_exp_f32 v141, v141
    v_exp_f32 v142, v142
    v_exp_f32 v143, v143
    s_nop 0
    v_pk_add_f32 v[140:141], v[140:141], v[22:23] op_sel_hi:[1,0]
    v_pk_add_f32 v[142:143], v[142:143], v[22:23] op_sel_hi:[1,0]
    v_rcp_f32 v140, v140
    v_rcp_f32 v141, v141
    v_rcp_f32 v142, v142
    v_rcp_f32 v143, v143
    s_nop 0
    v_pk_mul_f32 v[32:33], v[32:33], v[140:141]
    v_pk_mul_f32 v[34:35], v[34:35], v[142:143]
    v_fma_mix_f32 v36, v118, 1.0, v36 op_sel:[0,0,0] op_sel_hi:[1,0,0]
    v_fma_mix_f32 v37, v118, 1.0, v37 op_sel:[1,0,0] op_sel_hi:[1,0,0]
    v_fma_mix_f32 v38, v119, 1.0, v38 op_sel:[0,0,0] op_sel_hi:[1,0,0]
    v_fma_mix_f32 v39, v119, 1.0, v39 op_sel:[1,0,0] op_sel_hi:[1,0,0]
    v_cvt_pk_bf16_f32 v140, v36, v37
    v_cvt_pk_bf16_f32 v141, v38, v39
    v_lshlrev_b32 v36, 16, v140
    v_and_b32 v37, 0xffff0000, v140
    v_lshlrev_b32 v38, 16, v141
    v_and_b32 v39, 0xffff0000, v141
    v_pk_add_f32 v[36:37], v[36:37], v[12:13]
    v_pk_add_f32 v[38:39], v[38:39], v[14:15]
    v_cvt_pk_bf16_f32 v140, v36, v37
    v_cvt_pk_bf16_f32 v141, v38, v39
    v_lshlrev_b32 v36, 16, v140
    v_and_b32 v37, 0xffff0000, v140
    v_lshlrev_b32 v38, 16, v141
    v_and_b32 v39, 0xffff0000, v141
    v_pk_mul_f32 v[140:141], v[36:37], v[36:37]
    v_pk_mul_f32 v[142:143], v[38:39], v[38:39]
    v_pk_fma_f32 v[140:141], v[140:141], v[20:21], v[24:25] op_sel_hi:[1,0,0]
    v_pk_fma_f32 v[142:143], v[142:143], v[20:21], v[24:25] op_sel_hi:[1,0,0]
    v_pk_mul_f32 v[140:141], v[140:141], v[36:37]
    v_pk_mul_f32 v[142:143], v[142:143], v[38:39]
    v_exp_f32 v140, v140
    v_exp_f32 v141, v141
    v_exp_f32 v142, v142
    v_exp_f32 v143, v143
    s_nop 0
    v_pk_add_f32 v[140:141], v[140:141], v[22:23] op_sel_hi:[1,0]
    v_pk_add_f32 v[142:143], v[142:143], v[22:23] op_sel_hi:[1,0]
    v_rcp_f32 v140, v140
    v_rcp_f32 v141, v141
    v_rcp_f32 v142, v142
    v_rcp_f32 v143, v143
    s_nop 0
    v_pk_mul_f32 v[36:37], v[36:37], v[140:141]
    v_pk_mul_f32 v[38:39], v[38:39], v[142:143]
    v_cvt_pk_bf16_f32 v144, v32, v33
    v_cvt_pk_bf16_f32 v145, v34, v35
    v_cvt_pk_bf16_f32 v146, v36, v37
    v_cvt_pk_bf16_f32 v147, v38, v39

    s_lshl_b32 s48, s25, 1
    s_add_u32 s48, s48, 0
    s_cmp_ge_u32 s48, 9
    s_cselect_b32 s39, 9, 0
    s_sub_u32 s48, s48, s39
    s_lshl_b32 s48, s48, 8

    s_add_u32 s48, s48, s58
    buffer_store_dwordx4 v[144:147], v4, s[12:15], s48 offen sc1
    s_waitcnt vmcnt(2)
    v_fma_mix_f32 v40, v120, 1.0, v40 op_sel:[0,0,0] op_sel_hi:[1,0,0]
    v_fma_mix_f32 v41, v120, 1.0, v41 op_sel:[1,0,0] op_sel_hi:[1,0,0]
    v_fma_mix_f32 v42, v121, 1.0, v42 op_sel:[0,0,0] op_sel_hi:[1,0,0]
    v_fma_mix_f32 v43, v121, 1.0, v43 op_sel:[1,0,0] op_sel_hi:[1,0,0]
    v_cvt_pk_bf16_f32 v140, v40, v41
    v_cvt_pk_bf16_f32 v141, v42, v43
    v_lshlrev_b32 v40, 16, v140
    v_and_b32 v41, 0xffff0000, v140
    v_lshlrev_b32 v42, 16, v141
    v_and_b32 v43, 0xffff0000, v141
    v_pk_add_f32 v[40:41], v[40:41], v[8:9]
    v_pk_add_f32 v[42:43], v[42:43], v[10:11]
    v_cvt_pk_bf16_f32 v140, v40, v41
    v_cvt_pk_bf16_f32 v141, v42, v43
    v_lshlrev_b32 v40, 16, v140
    v_and_b32 v41, 0xffff0000, v140
    v_lshlrev_b32 v42, 16, v141
    v_and_b32 v43, 0xffff0000, v141
    v_pk_mul_f32 v[140:141], v[40:41], v[40:41]
    v_pk_mul_f32 v[142:143], v[42:43], v[42:43]
    v_pk_fma_f32 v[140:141], v[140:141], v[20:21], v[24:25] op_sel_hi:[1,0,0]
    v_pk_fma_f32 v[142:143], v[142:143], v[20:21], v[24:25] op_sel_hi:[1,0,0]
    v_pk_mul_f32 v[140:141], v[140:141], v[40:41]
    v_pk_mul_f32 v[142:143], v[142:143], v[42:43]
    v_exp_f32 v140, v140
    v_exp_f32 v141, v141
    v_exp_f32 v142, v142
    v_exp_f32 v143, v143
    s_nop 0
    v_pk_add_f32 v[140:141], v[140:141], v[22:23] op_sel_hi:[1,0]
    v_pk_add_f32 v[142:143], v[142:143], v[22:23] op_sel_hi:[1,0]
    v_rcp_f32 v140, v140
    v_rcp_f32 v141, v141
    v_rcp_f32 v142, v142
    v_rcp_f32 v143, v143
    s_nop 0
    v_pk_mul_f32 v[40:41], v[40:41], v[140:141]
    v_pk_mul_f32 v[42:43], v[42:43], v[142:143]
    v_fma_mix_f32 v44, v122, 1.0, v44 op_sel:[0,0,0] op_sel_hi:[1,0,0]
    v_fma_mix_f32 v45, v122, 1.0, v45 op_sel:[1,0,0] op_sel_hi:[1,0,0]
    v_fma_mix_f32 v46, v123, 1.0, v46 op_sel:[0,0,0] op_sel_hi:[1,0,0]
    v_fma_mix_f32 v47, v123, 1.0, v47 op_sel:[1,0,0] op_sel_hi:[1,0,0]
    v_cvt_pk_bf16_f32 v140, v44, v45
    v_cvt_pk_bf16_f32 v141, v46, v47
    v_lshlrev_b32 v44, 16, v140
    v_and_b32 v45, 0xffff0000, v140
    v_lshlrev_b32 v46, 16, v141
    v_and_b32 v47, 0xffff0000, v141
    v_pk_add_f32 v[44:45], v[44:45], v[12:13]
    v_pk_add_f32 v[46:47], v[46:47], v[14:15]
    v_cvt_pk_bf16_f32 v140, v44, v45
    v_cvt_pk_bf16_f32 v141, v46, v47
    v_lshlrev_b32 v44, 16, v140
    v_and_b32 v45, 0xffff0000, v140
    v_lshlrev_b32 v46, 16, v141
    v_and_b32 v47, 0xffff0000, v141
    v_pk_mul_f32 v[140:141], v[44:45], v[44:45]
    v_pk_mul_f32 v[142:143], v[46:47], v[46:47]
    v_pk_fma_f32 v[140:141], v[140:141], v[20:21], v[24:25] op_sel_hi:[1,0,0]
    v_pk_fma_f32 v[142:143], v[142:143], v[20:21], v[24:25] op_sel_hi:[1,0,0]
    v_pk_mul_f32 v[140:141], v[140:141], v[44:45]
    v_pk_mul_f32 v[142:143], v[142:143], v[46:47]
    v_exp_f32 v140, v140
    v_exp_f32 v141, v141
    v_exp_f32 v142, v142
    v_exp_f32 v143, v143
    s_nop 0
    v_pk_add_f32 v[140:141], v[140:141], v[22:23] op_sel_hi:[1,0]
    v_pk_add_f32 v[142:143], v[142:143], v[22:23] op_sel_hi:[1,0]
    v_rcp_f32 v140, v140
    v_rcp_f32 v141, v141
    v_rcp_f32 v142, v142
    v_rcp_f32 v143, v143
    s_nop 0
    v_pk_mul_f32 v[44:45], v[44:45], v[140:141]
    v_pk_mul_f32 v[46:47], v[46:47], v[142:143]
    v_cvt_pk_bf16_f32 v144, v40, v41
    v_cvt_pk_bf16_f32 v145, v42, v43
    v_cvt_pk_bf16_f32 v146, v44, v45
    v_cvt_pk_bf16_f32 v147, v46, v47

    s_lshl_b32 s48, s25, 1
    s_add_u32 s48, s48, 1
    s_cmp_ge_u32 s48, 9
    s_cselect_b32 s39, 9, 0
    s_sub_u32 s48, s48, s39
    s_lshl_b32 s48, s48, 8

    s_add_u32 s48, s48, s58
    buffer_store_dwordx4 v[144:147], v4, s[12:15], s48 offen sc1
    s_waitcnt vmcnt(2)
    v_fma_mix_f32 v64, v124, 1.0, v64 op_sel:[0,0,0] op_sel_hi:[1,0,0]
    v_fma_mix_f32 v65, v124, 1.0, v65 op_sel:[1,0,0] op_sel_hi:[1,0,0]
    v_fma_mix_f32 v66, v125, 1.0, v66 op_sel:[0,0,0] op_sel_hi:[1,0,0]
    v_fma_mix_f32 v67, v125, 1.0, v67 op_sel:[1,0,0] op_sel_hi:[1,0,0]
    v_cvt_pk_bf16_f32 v140, v64, v65
    v_cvt_pk_bf16_f32 v141, v66, v67
    v_lshlrev_b32 v64, 16, v140
    v_and_b32 v65, 0xffff0000, v140
    v_lshlrev_b32 v66, 16, v141
    v_and_b32 v67, 0xffff0000, v141
    v_pk_add_f32 v[64:65], v[64:65], v[8:9]
    v_pk_add_f32 v[66:67], v[66:67], v[10:11]
    v_cvt_pk_bf16_f32 v140, v64, v65
    v_cvt_pk_bf16_f32 v141, v66, v67
    v_lshlrev_b32 v64, 16, v140
    v_and_b32 v65, 0xffff0000, v140
    v_lshlrev_b32 v66, 16, v141
    v_and_b32 v67, 0xffff0000, v141
    v_pk_mul_f32 v[140:141], v[64:65], v[64:65]
    v_pk_mul_f32 v[142:143], v[66:67], v[66:67]
    v_pk_fma_f32 v[140:141], v[140:141], v[20:21], v[24:25] op_sel_hi:[1,0,0]
    v_pk_fma_f32 v[142:143], v[142:143], v[20:21], v[24:25] op_sel_hi:[1,0,0]
    v_pk_mul_f32 v[140:141], v[140:141], v[64:65]
    v_pk_mul_f32 v[142:143], v[142:143], v[66:67]
    v_exp_f32 v140, v140
    v_exp_f32 v141, v141
    v_exp_f32 v142, v142
    v_exp_f32 v143, v143
    s_nop 0
    v_pk_add_f32 v[140:141], v[140:141], v[22:23] op_sel_hi:[1,0]
    v_pk_add_f32 v[142:143], v[142:143], v[22:23] op_sel_hi:[1,0]
    v_rcp_f32 v140, v140
    v_rcp_f32 v141, v141
    v_rcp_f32 v142, v142
    v_rcp_f32 v143, v143
    s_nop 0
    v_pk_mul_f32 v[64:65], v[64:65], v[140:141]
    v_pk_mul_f32 v[66:67], v[66:67], v[142:143]
    s_lshl_b32 s48, s25, 1
    s_add_u32 s48, s48, 4
    s_cmp_ge_u32 s48, 9
    s_cselect_b32 s39, 9, 0
    s_sub_u32 s48, s48, s39
    s_lshl_b32 s48, s48, 8

    s_add_u32 s48, s48, s58
    v_cvt_pk_bf16_f32 v148, v64, v65
    v_cvt_pk_bf16_f32 v149, v66, v67
    buffer_store_dwordx2 v[148:149], v4, s[12:15], s48 offen offset:0 sc1

    s_cmp_eq_u32 s25, 3
    s_cbranch_scc0 L_m_ns2f_0False
    s_waitcnt vmcnt(3)
    v_fma_mix_f32 v112, v126, 1.0, v112 op_sel:[0,0,0] op_sel_hi:[1,0,0]
    v_fma_mix_f32 v113, v126, 1.0, v113 op_sel:[1,0,0] op_sel_hi:[1,0,0]
    v_fma_mix_f32 v114, v127, 1.0, v114 op_sel:[0,0,0] op_sel_hi:[1,0,0]
    v_fma_mix_f32 v115, v127, 1.0, v115 op_sel:[1,0,0] op_sel_hi:[1,0,0]
    v_cvt_pk_bf16_f32 v140, v112, v113
    v_cvt_pk_bf16_f32 v141, v114, v115
    v_lshlrev_b32 v112, 16, v140
    v_and_b32 v113, 0xffff0000, v140
    v_lshlrev_b32 v114, 16, v141
    v_and_b32 v115, 0xffff0000, v141
    v_pk_add_f32 v[112:113], v[112:113], v[16:17]
    v_pk_add_f32 v[114:115], v[114:115], v[18:19]
    v_cvt_pk_bf16_f32 v140, v112, v113
    v_cvt_pk_bf16_f32 v141, v114, v115
    v_lshlrev_b32 v112, 16, v140
    v_and_b32 v113, 0xffff0000, v140
    v_lshlrev_b32 v114, 16, v141
    v_and_b32 v115, 0xffff0000, v141
    v_pk_mul_f32 v[140:141], v[112:113], v[112:113]
    v_pk_mul_f32 v[142:143], v[114:115], v[114:115]
    v_pk_fma_f32 v[140:141], v[140:141], v[20:21], v[24:25] op_sel_hi:[1,0,0]
    v_pk_fma_f32 v[142:143], v[142:143], v[20:21], v[24:25] op_sel_hi:[1,0,0]
    v_pk_mul_f32 v[140:141], v[140:141], v[112:113]
    v_pk_mul_f32 v[142:143], v[142:143], v[114:115]
    v_exp_f32 v140, v140
    v_exp_f32 v141, v141
    v_exp_f32 v142, v142
    v_exp_f32 v143, v143
    s_nop 0
    v_pk_add_f32 v[140:141], v[140:141], v[22:23] op_sel_hi:[1,0]
    v_pk_add_f32 v[142:143], v[142:143], v[22:23] op_sel_hi:[1,0]
    v_rcp_f32 v140, v140
    v_rcp_f32 v141, v141
    v_rcp_f32 v142, v142
    v_rcp_f32 v143, v143
    s_nop 0
    v_pk_mul_f32 v[112:113], v[112:113], v[140:141]
    v_pk_mul_f32 v[114:115], v[114:115], v[142:143]
    s_lshl_b32 s48, s25, 1
    s_add_u32 s48, s48, 2
    s_cmp_ge_u32 s48, 9
    s_cselect_b32 s39, 9, 0
    s_sub_u32 s48, s48, s39
    s_lshl_b32 s48, s48, 8

    s_add_u32 s48, s48, s59
    v_cvt_pk_bf16_f32 v150, v112, v113
    v_cvt_pk_bf16_f32 v151, v114, v115
    buffer_store_dwordx2 v[150:151], v4, s[12:15], s48 offen sc1

L_m_ns2f_0False:
    s_branch L_m_t1_done
L_m_t1_k1:
    v_cvt_pk_f16_f32 v116, v32, v33
    v_cvt_pk_f16_f32 v117, v34, v35
    v_cvt_pk_f16_f32 v118, v36, v37
    v_cvt_pk_f16_f32 v119, v38, v39
    buffer_store_dwordx4 v[116:119], v3, s[12:15], s54 offen offset:0 sc1
    v_cvt_pk_f16_f32 v120, v40, v41
    v_cvt_pk_f16_f32 v121, v42, v43
    v_cvt_pk_f16_f32 v122, v44, v45
    v_cvt_pk_f16_f32 v123, v46, v47
    buffer_store_dwordx4 v[120:123], v3, s[12:15], s54 offen offset:1024 sc1
    v_cvt_pk_f16_f32 v124, v48, v49
    v_cvt_pk_f16_f32 v125, v50, v51
    v_cvt_pk_f16_f32 v126, v52, v53
    v_cvt_pk_f16_f32 v127, v54, v55
    buffer_store_dwordx4 v[124:127], v3, s[12:15], s54 offen offset:2048 sc1
    v_cvt_pk_f16_f32 v128, v56, v57
    v_cvt_pk_f16_f32 v129, v58, v59
    v_cvt_pk_f16_f32 v130, v60, v61
    v_cvt_pk_f16_f32 v131, v62, v63
    buffer_store_dwordx4 v[128:131], v3, s[12:15], s54 offen offset:3072 sc1
    v_cvt_pk_f16_f32 v132, v64, v65
    v_cvt_pk_f16_f32 v133, v66, v67
    v_cvt_pk_f16_f32 v134, v68, v69
    v_cvt_pk_f16_f32 v135, v70, v71
    s_add_u32 s48, s54, 4096
    buffer_store_dwordx4 v[132:135], v3, s[12:15], s48 offen offset:0 sc1
    s_cmp_eq_u32 s25, 3
    s_cbranch_scc0 L_m_ns2s
    v_cvt_pk_f16_f32 v136, v112, v113
    v_cvt_pk_f16_f32 v137, v114, v115
    buffer_store_dwordx2 v[136:137], v3, s[12:15], s48 offen offset:1024 sc1
L_m_ns2s:
    ds_write_b128 v6, v[88:91] offset:0
    ds_write_b128 v6, v[92:95] offset:1024
    ds_write_b128 v6, v[96:99] offset:2048
    ds_write_b128 v6, v[100:103] offset:3072
    ds_write_b128 v6, v[108:111] offset:4096
    s_waitcnt lgkmcnt(0)
    s_barrier
    s_waitcnt vmcnt(0)
    v_mov_b32 v140, s28
    v_mov_b32 v141, s28
    v_mov_b32 v142, s28
    v_mov_b32 v143, s28
    s_mov_b64 exec, 15
    buffer_store_dwordx4 v[140:143], v3, s[12:15], s56 offen sc1
    s_mov_b64 exec, -1
    v_mov_b32 v6, 0
    s_mov_b32 s49, 0
    buffer_load_dword v152, v6, s[12:15], s57 offen sc1
L_m_p1c1:
    s_waitcnt vmcnt(0)
    v_readfirstlane_b32 s48, v152
    s_cmp_eq_u32 s48, s28
    s_cbranch_scc1 L_m_p1c1_ok
    s_sleep 1
    buffer_load_dword v152, v6, s[12:15], s57 offen sc1
    s_add_u32 s49, s49, 1
    s_cmp_gt_u32 s49, 8000
    s_cbranch_scc0 L_m_p1c1

L_m_p1c1_ok:
    buffer_load_dwordx4 v[116:119], v3, s[12:15], s55 offen offset:0 sc1
    buffer_load_dwordx4 v[120:123], v3, s[12:15], s55 offen offset:1024 sc1
    s_add_u32 s48, s55, 4096
    buffer_load_dwordx2 v[124:125], v3, s[12:15], s48 offen offset:0 sc1
    s_waitcnt vmcnt(2)
    v_fma_mix_f32 v72, v116, 1.0, v72 op_sel:[0,0,0] op_sel_hi:[1,0,0]
    v_fma_mix_f32 v73, v116, 1.0, v73 op_sel:[1,0,0] op_sel_hi:[1,0,0]
    v_fma_mix_f32 v74, v117, 1.0, v74 op_sel:[0,0,0] op_sel_hi:[1,0,0]
    v_fma_mix_f32 v75, v117, 1.0, v75 op_sel:[1,0,0] op_sel_hi:[1,0,0]
    v_cvt_pk_bf16_f32 v140, v72, v73
    v_cvt_pk_bf16_f32 v141, v74, v75
    v_lshlrev_b32 v72, 16, v140
    v_and_b32 v73, 0xffff0000, v140
    v_lshlrev_b32 v74, 16, v141
    v_and_b32 v75, 0xffff0000, v141
    v_pk_add_f32 v[72:73], v[72:73], v[8:9]
    v_pk_add_f32 v[74:75], v[74:75], v[10:11]
    v_cvt_pk_bf16_f32 v140, v72, v73
    v_cvt_pk_bf16_f32 v141, v74, v75
    v_lshlrev_b32 v72, 16, v140
    v_and_b32 v73, 0xffff0000, v140
    v_lshlrev_b32 v74, 16, v141
    v_and_b32 v75, 0xffff0000, v141
    v_pk_mul_f32 v[140:141], v[72:73], v[72:73]
    v_pk_mul_f32 v[142:143], v[74:75], v[74:75]
    v_pk_fma_f32 v[140:141], v[140:141], v[20:21], v[24:25] op_sel_hi:[1,0,0]
    v_pk_fma_f32 v[142:143], v[142:143], v[20:21], v[24:25] op_sel_hi:[1,0,0]
    v_pk_mul_f32 v[140:141], v[140:141], v[72:73]
    v_pk_mul_f32 v[142:143], v[142:143], v[74:75]
    v_exp_f32 v140, v140
    v_exp_f32 v141, v141
    v_exp_f32 v142, v142
    v_exp_f32 v143, v143
    s_nop 0
    v_pk_add_f32 v[140:141], v[140:141], v[22:23] op_sel_hi:[1,0]
    v_pk_add_f32 v[142:143], v[142:143], v[22:23] op_sel_hi:[1,0]
    v_rcp_f32 v140, v140
    v_rcp_f32 v141, v141
    v_rcp_f32 v142, v142
    v_rcp_f32 v143, v143
    s_nop 0
    v_pk_mul_f32 v[72:73], v[72:73], v[140:141]
    v_pk_mul_f32 v[74:75], v[74:75], v[142:143]
    v_fma_mix_f32 v76, v118, 1.0, v76 op_sel:[0,0,0] op_sel_hi:[1,0,0]
    v_fma_mix_f32 v77, v118, 1.0, v77 op_sel:[1,0,0] op_sel_hi:[1,0,0]
    v_fma_mix_f32 v78, v119, 1.0, v78 op_sel:[0,0,0] op_sel_hi:[1,0,0]
    v_fma_mix_f32 v79, v119, 1.0, v79 op_sel:[1,0,0] op_sel_hi:[1,0,0]
    v_cvt_pk_bf16_f32 v140, v76, v77
    v_cvt_pk_bf16_f32 v141, v78, v79
    v_lshlrev_b32 v76, 16, v140
    v_and_b32 v77, 0xffff0000, v140
    v_lshlrev_b32 v78, 16, v141
    v_and_b32 v79, 0xffff0000, v141
    v_pk_add_f32 v[76:77], v[76:77], v[12:13]
    v_pk_add_f32 v[78:79], v[78:79], v[14:15]
    v_cvt_pk_bf16_f32 v140, v76, v77
    v_cvt_pk_bf16_f32 v141, v78, v79
    v_lshlrev_b32 v76, 16, v140
    v_and_b32 v77, 0xffff0000, v140
    v_lshlrev_b32 v78, 16, v141
    v_and_b32 v79, 0xffff0000, v141
    v_pk_mul_f32 v[140:141], v[76:77], v[76:77]
    v_pk_mul_f32 v[142:143], v[78:79], v[78:79]
    v_pk_fma_f32 v[140:141], v[140:141], v[20:21], v[24:25] op_sel_hi:[1,0,0]
    v_pk_fma_f32 v[142:143], v[142:143], v[20:21], v[24:25] op_sel_hi:[1,0,0]
    v_pk_mul_f32 v[140:141], v[140:141], v[76:77]
    v_pk_mul_f32 v[142:143], v[142:143], v[78:79]
    v_exp_f32 v140, v140
    v_exp_f32 v141, v141
    v_exp_f32 v142, v142
    v_exp_f32 v143, v143
    s_nop 0
    v_pk_add_f32 v[140:141], v[140:141], v[22:23] op_sel_hi:[1,0]
    v_pk_add_f32 v[142:143], v[142:143], v[22:23] op_sel_hi:[1,0]
    v_rcp_f32 v140, v140
    v_rcp_f32 v141, v141
    v_rcp_f32 v142, v142
    v_rcp_f32 v143, v143
    s_nop 0
    v_pk_mul_f32 v[76:77], v[76:77], v[140:141]
    v_pk_mul_f32 v[78:79], v[78:79], v[142:143]
    v_cvt_pk_bf16_f32 v144, v72, v73
    v_cvt_pk_bf16_f32 v145, v74, v75
    v_cvt_pk_bf16_f32 v146, v76, v77
    v_cvt_pk_bf16_f32 v147, v78, v79

    s_lshl_b32 s48, s25, 1
    s_add_u32 s48, s48, 5
    s_cmp_ge_u32 s48, 9
    s_cselect_b32 s39, 9, 0
    s_sub_u32 s48, s48, s39
    s_lshl_b32 s48, s48, 8

    s_add_u32 s48, s48, s58
    buffer_store_dwordx4 v[144:147], v4, s[12:15], s48 offen sc1
    s_waitcnt vmcnt(2)
    v_fma_mix_f32 v80, v120, 1.0, v80 op_sel:[0,0,0] op_sel_hi:[1,0,0]
    v_fma_mix_f32 v81, v120, 1.0, v81 op_sel:[1,0,0] op_sel_hi:[1,0,0]
    v_fma_mix_f32 v82, v121, 1.0, v82 op_sel:[0,0,0] op_sel_hi:[1,0,0]
    v_fma_mix_f32 v83, v121, 1.0, v83 op_sel:[1,0,0] op_sel_hi:[1,0,0]
    v_cvt_pk_bf16_f32 v140, v80, v81
    v_cvt_pk_bf16_f32 v141, v82, v83
    v_lshlrev_b32 v80, 16, v140
    v_and_b32 v81, 0xffff0000, v140
    v_lshlrev_b32 v82, 16, v141
    v_and_b32 v83, 0xffff0000, v141
    v_pk_add_f32 v[80:81], v[80:81], v[8:9]
    v_pk_add_f32 v[82:83], v[82:83], v[10:11]
    v_cvt_pk_bf16_f32 v140, v80, v81
    v_cvt_pk_bf16_f32 v141, v82, v83
    v_lshlrev_b32 v80, 16, v140
    v_and_b32 v81, 0xffff0000, v140
    v_lshlrev_b32 v82, 16, v141
    v_and_b32 v83, 0xffff0000, v141
    v_pk_mul_f32 v[140:141], v[80:81], v[80:81]
    v_pk_mul_f32 v[142:143], v[82:83], v[82:83]
    v_pk_fma_f32 v[140:141], v[140:141], v[20:21], v[24:25] op_sel_hi:[1,0,0]
    v_pk_fma_f32 v[142:143], v[142:143], v[20:21], v[24:25] op_sel_hi:[1,0,0]
    v_pk_mul_f32 v[140:141], v[140:141], v[80:81]
    v_pk_mul_f32 v[142:143], v[142:143], v[82:83]
    v_exp_f32 v140, v140
    v_exp_f32 v141, v141
    v_exp_f32 v142, v142
    v_exp_f32 v143, v143
    s_nop 0
    v_pk_add_f32 v[140:141], v[140:141], v[22:23] op_sel_hi:[1,0]
    v_pk_add_f32 v[142:143], v[142:143], v[22:23] op_sel_hi:[1,0]
    v_rcp_f32 v140, v140
    v_rcp_f32 v141, v141
    v_rcp_f32 v142, v142
    v_rcp_f32 v143, v143
    s_nop 0
    v_pk_mul_f32 v[80:81], v[80:81], v[140:141]
    v_pk_mul_f32 v[82:83], v[82:83], v[142:143]
    v_fma_mix_f32 v84, v122, 1.0, v84 op_sel:[0,0,0] op_sel_hi:[1,0,0]
    v_fma_mix_f32 v85, v122, 1.0, v85 op_sel:[1,0,0] op_sel_hi:[1,0,0]
    v_fma_mix_f32 v86, v123, 1.0, v86 op_sel:[0,0,0] op_sel_hi:[1,0,0]
    v_fma_mix_f32 v87, v123, 1.0, v87 op_sel:[1,0,0] op_sel_hi:[1,0,0]
    v_cvt_pk_bf16_f32 v140, v84, v85
    v_cvt_pk_bf16_f32 v141, v86, v87
    v_lshlrev_b32 v84, 16, v140
    v_and_b32 v85, 0xffff0000, v140
    v_lshlrev_b32 v86, 16, v141
    v_and_b32 v87, 0xffff0000, v141
    v_pk_add_f32 v[84:85], v[84:85], v[12:13]
    v_pk_add_f32 v[86:87], v[86:87], v[14:15]
    v_cvt_pk_bf16_f32 v140, v84, v85
    v_cvt_pk_bf16_f32 v141, v86, v87
    v_lshlrev_b32 v84, 16, v140
    v_and_b32 v85, 0xffff0000, v140
    v_lshlrev_b32 v86, 16, v141
    v_and_b32 v87, 0xffff0000, v141
    v_pk_mul_f32 v[140:141], v[84:85], v[84:85]
    v_pk_mul_f32 v[142:143], v[86:87], v[86:87]
    v_pk_fma_f32 v[140:141], v[140:141], v[20:21], v[24:25] op_sel_hi:[1,0,0]
    v_pk_fma_f32 v[142:143], v[142:143], v[20:21], v[24:25] op_sel_hi:[1,0,0]
    v_pk_mul_f32 v[140:141], v[140:141], v[84:85]
    v_pk_mul_f32 v[142:143], v[142:143], v[86:87]
    v_exp_f32 v140, v140
    v_exp_f32 v141, v141
    v_exp_f32 v142, v142
    v_exp_f32 v143, v143
    s_nop 0
    v_pk_add_f32 v[140:141], v[140:141], v[22:23] op_sel_hi:[1,0]
    v_pk_add_f32 v[142:143], v[142:143], v[22:23] op_sel_hi:[1,0]
    v_rcp_f32 v140, v140
    v_rcp_f32 v141, v141
    v_rcp_f32 v142, v142
    v_rcp_f32 v143, v143
    s_nop 0
    v_pk_mul_f32 v[84:85], v[84:85], v[140:141]
    v_pk_mul_f32 v[86:87], v[86:87], v[142:143]
    v_cvt_pk_bf16_f32 v144, v80, v81
    v_cvt_pk_bf16_f32 v145, v82, v83
    v_cvt_pk_bf16_f32 v146, v84, v85
    v_cvt_pk_bf16_f32 v147, v86, v87

    s_lshl_b32 s48, s25, 1
    s_add_u32 s48, s48, 6
    s_cmp_ge_u32 s48, 9
    s_cselect_b32 s39, 9, 0
    s_sub_u32 s48, s48, s39
    s_lshl_b32 s48, s48, 8

    s_add_u32 s48, s48, s58
    buffer_store_dwordx4 v[144:147], v4, s[12:15], s48 offen sc1
    s_waitcnt vmcnt(2)
    v_fma_mix_f32 v104, v124, 1.0, v104 op_sel:[0,0,0] op_sel_hi:[1,0,0]
    v_fma_mix_f32 v105, v124, 1.0, v105 op_sel:[1,0,0] op_sel_hi:[1,0,0]
    v_fma_mix_f32 v106, v125, 1.0, v106 op_sel:[0,0,0] op_sel_hi:[1,0,0]
    v_fma_mix_f32 v107, v125, 1.0, v107 op_sel:[1,0,0] op_sel_hi:[1,0,0]
    v_cvt_pk_bf16_f32 v140, v104, v105
    v_cvt_pk_bf16_f32 v141, v106, v107
    v_lshlrev_b32 v104, 16, v140
    v_and_b32 v105, 0xffff0000, v140
    v_lshlrev_b32 v106, 16, v141
    v_and_b32 v107, 0xffff0000, v141
    v_pk_add_f32 v[104:105], v[104:105], v[16:17]
    v_pk_add_f32 v[106:107], v[106:107], v[18:19]
    v_cvt_pk_bf16_f32 v140, v104, v105
    v_cvt_pk_bf16_f32 v141, v106, v107
    v_lshlrev_b32 v104, 16, v140
    v_and_b32 v105, 0xffff0000, v140
    v_lshlrev_b32 v106, 16, v141
    v_and_b32 v107, 0xffff0000, v141
    v_pk_mul_f32 v[140:141], v[104:105], v[104:105]
    v_pk_mul_f32 v[142:143], v[106:107], v[106:107]
    v_pk_fma_f32 v[140:141], v[140:141], v[20:21], v[24:25] op_sel_hi:[1,0,0]
    v_pk_fma_f32 v[142:143], v[142:143], v[20:21], v[24:25] op_sel_hi:[1,0,0]
    v_pk_mul_f32 v[140:141], v[140:141], v[104:105]
    v_pk_mul_f32 v[142:143], v[142:143], v[106:107]
    v_exp_f32 v140, v140
    v_exp_f32 v141, v141
    v_exp_f32 v142, v142
    v_exp_f32 v143, v143
    s_nop 0
    v_pk_add_f32 v[140:141], v[140:141], v[22:23] op_sel_hi:[1,0]
    v_pk_add_f32 v[142:143], v[142:143], v[22:23] op_sel_hi:[1,0]
    v_rcp_f32 v140, v140
    v_rcp_f32 v141, v141
    v_rcp_f32 v142, v142
    v_rcp_f32 v143, v143
    s_nop 0
    v_pk_mul_f32 v[104:105], v[104:105], v[140:141]
    v_pk_mul_f32 v[106:107], v[106:107], v[142:143]
    s_lshl_b32 s48, s25, 1
    s_add_u32 s48, s48, 0
    s_cmp_ge_u32 s48, 9
    s_cselect_b32 s39, 9, 0
    s_sub_u32 s48, s48, s39
    s_lshl_b32 s48, s48, 8

    s_add_u32 s48, s48, s59
    v_cvt_pk_bf16_f32 v148, v104, v105
    v_cvt_pk_bf16_f32 v149, v106, v107
    buffer_store_dwordx2 v[148:149], v4, s[12:15], s48 offen offset:0 sc1

    s_branch L_m_t1_done
L_m_loader:
    s_cmp_ge_u32 s24, 6
    s_cbranch_scc1 L_m_oload1
    s_cmp_lt_u32 s2, 128
    s_cbranch_scc0 L_m_r1c
    v_mov_b32 v5, v146
    v_mov_b32 v6, v147
    v_mov_b32 v7, v148
    v_mov_b32 v8, v149
    v_mov_b32 v9, v150
    v_mov_b32 v10, v151
    v_mov_b32 v11, v152
    v_mov_b32 v12, v153
    v_mov_b32 v13, v154
    s_branch L_m_r1d
L_m_r1c:
    s_and_b32 s38, s24, 1
    s_mul_i32 s38, s38, 576
    s_mov_b32 s39, 29826162
    s_add_u32 s48, s38, 0
    v_add_u32 v14, s48, v0
    v_mul_hi_u32 v15, v14, s39
    v_mul_u32_u24 v16, 144, v15
    v_sub_u32 v16, v14, v16

    v_mul_u32_u24 v15, 9216, v15
    v_lshlrev_b32 v16, 4, v16
    v_add_u32 v5, v15, v16

    s_add_u32 s48, s38, 64
    v_add_u32 v14, s48, v0
    v_mul_hi_u32 v15, v14, s39
    v_mul_u32_u24 v16, 144, v15
    v_sub_u32 v16, v14, v16

    v_mul_u32_u24 v15, 9216, v15
    v_lshlrev_b32 v16, 4, v16
    v_add_u32 v6, v15, v16

    s_add_u32 s48, s38, 128
    v_add_u32 v14, s48, v0
    v_mul_hi_u32 v15, v14, s39
    v_mul_u32_u24 v16, 144, v15
    v_sub_u32 v16, v14, v16

    v_mul_u32_u24 v15, 9216, v15
    v_lshlrev_b32 v16, 4, v16
    v_add_u32 v7, v15, v16

    s_add_u32 s48, s38, 192
    v_add_u32 v14, s48, v0
    v_mul_hi_u32 v15, v14, s39
    v_mul_u32_u24 v16, 144, v15
    v_sub_u32 v16, v14, v16

    v_mul_u32_u24 v15, 9216, v15
    v_lshlrev_b32 v16, 4, v16
    v_add_u32 v8, v15, v16

    s_add_u32 s48, s38, 256
    v_add_u32 v14, s48, v0
    v_mul_hi_u32 v15, v14, s39
    v_mul_u32_u24 v16, 144, v15
    v_sub_u32 v16, v14, v16

    v_mul_u32_u24 v15, 9216, v15
    v_lshlrev_b32 v16, 4, v16
    v_add_u32 v9, v15, v16

    s_add_u32 s48, s38, 320
    v_add_u32 v14, s48, v0
    v_mul_hi_u32 v15, v14, s39
    v_mul_u32_u24 v16, 144, v15
    v_sub_u32 v16, v14, v16

    v_mul_u32_u24 v15, 9216, v15
    v_lshlrev_b32 v16, 4, v16
    v_add_u32 v10, v15, v16

    s_add_u32 s48, s38, 384
    v_add_u32 v14, s48, v0
    v_mul_hi_u32 v15, v14, s39
    v_mul_u32_u24 v16, 144, v15
    v_sub_u32 v16, v14, v16

    v_mul_u32_u24 v15, 9216, v15
    v_lshlrev_b32 v16, 4, v16
    v_add_u32 v11, v15, v16

    s_add_u32 s48, s38, 448
    v_add_u32 v14, s48, v0
    v_mul_hi_u32 v15, v14, s39
    v_mul_u32_u24 v16, 144, v15
    v_sub_u32 v16, v14, v16

    v_mul_u32_u24 v15, 9216, v15
    v_lshlrev_b32 v16, 4, v16
    v_add_u32 v12, v15, v16

    s_add_u32 s48, s38, 512
    v_add_u32 v14, s48, v0
    v_mul_hi_u32 v15, v14, s39
    v_mul_u32_u24 v16, 144, v15
    v_sub_u32 v16, v14, v16

    v_mul_u32_u24 v15, 9216, v15
    v_lshlrev_b32 v16, 4, v16
    v_add_u32 v13, v15, v16

L_m_r1d:
    s_lshl_b32 s40, s32, 7
    s_mul_i32 s40, s40, 9216
    s_mul_i32 s38, s34, 2304
    s_add_u32 s40, s40, s38
    s_add_u32 s40, s40, 7340032
    s_and_b32 s41, s24, 1
    s_mul_i32 s41, s41, 9216

    s_lshr_b32 s38, s2, 3
    s_and_b32 s38, s38, 15
    s_mul_i32 s38, s38, 4352
    s_lshl_b32 s39, s32, 8
    s_add_u32 s38, s38, s39
    s_add_u32 s38, s38, 19922944
    v_lshlrev_b32 v14, 2, v0
    s_mov_b32 s49, 0

    s_lshr_b32 s38, s2, 3
    s_and_b32 s38, s38, 15
    s_mul_i32 s38, s38, 33152
    s_lshl_b32 s39, s32, 13
    s_add_u32 s38, s38, s39
    s_add_u32 s38, s38, 30408704
    v_lshlrev_b32 v14, 7, v0
    s_lshl_b32 s39, s31, 1
    s_and_b32 s48, s24, 1
    s_add_u32 s39, s39, s48

    s_mov_b32 s49, 0
    s_lshl_b64 exec, 1, s39
L_m_ps2_p1:
    buffer_load_dword v140, v14, s[12:15], s38 offen sc1
    s_waitcnt vmcnt(0)
    v_cmp_ne_u32 vcc, s28, v140
    s_add_u32 s49, s49, 1
    s_cmp_gt_u32 s49, 8000
    s_cbranch_scc1 L_m_ps2_ok
    s_cbranch_vccz L_m_ps2_p1_done
    s_sleep 1
    s_branch L_m_ps2_p1
L_m_ps2_p1_done:
    s_mov_b32 s50, 0xffffffff
    s_mov_b32 s51, 0xffffffff
L_m_ps2_p2:
    s_mov_b64 exec, s[50:51]
    buffer_load_dword v140, v14, s[12:15], s38 offen sc1
    s_waitcnt vmcnt(0)
    s_mov_b64 exec, s[50:51]
    v_cmp_ne_u32 s[50:51], s28, v140
    s_nop 0
    s_add_u32 s49, s49, 1
    s_cmp_gt_u32 s49, 8000
    s_cbranch_scc1 L_m_ps2_ok
    s_cmp_eq_u64 s[50:51], 0
    s_cbranch_scc1 L_m_ps2_ok
    s_sleep 1
    s_branch L_m_ps2_p2
L_m_ps2_ok:
    s_mov_b64 exec, -1
    s_mov_b32 s52, s8
    s_and_b32 s53, s9, 0xffff
    s_mov_b32 s54, 18874368
    s_mov_b32 s55, 0x00020000
    s_sub_u32 s38, s24, 4
    s_lshl_b32 s39, s31, 2
    s_add_u32 s38, s38, s39
    s_lshr_b32 s39, s38, 4
    s_mul_i32 s42, s36, 1152
    s_add_u32 s42, s42, s39
    s_lshl_b32 s42, s42, 12
    s_and_b32 s38, s38, 15
    s_lshl_b32 s38, s38, 7
    s_add_u32 s42, s42, s38
    s_and_b32 s38, s30, 1
    s_lshl_b32 s38, s38, 11
    s_add_u32 s42, s42, s38
    s_add_u32 s42, s42, 0

    s_add_u32 m0, s41, 0
    s_nop 0
    buffer_load_dwordx4 v5, s[12:15], s40 offen  lds
    s_add_u32 m0, s41, 1024
    s_nop 0
    buffer_load_dwordx4 v6, s[12:15], s40 offen  lds
    s_add_u32 m0, s41, 2048
    s_nop 0
    buffer_load_dwordx4 v7, s[12:15], s40 offen  lds
    s_add_u32 m0, s41, 3072
    s_nop 0
    buffer_load_dwordx4 v8, s[12:15], s40 offen  lds
    s_add_u32 m0, s41, 4096
    s_nop 0
    buffer_load_dwordx4 v9, s[12:15], s40 offen  lds
    s_add_u32 m0, s41, 5120
    s_nop 0
    buffer_load_dwordx4 v10, s[12:15], s40 offen  lds
    s_add_u32 m0, s41, 6144
    s_nop 0
    buffer_load_dwordx4 v11, s[12:15], s40 offen  lds
    s_add_u32 m0, s41, 7168
    s_nop 0
    buffer_load_dwordx4 v12, s[12:15], s40 offen  lds
    s_add_u32 m0, s41, 8192
    s_nop 0
    buffer_load_dwordx4 v13, s[12:15], s40 offen  lds
    s_add_u32 s40, s40, 73728
    s_add_u32 m0, s41, 36864
    s_nop 0
    buffer_load_dwordx4 v5, s[12:15], s40 offen  lds
    s_add_u32 m0, s41, 37888
    s_nop 0
    buffer_load_dwordx4 v6, s[12:15], s40 offen  lds
    s_add_u32 m0, s41, 38912
    s_nop 0
    buffer_load_dwordx4 v7, s[12:15], s40 offen  lds
    s_add_u32 m0, s41, 39936
    s_nop 0
    buffer_load_dwordx4 v8, s[12:15], s40 offen  lds
    s_add_u32 m0, s41, 40960
    s_nop 0
    buffer_load_dwordx4 v9, s[12:15], s40 offen  lds
    s_add_u32 m0, s41, 41984
    s_nop 0
    buffer_load_dwordx4 v10, s[12:15], s40 offen  lds
    s_add_u32 m0, s41, 43008
    s_nop 0
    buffer_load_dwordx4 v11, s[12:15], s40 offen  lds
    s_add_u32 m0, s41, 44032
    s_nop 0
    buffer_load_dwordx4 v12, s[12:15], s40 offen  lds
    s_add_u32 m0, s41, 45056
    s_nop 0
    buffer_load_dwordx4 v13, s[12:15], s40 offen  lds
    s_add_u32 s40, s40, 73728
    s_add_u32 m0, s41, 73728
    s_nop 0
    buffer_load_dwordx4 v5, s[12:15], s40 offen  lds
    s_add_u32 m0, s41, 74752
    s_nop 0
    buffer_load_dwordx4 v6, s[12:15], s40 offen  lds
    s_add_u32 m0, s41, 75776
    s_nop 0
    buffer_load_dwordx4 v7, s[12:15], s40 offen  lds
    s_add_u32 m0, s41, 76800
    s_nop 0
    buffer_load_dwordx4 v8, s[12:15], s40 offen  lds
    s_add_u32 m0, s41, 77824
    s_nop 0
    buffer_load_dwordx4 v9, s[12:15], s40 offen  lds
    s_add_u32 m0, s41, 78848
    s_nop 0
    buffer_load_dwordx4 v10, s[12:15], s40 offen  lds
    s_add_u32 m0, s41, 79872
    s_nop 0
    buffer_load_dwordx4 v11, s[12:15], s40 offen  lds
    s_add_u32 m0, s41, 80896
    s_nop 0
    buffer_load_dwordx4 v12, s[12:15], s40 offen  lds
    s_add_u32 m0, s41, 81920
    s_nop 0
    buffer_load_dwordx4 v13, s[12:15], s40 offen  lds
    s_add_u32 s40, s40, 73728
    s_add_u32 m0, s41, 110592
    s_nop 0
    buffer_load_dwordx4 v5, s[12:15], s40 offen  lds
    s_add_u32 m0, s41, 111616
    s_nop 0
    buffer_load_dwordx4 v6, s[12:15], s40 offen  lds
    s_add_u32 m0, s41, 112640
    s_nop 0
    buffer_load_dwordx4 v7, s[12:15], s40 offen  lds
    s_add_u32 m0, s41, 113664
    s_nop 0
    buffer_load_dwordx4 v8, s[12:15], s40 offen  lds
    s_add_u32 m0, s41, 114688
    s_nop 0
    buffer_load_dwordx4 v9, s[12:15], s40 offen  lds
    s_add_u32 m0, s41, 115712
    s_nop 0
    buffer_load_dwordx4 v10, s[12:15], s40 offen  lds
    s_add_u32 m0, s41, 116736
    s_nop 0
    buffer_load_dwordx4 v11, s[12:15], s40 offen  lds
    s_add_u32 m0, s41, 117760
    s_nop 0
    buffer_load_dwordx4 v12, s[12:15], s40 offen  lds
    s_add_u32 m0, s41, 118784
    s_nop 0
    buffer_load_dwordx4 v13, s[12:15], s40 offen  lds
    s_add_u32 s40, s40, 73728
    s_waitcnt vmcnt(27)
    s_barrier
    s_waitcnt vmcnt(18)
    s_barrier
    s_add_u32 m0, s41, 0
    s_nop 0
    buffer_load_dwordx4 v5, s[12:15], s40 offen  lds
    s_add_u32 m0, s41, 1024
    s_nop 0
    buffer_load_dwordx4 v6, s[12:15], s40 offen  lds
    s_add_u32 m0, s41, 2048
    s_nop 0
    buffer_load_dwordx4 v7, s[12:15], s40 offen  lds
    s_add_u32 m0, s41, 3072
    s_nop 0
    buffer_load_dwordx4 v8, s[12:15], s40 offen  lds
    s_add_u32 m0, s41, 4096
    s_nop 0
    buffer_load_dwordx4 v9, s[12:15], s40 offen  lds
    s_add_u32 m0, s41, 5120
    s_nop 0
    buffer_load_dwordx4 v10, s[12:15], s40 offen  lds
    s_add_u32 m0, s41, 6144
    s_nop 0
    buffer_load_dwordx4 v11, s[12:15], s40 offen  lds
    s_add_u32 m0, s41, 7168
    s_nop 0
    buffer_load_dwordx4 v12, s[12:15], s40 offen  lds
    s_add_u32 m0, s41, 8192
    s_nop 0
    buffer_load_dwordx4 v13, s[12:15], s40 offen  lds
    s_add_u32 s40, s40, 73728
    s_buffer_load_dwordx2 s[50:51], s[52:55], s42 offset:60
    s_buffer_load_dwordx2 s[50:51], s[52:55], s42 offset:32828
    s_buffer_load_dwordx2 s[50:51], s[52:55], s42 offset:65596
    s_buffer_load_dwordx2 s[50:51], s[52:55], s42 offset:98364
    s_waitcnt vmcnt(18)
    s_barrier
    s_add_u32 m0, s41, 36864
    s_nop 0
    buffer_load_dwordx4 v5, s[12:15], s40 offen  lds
    s_add_u32 m0, s41, 37888
    s_nop 0
    buffer_load_dwordx4 v6, s[12:15], s40 offen  lds
    s_add_u32 m0, s41, 38912
    s_nop 0
    buffer_load_dwordx4 v7, s[12:15], s40 offen  lds
    s_add_u32 m0, s41, 39936
    s_nop 0
    buffer_load_dwordx4 v8, s[12:15], s40 offen  lds
    s_add_u32 m0, s41, 40960
    s_nop 0
    buffer_load_dwordx4 v9, s[12:15], s40 offen  lds
    s_add_u32 m0, s41, 41984
    s_nop 0
    buffer_load_dwordx4 v10, s[12:15], s40 offen  lds
    s_add_u32 m0, s41, 43008
    s_nop 0
    buffer_load_dwordx4 v11, s[12:15], s40 offen  lds
    s_add_u32 m0, s41, 44032
    s_nop 0
    buffer_load_dwordx4 v12, s[12:15], s40 offen  lds
    s_add_u32 m0, s41, 45056
    s_nop 0
    buffer_load_dwordx4 v13, s[12:15], s40 offen  lds
    s_add_u32 s40, s40, 73728
    s_buffer_load_dwordx2 s[50:51], s[52:55], s42 offset:131132
    s_buffer_load_dwordx2 s[50:51], s[52:55], s42 offset:163900
    s_buffer_load_dwordx2 s[50:51], s[52:55], s42 offset:196668
    s_buffer_load_dwordx2 s[50:51], s[52:55], s42 offset:229436
    s_waitcnt vmcnt(18)
    s_barrier
    s_add_u32 m0, s41, 73728
    s_nop 0
    buffer_load_dwordx4 v5, s[12:15], s40 offen  lds
    s_add_u32 m0, s41, 74752
    s_nop 0
    buffer_load_dwordx4 v6, s[12:15], s40 offen  lds
    s_add_u32 m0, s41, 75776
    s_nop 0
    buffer_load_dwordx4 v7, s[12:15], s40 offen  lds
    s_add_u32 m0, s41, 76800
    s_nop 0
    buffer_load_dwordx4 v8, s[12:15], s40 offen  lds
    s_add_u32 m0, s41, 77824
    s_nop 0
    buffer_load_dwordx4 v9, s[12:15], s40 offen  lds
    s_add_u32 m0, s41, 78848
    s_nop 0
    buffer_load_dwordx4 v10, s[12:15], s40 offen  lds
    s_add_u32 m0, s41, 79872
    s_nop 0
    buffer_load_dwordx4 v11, s[12:15], s40 offen  lds
    s_add_u32 m0, s41, 80896
    s_nop 0
    buffer_load_dwordx4 v12, s[12:15], s40 offen  lds
    s_add_u32 m0, s41, 81920
    s_nop 0
    buffer_load_dwordx4 v13, s[12:15], s40 offen  lds
    s_add_u32 s40, s40, 73728
    s_buffer_load_dwordx2 s[50:51], s[52:55], s42 offset:262204
    s_buffer_load_dwordx2 s[50:51], s[52:55], s42 offset:294972
    s_buffer_load_dwordx2 s[50:51], s[52:55], s42 offset:327740
    s_buffer_load_dwordx2 s[50:51], s[52:55], s42 offset:360508
    s_waitcnt vmcnt(18)
    s_barrier
    s_add_u32 m0, s41, 110592
    s_nop 0
    buffer_load_dwordx4 v5, s[12:15], s40 offen  lds
    s_add_u32 m0, s41, 111616
    s_nop 0
    buffer_load_dwordx4 v6, s[12:15], s40 offen  lds
    s_add_u32 m0, s41, 112640
    s_nop 0
    buffer_load_dwordx4 v7, s[12:15], s40 offen  lds
    s_add_u32 m0, s41, 113664
    s_nop 0
    buffer_load_dwordx4 v8, s[12:15], s40 offen  lds
    s_add_u32 m0, s41, 114688
    s_nop 0
    buffer_load_dwordx4 v9, s[12:15], s40 offen  lds
    s_add_u32 m0, s41, 115712
    s_nop 0
    buffer_load_dwordx4 v10, s[12:15], s40 offen  lds
    s_add_u32 m0, s41, 116736
    s_nop 0
    buffer_load_dwordx4 v11, s[12:15], s40 offen  lds
    s_add_u32 m0, s41, 117760
    s_nop 0
    buffer_load_dwordx4 v12, s[12:15], s40 offen  lds
    s_add_u32 m0, s41, 118784
    s_nop 0
    buffer_load_dwordx4 v13, s[12:15], s40 offen  lds
    s_add_u32 s40, s40, 73728
    s_buffer_load_dwordx2 s[50:51], s[52:55], s42 offset:393276
    s_buffer_load_dwordx2 s[50:51], s[52:55], s42 offset:426044
    s_buffer_load_dwordx2 s[50:51], s[52:55], s42 offset:458812
    s_buffer_load_dwordx2 s[50:51], s[52:55], s42 offset:491580
    s_waitcnt vmcnt(18)
    s_barrier
    s_add_u32 m0, s41, 0
    s_nop 0
    buffer_load_dwordx4 v5, s[12:15], s40 offen  lds
    s_add_u32 m0, s41, 1024
    s_nop 0
    buffer_load_dwordx4 v6, s[12:15], s40 offen  lds
    s_add_u32 m0, s41, 2048
    s_nop 0
    buffer_load_dwordx4 v7, s[12:15], s40 offen  lds
    s_add_u32 m0, s41, 3072
    s_nop 0
    buffer_load_dwordx4 v8, s[12:15], s40 offen  lds
    s_add_u32 m0, s41, 4096
    s_nop 0
    buffer_load_dwordx4 v9, s[12:15], s40 offen  lds
    s_add_u32 m0, s41, 5120
    s_nop 0
    buffer_load_dwordx4 v10, s[12:15], s40 offen  lds
    s_add_u32 m0, s41, 6144
    s_nop 0
    buffer_load_dwordx4 v11, s[12:15], s40 offen  lds
    s_add_u32 m0, s41, 7168
    s_nop 0
    buffer_load_dwordx4 v12, s[12:15], s40 offen  lds
    s_add_u32 m0, s41, 8192
    s_nop 0
    buffer_load_dwordx4 v13, s[12:15], s40 offen  lds
    s_add_u32 s40, s40, 73728
    s_buffer_load_dwordx2 s[50:51], s[52:55], s42 offset:524348
    s_buffer_load_dwordx2 s[50:51], s[52:55], s42 offset:557116
    s_buffer_load_dwordx2 s[50:51], s[52:55], s42 offset:589884
    s_buffer_load_dwordx2 s[50:51], s[52:55], s42 offset:622652
    s_waitcnt vmcnt(18)
    s_barrier
    s_add_u32 m0, s41, 36864
    s_nop 0
    buffer_load_dwordx4 v5, s[12:15], s40 offen  lds
    s_add_u32 m0, s41, 37888
    s_nop 0
    buffer_load_dwordx4 v6, s[12:15], s40 offen  lds
    s_add_u32 m0, s41, 38912
    s_nop 0
    buffer_load_dwordx4 v7, s[12:15], s40 offen  lds
    s_add_u32 m0, s41, 39936
    s_nop 0
    buffer_load_dwordx4 v8, s[12:15], s40 offen  lds
    s_add_u32 m0, s41, 40960
    s_nop 0
    buffer_load_dwordx4 v9, s[12:15], s40 offen  lds
    s_add_u32 m0, s41, 41984
    s_nop 0
    buffer_load_dwordx4 v10, s[12:15], s40 offen  lds
    s_add_u32 m0, s41, 43008
    s_nop 0
    buffer_load_dwordx4 v11, s[12:15], s40 offen  lds
    s_add_u32 m0, s41, 44032
    s_nop 0
    buffer_load_dwordx4 v12, s[12:15], s40 offen  lds
    s_add_u32 m0, s41, 45056
    s_nop 0
    buffer_load_dwordx4 v13, s[12:15], s40 offen  lds
    s_add_u32 s40, s40, 73728
    s_buffer_load_dwordx2 s[50:51], s[52:55], s42 offset:655420
    s_buffer_load_dwordx2 s[50:51], s[52:55], s42 offset:688188
    s_buffer_load_dwordx2 s[50:51], s[52:55], s42 offset:720956
    s_buffer_load_dwordx2 s[50:51], s[52:55], s42 offset:753724
    s_waitcnt vmcnt(18)
    s_barrier
    s_add_u32 m0, s41, 73728
    s_nop 0
    buffer_load_dwordx4 v5, s[12:15], s40 offen  lds
    s_add_u32 m0, s41, 74752
    s_nop 0
    buffer_load_dwordx4 v6, s[12:15], s40 offen  lds
    s_add_u32 m0, s41, 75776
    s_nop 0
    buffer_load_dwordx4 v7, s[12:15], s40 offen  lds
    s_add_u32 m0, s41, 76800
    s_nop 0
    buffer_load_dwordx4 v8, s[12:15], s40 offen  lds
    s_add_u32 m0, s41, 77824
    s_nop 0
    buffer_load_dwordx4 v9, s[12:15], s40 offen  lds
    s_add_u32 m0, s41, 78848
    s_nop 0
    buffer_load_dwordx4 v10, s[12:15], s40 offen  lds
    s_add_u32 m0, s41, 79872
    s_nop 0
    buffer_load_dwordx4 v11, s[12:15], s40 offen  lds
    s_add_u32 m0, s41, 80896
    s_nop 0
    buffer_load_dwordx4 v12, s[12:15], s40 offen  lds
    s_add_u32 m0, s41, 81920
    s_nop 0
    buffer_load_dwordx4 v13, s[12:15], s40 offen  lds
    s_add_u32 s40, s40, 73728
    s_buffer_load_dwordx2 s[50:51], s[52:55], s42 offset:786492
    s_buffer_load_dwordx2 s[50:51], s[52:55], s42 offset:819260
    s_buffer_load_dwordx2 s[50:51], s[52:55], s42 offset:852028
    s_buffer_load_dwordx2 s[50:51], s[52:55], s42 offset:884796
    s_waitcnt vmcnt(18)
    s_barrier
    s_add_u32 m0, s41, 110592
    s_nop 0
    buffer_load_dwordx4 v5, s[12:15], s40 offen  lds
    s_add_u32 m0, s41, 111616
    s_nop 0
    buffer_load_dwordx4 v6, s[12:15], s40 offen  lds
    s_add_u32 m0, s41, 112640
    s_nop 0
    buffer_load_dwordx4 v7, s[12:15], s40 offen  lds
    s_add_u32 m0, s41, 113664
    s_nop 0
    buffer_load_dwordx4 v8, s[12:15], s40 offen  lds
    s_add_u32 m0, s41, 114688
    s_nop 0
    buffer_load_dwordx4 v9, s[12:15], s40 offen  lds
    s_add_u32 m0, s41, 115712
    s_nop 0
    buffer_load_dwordx4 v10, s[12:15], s40 offen  lds
    s_add_u32 m0, s41, 116736
    s_nop 0
    buffer_load_dwordx4 v11, s[12:15], s40 offen  lds
    s_add_u32 m0, s41, 117760
    s_nop 0
    buffer_load_dwordx4 v12, s[12:15], s40 offen  lds
    s_add_u32 m0, s41, 118784
    s_nop 0
    buffer_load_dwordx4 v13, s[12:15], s40 offen  lds
    s_add_u32 s40, s40, 73728
    s_buffer_load_dwordx2 s[50:51], s[52:55], s42 offset:917564
    s_buffer_load_dwordx2 s[50:51], s[52:55], s42 offset:950332
    s_buffer_load_dwordx2 s[50:51], s[52:55], s42 offset:983100
    s_buffer_load_dwordx2 s[50:51], s[52:55], s42 offset:1015868
    s_waitcnt vmcnt(18)
    s_barrier
    s_add_u32 m0, s41, 0
    s_nop 0
    buffer_load_dwordx4 v5, s[12:15], s40 offen  lds
    s_add_u32 m0, s41, 1024
    s_nop 0
    buffer_load_dwordx4 v6, s[12:15], s40 offen  lds
    s_add_u32 m0, s41, 2048
    s_nop 0
    buffer_load_dwordx4 v7, s[12:15], s40 offen  lds
    s_add_u32 m0, s41, 3072
    s_nop 0
    buffer_load_dwordx4 v8, s[12:15], s40 offen  lds
    s_add_u32 m0, s41, 4096
    s_nop 0
    buffer_load_dwordx4 v9, s[12:15], s40 offen  lds
    s_add_u32 m0, s41, 5120
    s_nop 0
    buffer_load_dwordx4 v10, s[12:15], s40 offen  lds
    s_add_u32 m0, s41, 6144
    s_nop 0
    buffer_load_dwordx4 v11, s[12:15], s40 offen  lds
    s_add_u32 m0, s41, 7168
    s_nop 0
    buffer_load_dwordx4 v12, s[12:15], s40 offen  lds
    s_add_u32 m0, s41, 8192
    s_nop 0
    buffer_load_dwordx4 v13, s[12:15], s40 offen  lds
    s_add_u32 s40, s40, 73728
    s_waitcnt vmcnt(18)
    s_barrier
    s_add_u32 m0, s41, 36864
    s_nop 0
    buffer_load_dwordx4 v5, s[12:15], s40 offen  lds
    s_add_u32 m0, s41, 37888
    s_nop 0
    buffer_load_dwordx4 v6, s[12:15], s40 offen  lds
    s_add_u32 m0, s41, 38912
    s_nop 0
    buffer_load_dwordx4 v7, s[12:15], s40 offen  lds
    s_add_u32 m0, s41, 39936
    s_nop 0
    buffer_load_dwordx4 v8, s[12:15], s40 offen  lds
    s_add_u32 m0, s41, 40960
    s_nop 0
    buffer_load_dwordx4 v9, s[12:15], s40 offen  lds
    s_add_u32 m0, s41, 41984
    s_nop 0
    buffer_load_dwordx4 v10, s[12:15], s40 offen  lds
    s_add_u32 m0, s41, 43008
    s_nop 0
    buffer_load_dwordx4 v11, s[12:15], s40 offen  lds
    s_add_u32 m0, s41, 44032
    s_nop 0
    buffer_load_dwordx4 v12, s[12:15], s40 offen  lds
    s_add_u32 m0, s41, 45056
    s_nop 0
    buffer_load_dwordx4 v13, s[12:15], s40 offen  lds
    s_add_u32 s40, s40, 73728
    s_waitcnt vmcnt(18)
    s_barrier
    s_add_u32 m0, s41, 73728
    s_nop 0
    buffer_load_dwordx4 v5, s[12:15], s40 offen  lds
    s_add_u32 m0, s41, 74752
    s_nop 0
    buffer_load_dwordx4 v6, s[12:15], s40 offen  lds
    s_add_u32 m0, s41, 75776
    s_nop 0
    buffer_load_dwordx4 v7, s[12:15], s40 offen  lds
    s_add_u32 m0, s41, 76800
    s_nop 0
    buffer_load_dwordx4 v8, s[12:15], s40 offen  lds
    s_add_u32 m0, s41, 77824
    s_nop 0
    buffer_load_dwordx4 v9, s[12:15], s40 offen  lds
    s_add_u32 m0, s41, 78848
    s_nop 0
    buffer_load_dwordx4 v10, s[12:15], s40 offen  lds
    s_add_u32 m0, s41, 79872
    s_nop 0
    buffer_load_dwordx4 v11, s[12:15], s40 offen  lds
    s_add_u32 m0, s41, 80896
    s_nop 0
    buffer_load_dwordx4 v12, s[12:15], s40 offen  lds
    s_add_u32 m0, s41, 81920
    s_nop 0
    buffer_load_dwordx4 v13, s[12:15], s40 offen  lds
    s_add_u32 s40, s40, 73728
    s_waitcnt vmcnt(18)
    s_barrier
    s_add_u32 m0, s41, 110592
    s_nop 0
    buffer_load_dwordx4 v5, s[12:15], s40 offen  lds
    s_add_u32 m0, s41, 111616
    s_nop 0
    buffer_load_dwordx4 v6, s[12:15], s40 offen  lds
    s_add_u32 m0, s41, 112640
    s_nop 0
    buffer_load_dwordx4 v7, s[12:15], s40 offen  lds
    s_add_u32 m0, s41, 113664
    s_nop 0
    buffer_load_dwordx4 v8, s[12:15], s40 offen  lds
    s_add_u32 m0, s41, 114688
    s_nop 0
    buffer_load_dwordx4 v9, s[12:15], s40 offen  lds
    s_add_u32 m0, s41, 115712
    s_nop 0
    buffer_load_dwordx4 v10, s[12:15], s40 offen  lds
    s_add_u32 m0, s41, 116736
    s_nop 0
    buffer_load_dwordx4 v11, s[12:15], s40 offen  lds
    s_add_u32 m0, s41, 117760
    s_nop 0
    buffer_load_dwordx4 v12, s[12:15], s40 offen  lds
    s_add_u32 m0, s41, 118784
    s_nop 0
    buffer_load_dwordx4 v13, s[12:15], s40 offen  lds
    s_add_u32 s40, s40, 73728
    s_waitcnt vmcnt(18)
    s_barrier
    s_waitcnt vmcnt(9)
    s_barrier
    s_waitcnt vmcnt(0)
    s_barrier
    s_waitcnt vmcnt(0)
    s_barrier
    s_branch L_m_help1
L_m_oload1:
    s_cmp_lt_u32 s2, 128
    s_cbranch_scc0 L_m_o1c
    v_mov_b32 v5, v146
    v_mov_b32 v6, v147
    v_mov_b32 v7, v148
    v_mov_b32 v8, v149
    v_mov_b32 v9, v150
    v_mov_b32 v10, v151
    v_mov_b32 v11, v152
    v_mov_b32 v12, v153
    v_mov_b32 v13, v154
    s_branch L_m_o1d
L_m_o1c:
    s_and_b32 s38, s24, 1
    s_mul_i32 s38, s38, 576
    s_mov_b32 s39, 238609295
    s_add_u32 s48, s38, 0
    v_add_u32 v14, s48, v0
    v_mul_hi_u32 v15, v14, s39
    v_mul_u32_u24 v16, 18, v15
    v_sub_u32 v16, v14, v16
    v_mul_u32_u24 v15, 9216, v15
    v_lshlrev_b32 v16, 4, v16
    v_add_u32 v5, v15, v16

    s_add_u32 s48, s38, 64
    v_add_u32 v14, s48, v0
    v_mul_hi_u32 v15, v14, s39
    v_mul_u32_u24 v16, 18, v15
    v_sub_u32 v16, v14, v16
    v_mul_u32_u24 v15, 9216, v15
    v_lshlrev_b32 v16, 4, v16
    v_add_u32 v6, v15, v16

    s_add_u32 s48, s38, 128
    v_add_u32 v14, s48, v0
    v_mul_hi_u32 v15, v14, s39
    v_mul_u32_u24 v16, 18, v15
    v_sub_u32 v16, v14, v16
    v_mul_u32_u24 v15, 9216, v15
    v_lshlrev_b32 v16, 4, v16
    v_add_u32 v7, v15, v16

    s_add_u32 s48, s38, 192
    v_add_u32 v14, s48, v0
    v_mul_hi_u32 v15, v14, s39
    v_mul_u32_u24 v16, 18, v15
    v_sub_u32 v16, v14, v16
    v_mul_u32_u24 v15, 9216, v15
    v_lshlrev_b32 v16, 4, v16
    v_add_u32 v8, v15, v16

    s_add_u32 s48, s38, 256
    v_add_u32 v14, s48, v0
    v_mul_hi_u32 v15, v14, s39
    v_mul_u32_u24 v16, 18, v15
    v_sub_u32 v16, v14, v16
    v_mul_u32_u24 v15, 9216, v15
    v_lshlrev_b32 v16, 4, v16
    v_add_u32 v9, v15, v16

    s_add_u32 s48, s38, 320
    v_add_u32 v14, s48, v0
    v_mul_hi_u32 v15, v14, s39
    v_mul_u32_u24 v16, 18, v15
    v_sub_u32 v16, v14, v16
    v_mul_u32_u24 v15, 9216, v15
    v_lshlrev_b32 v16, 4, v16
    v_add_u32 v10, v15, v16

    s_add_u32 s48, s38, 384
    v_add_u32 v14, s48, v0
    v_mul_hi_u32 v15, v14, s39
    v_mul_u32_u24 v16, 18, v15
    v_sub_u32 v16, v14, v16
    v_mul_u32_u24 v15, 9216, v15
    v_lshlrev_b32 v16, 4, v16
    v_add_u32 v11, v15, v16

    s_add_u32 s48, s38, 448
    v_add_u32 v14, s48, v0
    v_mul_hi_u32 v15, v14, s39
    v_mul_u32_u24 v16, 18, v15
    v_sub_u32 v16, v14, v16
    v_mul_u32_u24 v15, 9216, v15
    v_lshlrev_b32 v16, 4, v16
    v_add_u32 v12, v15, v16

    s_add_u32 s48, s38, 512
    v_add_u32 v14, s48, v0
    v_mul_hi_u32 v15, v14, s39
    v_mul_u32_u24 v16, 18, v15
    v_sub_u32 v16, v14, v16
    v_mul_u32_u24 v15, 9216, v15
    v_lshlrev_b32 v16, 4, v16
    v_add_u32 v13, v15, v16

L_m_o1d:
    s_mul_i32 s40, s32, 9437184
    s_mul_i32 s38, s33, 288
    s_add_u32 s40, s40, s38
    s_and_b32 s41, s24, 1
    s_mul_i32 s41, s41, 9216
    s_add_u32 s41, s41, 18432

    s_mov_b32 s52, s8
    s_and_b32 s53, s9, 0xffff
    s_mov_b32 s54, 18874368
    s_mov_b32 s55, 0x00020000
    s_sub_u32 s38, s24, 4
    s_lshl_b32 s39, s31, 2
    s_add_u32 s38, s38, s39
    s_lshr_b32 s39, s38, 4
    s_mul_i32 s42, s36, 1152
    s_add_u32 s42, s42, s39
    s_lshl_b32 s42, s42, 12
    s_and_b32 s38, s38, 15
    s_lshl_b32 s38, s38, 7
    s_add_u32 s42, s42, s38
    s_and_b32 s38, s30, 1
    s_lshl_b32 s38, s38, 11
    s_add_u32 s42, s42, s38
    s_add_u32 s42, s42, 0

    s_add_u32 m0, s41, 0
    s_nop 0
    buffer_load_dwordx4 v5, s[16:19], s40 offen  lds
    s_add_u32 m0, s41, 1024
    s_nop 0
    buffer_load_dwordx4 v6, s[16:19], s40 offen  lds
    s_add_u32 m0, s41, 2048
    s_nop 0
    buffer_load_dwordx4 v7, s[16:19], s40 offen  lds
    s_add_u32 m0, s41, 3072
    s_nop 0
    buffer_load_dwordx4 v8, s[16:19], s40 offen  lds
    s_add_u32 m0, s41, 4096
    s_nop 0
    buffer_load_dwordx4 v9, s[16:19], s40 offen  lds
    s_add_u32 m0, s41, 5120
    s_nop 0
    buffer_load_dwordx4 v10, s[16:19], s40 offen  lds
    s_add_u32 m0, s41, 6144
    s_nop 0
    buffer_load_dwordx4 v11, s[16:19], s40 offen  lds
    s_add_u32 m0, s41, 7168
    s_nop 0
    buffer_load_dwordx4 v12, s[16:19], s40 offen  lds
    s_add_u32 m0, s41, 8192
    s_nop 0
    buffer_load_dwordx4 v13, s[16:19], s40 offen  lds
    s_add_u32 s40, s40, 589824
    s_add_u32 m0, s41, 36864
    s_nop 0
    buffer_load_dwordx4 v5, s[16:19], s40 offen  lds
    s_add_u32 m0, s41, 37888
    s_nop 0
    buffer_load_dwordx4 v6, s[16:19], s40 offen  lds
    s_add_u32 m0, s41, 38912
    s_nop 0
    buffer_load_dwordx4 v7, s[16:19], s40 offen  lds
    s_add_u32 m0, s41, 39936
    s_nop 0
    buffer_load_dwordx4 v8, s[16:19], s40 offen  lds
    s_add_u32 m0, s41, 40960
    s_nop 0
    buffer_load_dwordx4 v9, s[16:19], s40 offen  lds
    s_add_u32 m0, s41, 41984
    s_nop 0
    buffer_load_dwordx4 v10, s[16:19], s40 offen  lds
    s_add_u32 m0, s41, 43008
    s_nop 0
    buffer_load_dwordx4 v11, s[16:19], s40 offen  lds
    s_add_u32 m0, s41, 44032
    s_nop 0
    buffer_load_dwordx4 v12, s[16:19], s40 offen  lds
    s_add_u32 m0, s41, 45056
    s_nop 0
    buffer_load_dwordx4 v13, s[16:19], s40 offen  lds
    s_add_u32 s40, s40, 589824
    s_add_u32 m0, s41, 73728
    s_nop 0
    buffer_load_dwordx4 v5, s[16:19], s40 offen  lds
    s_add_u32 m0, s41, 74752
    s_nop 0
    buffer_load_dwordx4 v6, s[16:19], s40 offen  lds
    s_add_u32 m0, s41, 75776
    s_nop 0
    buffer_load_dwordx4 v7, s[16:19], s40 offen  lds
    s_add_u32 m0, s41, 76800
    s_nop 0
    buffer_load_dwordx4 v8, s[16:19], s40 offen  lds
    s_add_u32 m0, s41, 77824
    s_nop 0
    buffer_load_dwordx4 v9, s[16:19], s40 offen  lds
    s_add_u32 m0, s41, 78848
    s_nop 0
    buffer_load_dwordx4 v10, s[16:19], s40 offen  lds
    s_add_u32 m0, s41, 79872
    s_nop 0
    buffer_load_dwordx4 v11, s[16:19], s40 offen  lds
    s_add_u32 m0, s41, 80896
    s_nop 0
    buffer_load_dwordx4 v12, s[16:19], s40 offen  lds
    s_add_u32 m0, s41, 81920
    s_nop 0
    buffer_load_dwordx4 v13, s[16:19], s40 offen  lds
    s_add_u32 s40, s40, 589824
    s_add_u32 m0, s41, 110592
    s_nop 0
    buffer_load_dwordx4 v5, s[16:19], s40 offen  lds
    s_add_u32 m0, s41, 111616
    s_nop 0
    buffer_load_dwordx4 v6, s[16:19], s40 offen  lds
    s_add_u32 m0, s41, 112640
    s_nop 0
    buffer_load_dwordx4 v7, s[16:19], s40 offen  lds
    s_add_u32 m0, s41, 113664
    s_nop 0
    buffer_load_dwordx4 v8, s[16:19], s40 offen  lds
    s_add_u32 m0, s41, 114688
    s_nop 0
    buffer_load_dwordx4 v9, s[16:19], s40 offen  lds
    s_add_u32 m0, s41, 115712
    s_nop 0
    buffer_load_dwordx4 v10, s[16:19], s40 offen  lds
    s_add_u32 m0, s41, 116736
    s_nop 0
    buffer_load_dwordx4 v11, s[16:19], s40 offen  lds
    s_add_u32 m0, s41, 117760
    s_nop 0
    buffer_load_dwordx4 v12, s[16:19], s40 offen  lds
    s_add_u32 m0, s41, 118784
    s_nop 0
    buffer_load_dwordx4 v13, s[16:19], s40 offen  lds
    s_add_u32 s40, s40, 589824
    s_waitcnt vmcnt(27)
    s_barrier
    s_waitcnt vmcnt(18)
    s_barrier
    s_add_u32 m0, s41, 0
    s_nop 0
    buffer_load_dwordx4 v5, s[16:19], s40 offen  lds
    s_add_u32 m0, s41, 1024
    s_nop 0
    buffer_load_dwordx4 v6, s[16:19], s40 offen  lds
    s_add_u32 m0, s41, 2048
    s_nop 0
    buffer_load_dwordx4 v7, s[16:19], s40 offen  lds
    s_add_u32 m0, s41, 3072
    s_nop 0
    buffer_load_dwordx4 v8, s[16:19], s40 offen  lds
    s_add_u32 m0, s41, 4096
    s_nop 0
    buffer_load_dwordx4 v9, s[16:19], s40 offen  lds
    s_add_u32 m0, s41, 5120
    s_nop 0
    buffer_load_dwordx4 v10, s[16:19], s40 offen  lds
    s_add_u32 m0, s41, 6144
    s_nop 0
    buffer_load_dwordx4 v11, s[16:19], s40 offen  lds
    s_add_u32 m0, s41, 7168
    s_nop 0
    buffer_load_dwordx4 v12, s[16:19], s40 offen  lds
    s_add_u32 m0, s41, 8192
    s_nop 0
    buffer_load_dwordx4 v13, s[16:19], s40 offen  lds
    s_add_u32 s40, s40, 589824
    s_buffer_load_dwordx2 s[50:51], s[52:55], s42 offset:60
    s_buffer_load_dwordx2 s[50:51], s[52:55], s42 offset:32828
    s_buffer_load_dwordx2 s[50:51], s[52:55], s42 offset:65596
    s_buffer_load_dwordx2 s[50:51], s[52:55], s42 offset:98364
    s_waitcnt vmcnt(18)
    s_barrier
    s_add_u32 m0, s41, 36864
    s_nop 0
    buffer_load_dwordx4 v5, s[16:19], s40 offen  lds
    s_add_u32 m0, s41, 37888
    s_nop 0
    buffer_load_dwordx4 v6, s[16:19], s40 offen  lds
    s_add_u32 m0, s41, 38912
    s_nop 0
    buffer_load_dwordx4 v7, s[16:19], s40 offen  lds
    s_add_u32 m0, s41, 39936
    s_nop 0
    buffer_load_dwordx4 v8, s[16:19], s40 offen  lds
    s_add_u32 m0, s41, 40960
    s_nop 0
    buffer_load_dwordx4 v9, s[16:19], s40 offen  lds
    s_add_u32 m0, s41, 41984
    s_nop 0
    buffer_load_dwordx4 v10, s[16:19], s40 offen  lds
    s_add_u32 m0, s41, 43008
    s_nop 0
    buffer_load_dwordx4 v11, s[16:19], s40 offen  lds
    s_add_u32 m0, s41, 44032
    s_nop 0
    buffer_load_dwordx4 v12, s[16:19], s40 offen  lds
    s_add_u32 m0, s41, 45056
    s_nop 0
    buffer_load_dwordx4 v13, s[16:19], s40 offen  lds
    s_add_u32 s40, s40, 589824
    s_buffer_load_dwordx2 s[50:51], s[52:55], s42 offset:131132
    s_buffer_load_dwordx2 s[50:51], s[52:55], s42 offset:163900
    s_buffer_load_dwordx2 s[50:51], s[52:55], s42 offset:196668
    s_buffer_load_dwordx2 s[50:51], s[52:55], s42 offset:229436
    s_waitcnt vmcnt(18)
    s_barrier
    s_add_u32 m0, s41, 73728
    s_nop 0
    buffer_load_dwordx4 v5, s[16:19], s40 offen  lds
    s_add_u32 m0, s41, 74752
    s_nop 0
    buffer_load_dwordx4 v6, s[16:19], s40 offen  lds
    s_add_u32 m0, s41, 75776
    s_nop 0
    buffer_load_dwordx4 v7, s[16:19], s40 offen  lds
    s_add_u32 m0, s41, 76800
    s_nop 0
    buffer_load_dwordx4 v8, s[16:19], s40 offen  lds
    s_add_u32 m0, s41, 77824
    s_nop 0
    buffer_load_dwordx4 v9, s[16:19], s40 offen  lds
    s_add_u32 m0, s41, 78848
    s_nop 0
    buffer_load_dwordx4 v10, s[16:19], s40 offen  lds
    s_add_u32 m0, s41, 79872
    s_nop 0
    buffer_load_dwordx4 v11, s[16:19], s40 offen  lds
    s_add_u32 m0, s41, 80896
    s_nop 0
    buffer_load_dwordx4 v12, s[16:19], s40 offen  lds
    s_add_u32 m0, s41, 81920
    s_nop 0
    buffer_load_dwordx4 v13, s[16:19], s40 offen  lds
    s_add_u32 s40, s40, 589824
    s_buffer_load_dwordx2 s[50:51], s[52:55], s42 offset:262204
    s_buffer_load_dwordx2 s[50:51], s[52:55], s42 offset:294972
    s_buffer_load_dwordx2 s[50:51], s[52:55], s42 offset:327740
    s_buffer_load_dwordx2 s[50:51], s[52:55], s42 offset:360508
    s_waitcnt vmcnt(18)
    s_barrier
    s_add_u32 m0, s41, 110592
    s_nop 0
    buffer_load_dwordx4 v5, s[16:19], s40 offen  lds
    s_add_u32 m0, s41, 111616
    s_nop 0
    buffer_load_dwordx4 v6, s[16:19], s40 offen  lds
    s_add_u32 m0, s41, 112640
    s_nop 0
    buffer_load_dwordx4 v7, s[16:19], s40 offen  lds
    s_add_u32 m0, s41, 113664
    s_nop 0
    buffer_load_dwordx4 v8, s[16:19], s40 offen  lds
    s_add_u32 m0, s41, 114688
    s_nop 0
    buffer_load_dwordx4 v9, s[16:19], s40 offen  lds
    s_add_u32 m0, s41, 115712
    s_nop 0
    buffer_load_dwordx4 v10, s[16:19], s40 offen  lds
    s_add_u32 m0, s41, 116736
    s_nop 0
    buffer_load_dwordx4 v11, s[16:19], s40 offen  lds
    s_add_u32 m0, s41, 117760
    s_nop 0
    buffer_load_dwordx4 v12, s[16:19], s40 offen  lds
    s_add_u32 m0, s41, 118784
    s_nop 0
    buffer_load_dwordx4 v13, s[16:19], s40 offen  lds
    s_add_u32 s40, s40, 589824
    s_buffer_load_dwordx2 s[50:51], s[52:55], s42 offset:393276
    s_buffer_load_dwordx2 s[50:51], s[52:55], s42 offset:426044
    s_buffer_load_dwordx2 s[50:51], s[52:55], s42 offset:458812
    s_buffer_load_dwordx2 s[50:51], s[52:55], s42 offset:491580
    s_waitcnt vmcnt(18)
    s_barrier
    s_add_u32 m0, s41, 0
    s_nop 0
    buffer_load_dwordx4 v5, s[16:19], s40 offen  lds
    s_add_u32 m0, s41, 1024
    s_nop 0
    buffer_load_dwordx4 v6, s[16:19], s40 offen  lds
    s_add_u32 m0, s41, 2048
    s_nop 0
    buffer_load_dwordx4 v7, s[16:19], s40 offen  lds
    s_add_u32 m0, s41, 3072
    s_nop 0
    buffer_load_dwordx4 v8, s[16:19], s40 offen  lds
    s_add_u32 m0, s41, 4096
    s_nop 0
    buffer_load_dwordx4 v9, s[16:19], s40 offen  lds
    s_add_u32 m0, s41, 5120
    s_nop 0
    buffer_load_dwordx4 v10, s[16:19], s40 offen  lds
    s_add_u32 m0, s41, 6144
    s_nop 0
    buffer_load_dwordx4 v11, s[16:19], s40 offen  lds
    s_add_u32 m0, s41, 7168
    s_nop 0
    buffer_load_dwordx4 v12, s[16:19], s40 offen  lds
    s_add_u32 m0, s41, 8192
    s_nop 0
    buffer_load_dwordx4 v13, s[16:19], s40 offen  lds
    s_add_u32 s40, s40, 589824
    s_buffer_load_dwordx2 s[50:51], s[52:55], s42 offset:524348
    s_buffer_load_dwordx2 s[50:51], s[52:55], s42 offset:557116
    s_buffer_load_dwordx2 s[50:51], s[52:55], s42 offset:589884
    s_buffer_load_dwordx2 s[50:51], s[52:55], s42 offset:622652
    s_waitcnt vmcnt(18)
    s_barrier
    s_add_u32 m0, s41, 36864
    s_nop 0
    buffer_load_dwordx4 v5, s[16:19], s40 offen  lds
    s_add_u32 m0, s41, 37888
    s_nop 0
    buffer_load_dwordx4 v6, s[16:19], s40 offen  lds
    s_add_u32 m0, s41, 38912
    s_nop 0
    buffer_load_dwordx4 v7, s[16:19], s40 offen  lds
    s_add_u32 m0, s41, 39936
    s_nop 0
    buffer_load_dwordx4 v8, s[16:19], s40 offen  lds
    s_add_u32 m0, s41, 40960
    s_nop 0
    buffer_load_dwordx4 v9, s[16:19], s40 offen  lds
    s_add_u32 m0, s41, 41984
    s_nop 0
    buffer_load_dwordx4 v10, s[16:19], s40 offen  lds
    s_add_u32 m0, s41, 43008
    s_nop 0
    buffer_load_dwordx4 v11, s[16:19], s40 offen  lds
    s_add_u32 m0, s41, 44032
    s_nop 0
    buffer_load_dwordx4 v12, s[16:19], s40 offen  lds
    s_add_u32 m0, s41, 45056
    s_nop 0
    buffer_load_dwordx4 v13, s[16:19], s40 offen  lds
    s_add_u32 s40, s40, 589824
    s_buffer_load_dwordx2 s[50:51], s[52:55], s42 offset:655420
    s_buffer_load_dwordx2 s[50:51], s[52:55], s42 offset:688188
    s_buffer_load_dwordx2 s[50:51], s[52:55], s42 offset:720956
    s_buffer_load_dwordx2 s[50:51], s[52:55], s42 offset:753724
    s_waitcnt vmcnt(18)
    s_barrier
    s_add_u32 m0, s41, 73728
    s_nop 0
    buffer_load_dwordx4 v5, s[16:19], s40 offen  lds
    s_add_u32 m0, s41, 74752
    s_nop 0
    buffer_load_dwordx4 v6, s[16:19], s40 offen  lds
    s_add_u32 m0, s41, 75776
    s_nop 0
    buffer_load_dwordx4 v7, s[16:19], s40 offen  lds
    s_add_u32 m0, s41, 76800
    s_nop 0
    buffer_load_dwordx4 v8, s[16:19], s40 offen  lds
    s_add_u32 m0, s41, 77824
    s_nop 0
    buffer_load_dwordx4 v9, s[16:19], s40 offen  lds
    s_add_u32 m0, s41, 78848
    s_nop 0
    buffer_load_dwordx4 v10, s[16:19], s40 offen  lds
    s_add_u32 m0, s41, 79872
    s_nop 0
    buffer_load_dwordx4 v11, s[16:19], s40 offen  lds
    s_add_u32 m0, s41, 80896
    s_nop 0
    buffer_load_dwordx4 v12, s[16:19], s40 offen  lds
    s_add_u32 m0, s41, 81920
    s_nop 0
    buffer_load_dwordx4 v13, s[16:19], s40 offen  lds
    s_add_u32 s40, s40, 589824
    s_buffer_load_dwordx2 s[50:51], s[52:55], s42 offset:786492
    s_buffer_load_dwordx2 s[50:51], s[52:55], s42 offset:819260
    s_buffer_load_dwordx2 s[50:51], s[52:55], s42 offset:852028
    s_buffer_load_dwordx2 s[50:51], s[52:55], s42 offset:884796
    s_waitcnt vmcnt(18)
    s_barrier
    s_add_u32 m0, s41, 110592
    s_nop 0
    buffer_load_dwordx4 v5, s[16:19], s40 offen  lds
    s_add_u32 m0, s41, 111616
    s_nop 0
    buffer_load_dwordx4 v6, s[16:19], s40 offen  lds
    s_add_u32 m0, s41, 112640
    s_nop 0
    buffer_load_dwordx4 v7, s[16:19], s40 offen  lds
    s_add_u32 m0, s41, 113664
    s_nop 0
    buffer_load_dwordx4 v8, s[16:19], s40 offen  lds
    s_add_u32 m0, s41, 114688
    s_nop 0
    buffer_load_dwordx4 v9, s[16:19], s40 offen  lds
    s_add_u32 m0, s41, 115712
    s_nop 0
    buffer_load_dwordx4 v10, s[16:19], s40 offen  lds
    s_add_u32 m0, s41, 116736
    s_nop 0
    buffer_load_dwordx4 v11, s[16:19], s40 offen  lds
    s_add_u32 m0, s41, 117760
    s_nop 0
    buffer_load_dwordx4 v12, s[16:19], s40 offen  lds
    s_add_u32 m0, s41, 118784
    s_nop 0
    buffer_load_dwordx4 v13, s[16:19], s40 offen  lds
    s_add_u32 s40, s40, 589824
    s_buffer_load_dwordx2 s[50:51], s[52:55], s42 offset:917564
    s_buffer_load_dwordx2 s[50:51], s[52:55], s42 offset:950332
    s_buffer_load_dwordx2 s[50:51], s[52:55], s42 offset:983100
    s_buffer_load_dwordx2 s[50:51], s[52:55], s42 offset:1015868
    s_waitcnt vmcnt(18)
    s_barrier
    s_add_u32 m0, s41, 0
    s_nop 0
    buffer_load_dwordx4 v5, s[16:19], s40 offen  lds
    s_add_u32 m0, s41, 1024
    s_nop 0
    buffer_load_dwordx4 v6, s[16:19], s40 offen  lds
    s_add_u32 m0, s41, 2048
    s_nop 0
    buffer_load_dwordx4 v7, s[16:19], s40 offen  lds
    s_add_u32 m0, s41, 3072
    s_nop 0
    buffer_load_dwordx4 v8, s[16:19], s40 offen  lds
    s_add_u32 m0, s41, 4096
    s_nop 0
    buffer_load_dwordx4 v9, s[16:19], s40 offen  lds
    s_add_u32 m0, s41, 5120
    s_nop 0
    buffer_load_dwordx4 v10, s[16:19], s40 offen  lds
    s_add_u32 m0, s41, 6144
    s_nop 0
    buffer_load_dwordx4 v11, s[16:19], s40 offen  lds
    s_add_u32 m0, s41, 7168
    s_nop 0
    buffer_load_dwordx4 v12, s[16:19], s40 offen  lds
    s_add_u32 m0, s41, 8192
    s_nop 0
    buffer_load_dwordx4 v13, s[16:19], s40 offen  lds
    s_add_u32 s40, s40, 589824
    s_waitcnt vmcnt(18)
    s_barrier
    s_add_u32 m0, s41, 36864
    s_nop 0
    buffer_load_dwordx4 v5, s[16:19], s40 offen  lds
    s_add_u32 m0, s41, 37888
    s_nop 0
    buffer_load_dwordx4 v6, s[16:19], s40 offen  lds
    s_add_u32 m0, s41, 38912
    s_nop 0
    buffer_load_dwordx4 v7, s[16:19], s40 offen  lds
    s_add_u32 m0, s41, 39936
    s_nop 0
    buffer_load_dwordx4 v8, s[16:19], s40 offen  lds
    s_add_u32 m0, s41, 40960
    s_nop 0
    buffer_load_dwordx4 v9, s[16:19], s40 offen  lds
    s_add_u32 m0, s41, 41984
    s_nop 0
    buffer_load_dwordx4 v10, s[16:19], s40 offen  lds
    s_add_u32 m0, s41, 43008
    s_nop 0
    buffer_load_dwordx4 v11, s[16:19], s40 offen  lds
    s_add_u32 m0, s41, 44032
    s_nop 0
    buffer_load_dwordx4 v12, s[16:19], s40 offen  lds
    s_add_u32 m0, s41, 45056
    s_nop 0
    buffer_load_dwordx4 v13, s[16:19], s40 offen  lds
    s_add_u32 s40, s40, 589824
    s_waitcnt vmcnt(18)
    s_barrier
    s_add_u32 m0, s41, 73728
    s_nop 0
    buffer_load_dwordx4 v5, s[16:19], s40 offen  lds
    s_add_u32 m0, s41, 74752
    s_nop 0
    buffer_load_dwordx4 v6, s[16:19], s40 offen  lds
    s_add_u32 m0, s41, 75776
    s_nop 0
    buffer_load_dwordx4 v7, s[16:19], s40 offen  lds
    s_add_u32 m0, s41, 76800
    s_nop 0
    buffer_load_dwordx4 v8, s[16:19], s40 offen  lds
    s_add_u32 m0, s41, 77824
    s_nop 0
    buffer_load_dwordx4 v9, s[16:19], s40 offen  lds
    s_add_u32 m0, s41, 78848
    s_nop 0
    buffer_load_dwordx4 v10, s[16:19], s40 offen  lds
    s_add_u32 m0, s41, 79872
    s_nop 0
    buffer_load_dwordx4 v11, s[16:19], s40 offen  lds
    s_add_u32 m0, s41, 80896
    s_nop 0
    buffer_load_dwordx4 v12, s[16:19], s40 offen  lds
    s_add_u32 m0, s41, 81920
    s_nop 0
    buffer_load_dwordx4 v13, s[16:19], s40 offen  lds
    s_add_u32 s40, s40, 589824
    s_waitcnt vmcnt(18)
    s_barrier
    s_add_u32 m0, s41, 110592
    s_nop 0
    buffer_load_dwordx4 v5, s[16:19], s40 offen  lds
    s_add_u32 m0, s41, 111616
    s_nop 0
    buffer_load_dwordx4 v6, s[16:19], s40 offen  lds
    s_add_u32 m0, s41, 112640
    s_nop 0
    buffer_load_dwordx4 v7, s[16:19], s40 offen  lds
    s_add_u32 m0, s41, 113664
    s_nop 0
    buffer_load_dwordx4 v8, s[16:19], s40 offen  lds
    s_add_u32 m0, s41, 114688
    s_nop 0
    buffer_load_dwordx4 v9, s[16:19], s40 offen  lds
    s_add_u32 m0, s41, 115712
    s_nop 0
    buffer_load_dwordx4 v10, s[16:19], s40 offen  lds
    s_add_u32 m0, s41, 116736
    s_nop 0
    buffer_load_dwordx4 v11, s[16:19], s40 offen  lds
    s_add_u32 m0, s41, 117760
    s_nop 0
    buffer_load_dwordx4 v12, s[16:19], s40 offen  lds
    s_add_u32 m0, s41, 118784
    s_nop 0
    buffer_load_dwordx4 v13, s[16:19], s40 offen  lds
    s_add_u32 s40, s40, 589824
    s_waitcnt vmcnt(18)
    s_barrier
    s_waitcnt vmcnt(9)
    s_barrier
    s_waitcnt vmcnt(0)
    s_barrier
    s_waitcnt vmcnt(0)
    s_barrier
    s_mov_b32 s16, s8
    s_and_b32 s17, s9, 0xffff
    s_mov_b32 s18, 18874368
    s_mov_b32 s19, 0x00020000
    s_and_b32 s38, s24, 1
    s_lshl_b32 s38, s38, 5
    v_add_u32 v14, s38, v2
    v_lshrrev_b32 v15, 1, v1
    v_and_b32 v16, 1, v1
    v_lshlrev_b32 v16, 4, v16

    v_add_u32 v17, 0, v14
    v_and_b32 v18, 7, v17
    v_xor_b32 v18, v18, v15
    v_lshlrev_b32 v18, 5, v18
    v_add_u32 v18, v18, v16
    v_lshlrev_b32 v17, 12, v17
    v_add_u32 v5, v17, v18

    v_add_u32 v17, 4, v14
    v_and_b32 v18, 7, v17
    v_xor_b32 v18, v18, v15
    v_lshlrev_b32 v18, 5, v18
    v_add_u32 v18, v18, v16
    v_lshlrev_b32 v17, 12, v17
    v_add_u32 v6, v17, v18

    v_add_u32 v17, 8, v14
    v_and_b32 v18, 7, v17
    v_xor_b32 v18, v18, v15
    v_lshlrev_b32 v18, 5, v18
    v_add_u32 v18, v18, v16
    v_lshlrev_b32 v17, 12, v17
    v_add_u32 v7, v17, v18

    v_add_u32 v17, 12, v14
    v_and_b32 v18, 7, v17
    v_xor_b32 v18, v18, v15
    v_lshlrev_b32 v18, 5, v18
    v_add_u32 v18, v18, v16
    v_lshlrev_b32 v17, 12, v17
    v_add_u32 v8, v17, v18

    v_add_u32 v17, 16, v14
    v_and_b32 v18, 7, v17
    v_xor_b32 v18, v18, v15
    v_lshlrev_b32 v18, 5, v18
    v_add_u32 v18, v18, v16
    v_lshlrev_b32 v17, 12, v17
    v_add_u32 v9, v17, v18

    v_add_u32 v17, 20, v14
    v_and_b32 v18, 7, v17
    v_xor_b32 v18, v18, v15
    v_lshlrev_b32 v18, 5, v18
    v_add_u32 v18, v18, v16
    v_lshlrev_b32 v17, 12, v17
    v_add_u32 v10, v17, v18

    v_add_u32 v17, 24, v14
    v_and_b32 v18, 7, v17
    v_xor_b32 v18, v18, v15
    v_lshlrev_b32 v18, 5, v18
    v_add_u32 v18, v18, v16
    v_lshlrev_b32 v17, 12, v17
    v_add_u32 v11, v17, v18

    v_add_u32 v17, 28, v14
    v_and_b32 v18, 7, v17
    v_xor_b32 v18, v18, v15
    v_lshlrev_b32 v18, 5, v18
    v_add_u32 v18, v18, v16
    v_lshlrev_b32 v17, 12, v17
    v_add_u32 v12, v17, v18

    s_mul_i32 s40, s36, 4718592
    s_lshl_b32 s38, s37, 8
    s_add_u32 s40, s40, s38
    s_add_u32 s40, s40, 0
    s_and_b32 s41, s24, 1
    s_lshl_b32 s41, s41, 13
    s_add_u32 s41, s41, 18432

L_m_help1:
    s_lshl_b32 s38, s33, 2
    s_add_u32 s38, s38, s34
    s_lshl_b32 s38, s38, 1
    s_xor_b32 s39, s32, 1
    s_add_u32 s39, s38, s39
    s_add_u32 s38, s38, s32
    s_lshl_b32 s39, s39, 2
    s_add_u32 s39, s39, s25
    s_lshl_b32 s38, s38, 2
    s_add_u32 s38, s38, s25
    s_mul_i32 s54, s39, 6144
    s_add_u32 s54, s54, 20971520
    s_mul_i32 s55, s38, 6144
    s_add_u32 s55, s55, 20971520
    s_lshl_b32 s56, s39, 7
    s_add_u32 s56, s56, 31457280
    s_lshl_b32 s57, s38, 7
    s_add_u32 s57, s57, 31457280
    s_mul_i32 s38, s33, 9
    s_lshl_b32 s39, s25, 1
    s_add_u32 s39, s39, s35
    s_add_u32 s38, s38, s39
    s_lshr_b32 s38, s38, 1
    s_mul_i32 s58, s38, 36864
    s_mul_i32 s39, s34, 2304
    s_add_u32 s39, s39, 13631488
    s_add_u32 s58, s58, s39
    s_mul_i32 s38, s33, 9
    s_cmp_eq_u32 s35, 0
    s_cselect_b32 s59, 8, 0
    s_add_u32 s38, s38, s59
    s_and_b32 s59, s38, 1
    s_lshl_b32 s59, s59, 3
    s_lshr_b32 s38, s38, 1
    s_mul_i32 s38, s38, 36864
    s_add_u32 s59, s59, s38
    s_add_u32 s59, s59, s39
    v_mul_u32_u24 v4, 9216, v2
    v_lshlrev_b32 v5, 4, v1
    v_add_u32 v4, v4, v5
    v_mov_b32 v24, 0xc0135761

    v_mov_b32 v20, 0xbdd2d3e8
    v_mov_b32 v22, 1.0
    v_lshlrev_b32 v8, 16, v26
    v_and_b32 v9, 0xffff0000, v26
    v_lshlrev_b32 v10, 16, v27
    v_and_b32 v11, 0xffff0000, v27

    v_lshlrev_b32 v12, 16, v28
    v_and_b32 v13, 0xffff0000, v28
    v_lshlrev_b32 v14, 16, v29
    v_and_b32 v15, 0xffff0000, v29

    v_lshlrev_b32 v16, 16, v30
    v_and_b32 v17, 0xffff0000, v30
    v_lshlrev_b32 v18, 16, v31
    v_and_b32 v19, 0xffff0000, v31

    s_mul_i32 s38, s25, 5120
    s_cmp_eq_u32 s25, 3
    s_cselect_b32 s38, 34816, s38
    s_add_u32 s38, s38, 69632
    v_add_u32 v6, s38, v3
    s_barrier
    ds_read_b128 v[32:35], v6 offset:0
    ds_read_b128 v[36:39], v6 offset:1024
    ds_read_b128 v[40:43], v6 offset:2048
    ds_read_b128 v[44:47], v6 offset:3072
    ds_read_b128 v[48:51], v6 offset:4096
    v_mov_b32 v6, 0
    s_mov_b32 s49, 0
    buffer_load_dword v152, v6, s[12:15], s57 offen sc1
L_m_p1h:
    s_waitcnt vmcnt(0)
    v_readfirstlane_b32 s48, v152
    s_cmp_eq_u32 s48, s28
    s_cbranch_scc1 L_m_p1h_ok
    s_sleep 1
    buffer_load_dword v152, v6, s[12:15], s57 offen sc1
    s_add_u32 s49, s49, 1
    s_cmp_gt_u32 s49, 8000
    s_cbranch_scc0 L_m_p1h

L_m_p1h_ok:
    s_waitcnt lgkmcnt(0)
    s_cmp_eq_u32 s32, 0
    s_cbranch_scc0 L_m_h1_k1
    buffer_load_dwordx4 v[116:119], v3, s[12:15], s55 offen offset:2048 sc1
    buffer_load_dwordx4 v[120:123], v3, s[12:15], s55 offen offset:3072 sc1
    s_add_u32 s48, s55, 4096
    buffer_load_dwordx2 v[124:125], v3, s[12:15], s48 offen offset:8 sc1
    s_waitcnt vmcnt(2)
    v_fma_mix_f32 v32, v116, 1.0, v32 op_sel:[0,0,0] op_sel_hi:[1,0,0]
    v_fma_mix_f32 v33, v116, 1.0, v33 op_sel:[1,0,0] op_sel_hi:[1,0,0]
    v_fma_mix_f32 v34, v117, 1.0, v34 op_sel:[0,0,0] op_sel_hi:[1,0,0]
    v_fma_mix_f32 v35, v117, 1.0, v35 op_sel:[1,0,0] op_sel_hi:[1,0,0]
    v_cvt_pk_bf16_f32 v140, v32, v33
    v_cvt_pk_bf16_f32 v141, v34, v35
    v_lshlrev_b32 v32, 16, v140
    v_and_b32 v33, 0xffff0000, v140
    v_lshlrev_b32 v34, 16, v141
    v_and_b32 v35, 0xffff0000, v141
    v_pk_add_f32 v[32:33], v[32:33], v[8:9]
    v_pk_add_f32 v[34:35], v[34:35], v[10:11]
    v_cvt_pk_bf16_f32 v140, v32, v33
    v_cvt_pk_bf16_f32 v141, v34, v35
    v_lshlrev_b32 v32, 16, v140
    v_and_b32 v33, 0xffff0000, v140
    v_lshlrev_b32 v34, 16, v141
    v_and_b32 v35, 0xffff0000, v141
    v_pk_mul_f32 v[140:141], v[32:33], v[32:33]
    v_pk_mul_f32 v[142:143], v[34:35], v[34:35]
    v_pk_fma_f32 v[140:141], v[140:141], v[20:21], v[24:25] op_sel_hi:[1,0,0]
    v_pk_fma_f32 v[142:143], v[142:143], v[20:21], v[24:25] op_sel_hi:[1,0,0]
    v_pk_mul_f32 v[140:141], v[140:141], v[32:33]
    v_pk_mul_f32 v[142:143], v[142:143], v[34:35]
    v_exp_f32 v140, v140
    v_exp_f32 v141, v141
    v_exp_f32 v142, v142
    v_exp_f32 v143, v143
    s_nop 0
    v_pk_add_f32 v[140:141], v[140:141], v[22:23] op_sel_hi:[1,0]
    v_pk_add_f32 v[142:143], v[142:143], v[22:23] op_sel_hi:[1,0]
    v_rcp_f32 v140, v140
    v_rcp_f32 v141, v141
    v_rcp_f32 v142, v142
    v_rcp_f32 v143, v143
    s_nop 0
    v_pk_mul_f32 v[32:33], v[32:33], v[140:141]
    v_pk_mul_f32 v[34:35], v[34:35], v[142:143]
    v_fma_mix_f32 v36, v118, 1.0, v36 op_sel:[0,0,0] op_sel_hi:[1,0,0]
    v_fma_mix_f32 v37, v118, 1.0, v37 op_sel:[1,0,0] op_sel_hi:[1,0,0]
    v_fma_mix_f32 v38, v119, 1.0, v38 op_sel:[0,0,0] op_sel_hi:[1,0,0]
    v_fma_mix_f32 v39, v119, 1.0, v39 op_sel:[1,0,0] op_sel_hi:[1,0,0]
    v_cvt_pk_bf16_f32 v140, v36, v37
    v_cvt_pk_bf16_f32 v141, v38, v39
    v_lshlrev_b32 v36, 16, v140
    v_and_b32 v37, 0xffff0000, v140
    v_lshlrev_b32 v38, 16, v141
    v_and_b32 v39, 0xffff0000, v141
    v_pk_add_f32 v[36:37], v[36:37], v[12:13]
    v_pk_add_f32 v[38:39], v[38:39], v[14:15]
    v_cvt_pk_bf16_f32 v140, v36, v37
    v_cvt_pk_bf16_f32 v141, v38, v39
    v_lshlrev_b32 v36, 16, v140
    v_and_b32 v37, 0xffff0000, v140
    v_lshlrev_b32 v38, 16, v141
    v_and_b32 v39, 0xffff0000, v141
    v_pk_mul_f32 v[140:141], v[36:37], v[36:37]
    v_pk_mul_f32 v[142:143], v[38:39], v[38:39]
    v_pk_fma_f32 v[140:141], v[140:141], v[20:21], v[24:25] op_sel_hi:[1,0,0]
    v_pk_fma_f32 v[142:143], v[142:143], v[20:21], v[24:25] op_sel_hi:[1,0,0]
    v_pk_mul_f32 v[140:141], v[140:141], v[36:37]
    v_pk_mul_f32 v[142:143], v[142:143], v[38:39]
    v_exp_f32 v140, v140
    v_exp_f32 v141, v141
    v_exp_f32 v142, v142
    v_exp_f32 v143, v143
    s_nop 0
    v_pk_add_f32 v[140:141], v[140:141], v[22:23] op_sel_hi:[1,0]
    v_pk_add_f32 v[142:143], v[142:143], v[22:23] op_sel_hi:[1,0]
    v_rcp_f32 v140, v140
    v_rcp_f32 v141, v141
    v_rcp_f32 v142, v142
    v_rcp_f32 v143, v143
    s_nop 0
    v_pk_mul_f32 v[36:37], v[36:37], v[140:141]
    v_pk_mul_f32 v[38:39], v[38:39], v[142:143]
    v_cvt_pk_bf16_f32 v144, v32, v33
    v_cvt_pk_bf16_f32 v145, v34, v35
    v_cvt_pk_bf16_f32 v146, v36, v37
    v_cvt_pk_bf16_f32 v147, v38, v39

    s_lshl_b32 s48, s25, 1
    s_add_u32 s48, s48, 2
    s_cmp_ge_u32 s48, 9
    s_cselect_b32 s39, 9, 0
    s_sub_u32 s48, s48, s39
    s_lshl_b32 s48, s48, 8

    s_add_u32 s48, s48, s58
    buffer_store_dwordx4 v[144:147], v4, s[12:15], s48 offen sc1
    s_waitcnt vmcnt(2)
    v_fma_mix_f32 v40, v120, 1.0, v40 op_sel:[0,0,0] op_sel_hi:[1,0,0]
    v_fma_mix_f32 v41, v120, 1.0, v41 op_sel:[1,0,0] op_sel_hi:[1,0,0]
    v_fma_mix_f32 v42, v121, 1.0, v42 op_sel:[0,0,0] op_sel_hi:[1,0,0]
    v_fma_mix_f32 v43, v121, 1.0, v43 op_sel:[1,0,0] op_sel_hi:[1,0,0]
    v_cvt_pk_bf16_f32 v140, v40, v41
    v_cvt_pk_bf16_f32 v141, v42, v43
    v_lshlrev_b32 v40, 16, v140
    v_and_b32 v41, 0xffff0000, v140
    v_lshlrev_b32 v42, 16, v141
    v_and_b32 v43, 0xffff0000, v141
    v_pk_add_f32 v[40:41], v[40:41], v[8:9]
    v_pk_add_f32 v[42:43], v[42:43], v[10:11]
    v_cvt_pk_bf16_f32 v140, v40, v41
    v_cvt_pk_bf16_f32 v141, v42, v43
    v_lshlrev_b32 v40, 16, v140
    v_and_b32 v41, 0xffff0000, v140
    v_lshlrev_b32 v42, 16, v141
    v_and_b32 v43, 0xffff0000, v141
    v_pk_mul_f32 v[140:141], v[40:41], v[40:41]
    v_pk_mul_f32 v[142:143], v[42:43], v[42:43]
    v_pk_fma_f32 v[140:141], v[140:141], v[20:21], v[24:25] op_sel_hi:[1,0,0]
    v_pk_fma_f32 v[142:143], v[142:143], v[20:21], v[24:25] op_sel_hi:[1,0,0]
    v_pk_mul_f32 v[140:141], v[140:141], v[40:41]
    v_pk_mul_f32 v[142:143], v[142:143], v[42:43]
    v_exp_f32 v140, v140
    v_exp_f32 v141, v141
    v_exp_f32 v142, v142
    v_exp_f32 v143, v143
    s_nop 0
    v_pk_add_f32 v[140:141], v[140:141], v[22:23] op_sel_hi:[1,0]
    v_pk_add_f32 v[142:143], v[142:143], v[22:23] op_sel_hi:[1,0]
    v_rcp_f32 v140, v140
    v_rcp_f32 v141, v141
    v_rcp_f32 v142, v142
    v_rcp_f32 v143, v143
    s_nop 0
    v_pk_mul_f32 v[40:41], v[40:41], v[140:141]
    v_pk_mul_f32 v[42:43], v[42:43], v[142:143]
    v_fma_mix_f32 v44, v122, 1.0, v44 op_sel:[0,0,0] op_sel_hi:[1,0,0]
    v_fma_mix_f32 v45, v122, 1.0, v45 op_sel:[1,0,0] op_sel_hi:[1,0,0]
    v_fma_mix_f32 v46, v123, 1.0, v46 op_sel:[0,0,0] op_sel_hi:[1,0,0]
    v_fma_mix_f32 v47, v123, 1.0, v47 op_sel:[1,0,0] op_sel_hi:[1,0,0]
    v_cvt_pk_bf16_f32 v140, v44, v45
    v_cvt_pk_bf16_f32 v141, v46, v47
    v_lshlrev_b32 v44, 16, v140
    v_and_b32 v45, 0xffff0000, v140
    v_lshlrev_b32 v46, 16, v141
    v_and_b32 v47, 0xffff0000, v141
    v_pk_add_f32 v[44:45], v[44:45], v[12:13]
    v_pk_add_f32 v[46:47], v[46:47], v[14:15]
    v_cvt_pk_bf16_f32 v140, v44, v45
    v_cvt_pk_bf16_f32 v141, v46, v47
    v_lshlrev_b32 v44, 16, v140
    v_and_b32 v45, 0xffff0000, v140
    v_lshlrev_b32 v46, 16, v141
    v_and_b32 v47, 0xffff0000, v141
    v_pk_mul_f32 v[140:141], v[44:45], v[44:45]
    v_pk_mul_f32 v[142:143], v[46:47], v[46:47]
    v_pk_fma_f32 v[140:141], v[140:141], v[20:21], v[24:25] op_sel_hi:[1,0,0]
    v_pk_fma_f32 v[142:143], v[142:143], v[20:21], v[24:25] op_sel_hi:[1,0,0]
    v_pk_mul_f32 v[140:141], v[140:141], v[44:45]
    v_pk_mul_f32 v[142:143], v[142:143], v[46:47]
    v_exp_f32 v140, v140
    v_exp_f32 v141, v141
    v_exp_f32 v142, v142
    v_exp_f32 v143, v143
    s_nop 0
    v_pk_add_f32 v[140:141], v[140:141], v[22:23] op_sel_hi:[1,0]
    v_pk_add_f32 v[142:143], v[142:143], v[22:23] op_sel_hi:[1,0]
    v_rcp_f32 v140, v140
    v_rcp_f32 v141, v141
    v_rcp_f32 v142, v142
    v_rcp_f32 v143, v143
    s_nop 0
    v_pk_mul_f32 v[44:45], v[44:45], v[140:141]
    v_pk_mul_f32 v[46:47], v[46:47], v[142:143]
    v_cvt_pk_bf16_f32 v144, v40, v41
    v_cvt_pk_bf16_f32 v145, v42, v43
    v_cvt_pk_bf16_f32 v146, v44, v45
    v_cvt_pk_bf16_f32 v147, v46, v47

    s_lshl_b32 s48, s25, 1
    s_add_u32 s48, s48, 3
    s_cmp_ge_u32 s48, 9
    s_cselect_b32 s39, 9, 0
    s_sub_u32 s48, s48, s39
    s_lshl_b32 s48, s48, 8

    s_add_u32 s48, s48, s58
    buffer_store_dwordx4 v[144:147], v4, s[12:15], s48 offen sc1
    s_waitcnt vmcnt(2)
    v_fma_mix_f32 v48, v124, 1.0, v48 op_sel:[0,0,0] op_sel_hi:[1,0,0]
    v_fma_mix_f32 v49, v124, 1.0, v49 op_sel:[1,0,0] op_sel_hi:[1,0,0]
    v_fma_mix_f32 v50, v125, 1.0, v50 op_sel:[0,0,0] op_sel_hi:[1,0,0]
    v_fma_mix_f32 v51, v125, 1.0, v51 op_sel:[1,0,0] op_sel_hi:[1,0,0]
    v_cvt_pk_bf16_f32 v140, v48, v49
    v_cvt_pk_bf16_f32 v141, v50, v51
    v_lshlrev_b32 v48, 16, v140
    v_and_b32 v49, 0xffff0000, v140
    v_lshlrev_b32 v50, 16, v141
    v_and_b32 v51, 0xffff0000, v141
    v_pk_add_f32 v[48:49], v[48:49], v[12:13]
    v_pk_add_f32 v[50:51], v[50:51], v[14:15]
    v_cvt_pk_bf16_f32 v140, v48, v49
    v_cvt_pk_bf16_f32 v141, v50, v51
    v_lshlrev_b32 v48, 16, v140
    v_and_b32 v49, 0xffff0000, v140
    v_lshlrev_b32 v50, 16, v141
    v_and_b32 v51, 0xffff0000, v141
    v_pk_mul_f32 v[140:141], v[48:49], v[48:49]
    v_pk_mul_f32 v[142:143], v[50:51], v[50:51]
    v_pk_fma_f32 v[140:141], v[140:141], v[20:21], v[24:25] op_sel_hi:[1,0,0]
    v_pk_fma_f32 v[142:143], v[142:143], v[20:21], v[24:25] op_sel_hi:[1,0,0]
    v_pk_mul_f32 v[140:141], v[140:141], v[48:49]
    v_pk_mul_f32 v[142:143], v[142:143], v[50:51]
    v_exp_f32 v140, v140
    v_exp_f32 v141, v141
    v_exp_f32 v142, v142
    v_exp_f32 v143, v143
    s_nop 0
    v_pk_add_f32 v[140:141], v[140:141], v[22:23] op_sel_hi:[1,0]
    v_pk_add_f32 v[142:143], v[142:143], v[22:23] op_sel_hi:[1,0]
    v_rcp_f32 v140, v140
    v_rcp_f32 v141, v141
    v_rcp_f32 v142, v142
    v_rcp_f32 v143, v143
    s_nop 0
    v_pk_mul_f32 v[48:49], v[48:49], v[140:141]
    v_pk_mul_f32 v[50:51], v[50:51], v[142:143]
    s_lshl_b32 s48, s25, 1
    s_add_u32 s48, s48, 4
    s_cmp_ge_u32 s48, 9
    s_cselect_b32 s39, 9, 0
    s_sub_u32 s48, s48, s39
    s_lshl_b32 s48, s48, 8

    s_add_u32 s48, s48, s58
    v_cvt_pk_bf16_f32 v148, v48, v49
    v_cvt_pk_bf16_f32 v149, v50, v51
    buffer_store_dwordx2 v[148:149], v4, s[12:15], s48 offen offset:8 sc1

    s_branch L_m_t1_done
L_m_h1_k1:
    buffer_load_dwordx4 v[116:119], v3, s[12:15], s55 offen offset:2048 sc1
    buffer_load_dwordx4 v[120:123], v3, s[12:15], s55 offen offset:3072 sc1
    s_add_u32 s48, s55, 4096
    buffer_load_dwordx2 v[124:125], v3, s[12:15], s48 offen offset:8 sc1
    s_waitcnt vmcnt(2)
    v_fma_mix_f32 v32, v116, 1.0, v32 op_sel:[0,0,0] op_sel_hi:[1,0,0]
    v_fma_mix_f32 v33, v116, 1.0, v33 op_sel:[1,0,0] op_sel_hi:[1,0,0]
    v_fma_mix_f32 v34, v117, 1.0, v34 op_sel:[0,0,0] op_sel_hi:[1,0,0]
    v_fma_mix_f32 v35, v117, 1.0, v35 op_sel:[1,0,0] op_sel_hi:[1,0,0]
    v_cvt_pk_bf16_f32 v140, v32, v33
    v_cvt_pk_bf16_f32 v141, v34, v35
    v_lshlrev_b32 v32, 16, v140
    v_and_b32 v33, 0xffff0000, v140
    v_lshlrev_b32 v34, 16, v141
    v_and_b32 v35, 0xffff0000, v141
    v_pk_add_f32 v[32:33], v[32:33], v[8:9]
    v_pk_add_f32 v[34:35], v[34:35], v[10:11]
    v_cvt_pk_bf16_f32 v140, v32, v33
    v_cvt_pk_bf16_f32 v141, v34, v35
    v_lshlrev_b32 v32, 16, v140
    v_and_b32 v33, 0xffff0000, v140
    v_lshlrev_b32 v34, 16, v141
    v_and_b32 v35, 0xffff0000, v141
    v_pk_mul_f32 v[140:141], v[32:33], v[32:33]
    v_pk_mul_f32 v[142:143], v[34:35], v[34:35]
    v_pk_fma_f32 v[140:141], v[140:141], v[20:21], v[24:25] op_sel_hi:[1,0,0]
    v_pk_fma_f32 v[142:143], v[142:143], v[20:21], v[24:25] op_sel_hi:[1,0,0]
    v_pk_mul_f32 v[140:141], v[140:141], v[32:33]
    v_pk_mul_f32 v[142:143], v[142:143], v[34:35]
    v_exp_f32 v140, v140
    v_exp_f32 v141, v141
    v_exp_f32 v142, v142
    v_exp_f32 v143, v143
    s_nop 0
    v_pk_add_f32 v[140:141], v[140:141], v[22:23] op_sel_hi:[1,0]
    v_pk_add_f32 v[142:143], v[142:143], v[22:23] op_sel_hi:[1,0]
    v_rcp_f32 v140, v140
    v_rcp_f32 v141, v141
    v_rcp_f32 v142, v142
    v_rcp_f32 v143, v143
    s_nop 0
    v_pk_mul_f32 v[32:33], v[32:33], v[140:141]
    v_pk_mul_f32 v[34:35], v[34:35], v[142:143]
    v_fma_mix_f32 v36, v118, 1.0, v36 op_sel:[0,0,0] op_sel_hi:[1,0,0]
    v_fma_mix_f32 v37, v118, 1.0, v37 op_sel:[1,0,0] op_sel_hi:[1,0,0]
    v_fma_mix_f32 v38, v119, 1.0, v38 op_sel:[0,0,0] op_sel_hi:[1,0,0]
    v_fma_mix_f32 v39, v119, 1.0, v39 op_sel:[1,0,0] op_sel_hi:[1,0,0]
    v_cvt_pk_bf16_f32 v140, v36, v37
    v_cvt_pk_bf16_f32 v141, v38, v39
    v_lshlrev_b32 v36, 16, v140
    v_and_b32 v37, 0xffff0000, v140
    v_lshlrev_b32 v38, 16, v141
    v_and_b32 v39, 0xffff0000, v141
    v_pk_add_f32 v[36:37], v[36:37], v[12:13]
    v_pk_add_f32 v[38:39], v[38:39], v[14:15]
    v_cvt_pk_bf16_f32 v140, v36, v37
    v_cvt_pk_bf16_f32 v141, v38, v39
    v_lshlrev_b32 v36, 16, v140
    v_and_b32 v37, 0xffff0000, v140
    v_lshlrev_b32 v38, 16, v141
    v_and_b32 v39, 0xffff0000, v141
    v_pk_mul_f32 v[140:141], v[36:37], v[36:37]
    v_pk_mul_f32 v[142:143], v[38:39], v[38:39]
    v_pk_fma_f32 v[140:141], v[140:141], v[20:21], v[24:25] op_sel_hi:[1,0,0]
    v_pk_fma_f32 v[142:143], v[142:143], v[20:21], v[24:25] op_sel_hi:[1,0,0]
    v_pk_mul_f32 v[140:141], v[140:141], v[36:37]
    v_pk_mul_f32 v[142:143], v[142:143], v[38:39]
    v_exp_f32 v140, v140
    v_exp_f32 v141, v141
    v_exp_f32 v142, v142
    v_exp_f32 v143, v143
    s_nop 0
    v_pk_add_f32 v[140:141], v[140:141], v[22:23] op_sel_hi:[1,0]
    v_pk_add_f32 v[142:143], v[142:143], v[22:23] op_sel_hi:[1,0]
    v_rcp_f32 v140, v140
    v_rcp_f32 v141, v141
    v_rcp_f32 v142, v142
    v_rcp_f32 v143, v143
    s_nop 0
    v_pk_mul_f32 v[36:37], v[36:37], v[140:141]
    v_pk_mul_f32 v[38:39], v[38:39], v[142:143]
    v_cvt_pk_bf16_f32 v144, v32, v33
    v_cvt_pk_bf16_f32 v145, v34, v35
    v_cvt_pk_bf16_f32 v146, v36, v37
    v_cvt_pk_bf16_f32 v147, v38, v39

    s_lshl_b32 s48, s25, 1
    s_add_u32 s48, s48, 7
    s_cmp_ge_u32 s48, 9
    s_cselect_b32 s39, 9, 0
    s_sub_u32 s48, s48, s39
    s_lshl_b32 s48, s48, 8

    s_add_u32 s48, s48, s58
    buffer_store_dwordx4 v[144:147], v4, s[12:15], s48 offen sc1
    s_waitcnt vmcnt(2)
    v_fma_mix_f32 v40, v120, 1.0, v40 op_sel:[0,0,0] op_sel_hi:[1,0,0]
    v_fma_mix_f32 v41, v120, 1.0, v41 op_sel:[1,0,0] op_sel_hi:[1,0,0]
    v_fma_mix_f32 v42, v121, 1.0, v42 op_sel:[0,0,0] op_sel_hi:[1,0,0]
    v_fma_mix_f32 v43, v121, 1.0, v43 op_sel:[1,0,0] op_sel_hi:[1,0,0]
    v_cvt_pk_bf16_f32 v140, v40, v41
    v_cvt_pk_bf16_f32 v141, v42, v43
    v_lshlrev_b32 v40, 16, v140
    v_and_b32 v41, 0xffff0000, v140
    v_lshlrev_b32 v42, 16, v141
    v_and_b32 v43, 0xffff0000, v141
    v_pk_add_f32 v[40:41], v[40:41], v[8:9]
    v_pk_add_f32 v[42:43], v[42:43], v[10:11]
    v_cvt_pk_bf16_f32 v140, v40, v41
    v_cvt_pk_bf16_f32 v141, v42, v43
    v_lshlrev_b32 v40, 16, v140
    v_and_b32 v41, 0xffff0000, v140
    v_lshlrev_b32 v42, 16, v141
    v_and_b32 v43, 0xffff0000, v141
    v_pk_mul_f32 v[140:141], v[40:41], v[40:41]
    v_pk_mul_f32 v[142:143], v[42:43], v[42:43]
    v_pk_fma_f32 v[140:141], v[140:141], v[20:21], v[24:25] op_sel_hi:[1,0,0]
    v_pk_fma_f32 v[142:143], v[142:143], v[20:21], v[24:25] op_sel_hi:[1,0,0]
    v_pk_mul_f32 v[140:141], v[140:141], v[40:41]
    v_pk_mul_f32 v[142:143], v[142:143], v[42:43]
    v_exp_f32 v140, v140
    v_exp_f32 v141, v141
    v_exp_f32 v142, v142
    v_exp_f32 v143, v143
    s_nop 0
    v_pk_add_f32 v[140:141], v[140:141], v[22:23] op_sel_hi:[1,0]
    v_pk_add_f32 v[142:143], v[142:143], v[22:23] op_sel_hi:[1,0]
    v_rcp_f32 v140, v140
    v_rcp_f32 v141, v141
    v_rcp_f32 v142, v142
    v_rcp_f32 v143, v143
    s_nop 0
    v_pk_mul_f32 v[40:41], v[40:41], v[140:141]
    v_pk_mul_f32 v[42:43], v[42:43], v[142:143]
    v_fma_mix_f32 v44, v122, 1.0, v44 op_sel:[0,0,0] op_sel_hi:[1,0,0]
    v_fma_mix_f32 v45, v122, 1.0, v45 op_sel:[1,0,0] op_sel_hi:[1,0,0]
    v_fma_mix_f32 v46, v123, 1.0, v46 op_sel:[0,0,0] op_sel_hi:[1,0,0]
    v_fma_mix_f32 v47, v123, 1.0, v47 op_sel:[1,0,0] op_sel_hi:[1,0,0]
    v_cvt_pk_bf16_f32 v140, v44, v45
    v_cvt_pk_bf16_f32 v141, v46, v47
    v_lshlrev_b32 v44, 16, v140
    v_and_b32 v45, 0xffff0000, v140
    v_lshlrev_b32 v46, 16, v141
    v_and_b32 v47, 0xffff0000, v141
    v_pk_add_f32 v[44:45], v[44:45], v[12:13]
    v_pk_add_f32 v[46:47], v[46:47], v[14:15]
    v_cvt_pk_bf16_f32 v140, v44, v45
    v_cvt_pk_bf16_f32 v141, v46, v47
    v_lshlrev_b32 v44, 16, v140
    v_and_b32 v45, 0xffff0000, v140
    v_lshlrev_b32 v46, 16, v141
    v_and_b32 v47, 0xffff0000, v141
    v_pk_mul_f32 v[140:141], v[44:45], v[44:45]
    v_pk_mul_f32 v[142:143], v[46:47], v[46:47]
    v_pk_fma_f32 v[140:141], v[140:141], v[20:21], v[24:25] op_sel_hi:[1,0,0]
    v_pk_fma_f32 v[142:143], v[142:143], v[20:21], v[24:25] op_sel_hi:[1,0,0]
    v_pk_mul_f32 v[140:141], v[140:141], v[44:45]
    v_pk_mul_f32 v[142:143], v[142:143], v[46:47]
    v_exp_f32 v140, v140
    v_exp_f32 v141, v141
    v_exp_f32 v142, v142
    v_exp_f32 v143, v143
    s_nop 0
    v_pk_add_f32 v[140:141], v[140:141], v[22:23] op_sel_hi:[1,0]
    v_pk_add_f32 v[142:143], v[142:143], v[22:23] op_sel_hi:[1,0]
    v_rcp_f32 v140, v140
    v_rcp_f32 v141, v141
    v_rcp_f32 v142, v142
    v_rcp_f32 v143, v143
    s_nop 0
    v_pk_mul_f32 v[44:45], v[44:45], v[140:141]
    v_pk_mul_f32 v[46:47], v[46:47], v[142:143]
    v_cvt_pk_bf16_f32 v144, v40, v41
    v_cvt_pk_bf16_f32 v145, v42, v43
    v_cvt_pk_bf16_f32 v146, v44, v45
    v_cvt_pk_bf16_f32 v147, v46, v47

    s_lshl_b32 s48, s25, 1
    s_add_u32 s48, s48, 8
    s_cmp_ge_u32 s48, 9
    s_cselect_b32 s39, 9, 0
    s_sub_u32 s48, s48, s39
    s_lshl_b32 s48, s48, 8

    s_add_u32 s48, s48, s58
    buffer_store_dwordx4 v[144:147], v4, s[12:15], s48 offen sc1
    s_waitcnt vmcnt(2)
    v_fma_mix_f32 v48, v124, 1.0, v48 op_sel:[0,0,0] op_sel_hi:[1,0,0]
    v_fma_mix_f32 v49, v124, 1.0, v49 op_sel:[1,0,0] op_sel_hi:[1,0,0]
    v_fma_mix_f32 v50, v125, 1.0, v50 op_sel:[0,0,0] op_sel_hi:[1,0,0]
    v_fma_mix_f32 v51, v125, 1.0, v51 op_sel:[1,0,0] op_sel_hi:[1,0,0]
    v_cvt_pk_bf16_f32 v140, v48, v49
    v_cvt_pk_bf16_f32 v141, v50, v51
    v_lshlrev_b32 v48, 16, v140
    v_and_b32 v49, 0xffff0000, v140
    v_lshlrev_b32 v50, 16, v141
    v_and_b32 v51, 0xffff0000, v141
    v_pk_add_f32 v[48:49], v[48:49], v[16:17]
    v_pk_add_f32 v[50:51], v[50:51], v[18:19]
    v_cvt_pk_bf16_f32 v140, v48, v49
    v_cvt_pk_bf16_f32 v141, v50, v51
    v_lshlrev_b32 v48, 16, v140
    v_and_b32 v49, 0xffff0000, v140
    v_lshlrev_b32 v50, 16, v141
    v_and_b32 v51, 0xffff0000, v141
    v_pk_mul_f32 v[140:141], v[48:49], v[48:49]
    v_pk_mul_f32 v[142:143], v[50:51], v[50:51]
    v_pk_fma_f32 v[140:141], v[140:141], v[20:21], v[24:25] op_sel_hi:[1,0,0]
    v_pk_fma_f32 v[142:143], v[142:143], v[20:21], v[24:25] op_sel_hi:[1,0,0]
    v_pk_mul_f32 v[140:141], v[140:141], v[48:49]
    v_pk_mul_f32 v[142:143], v[142:143], v[50:51]
    v_exp_f32 v140, v140
    v_exp_f32 v141, v141
    v_exp_f32 v142, v142
    v_exp_f32 v143, v143
    s_nop 0
    v_pk_add_f32 v[140:141], v[140:141], v[22:23] op_sel_hi:[1,0]
    v_pk_add_f32 v[142:143], v[142:143], v[22:23] op_sel_hi:[1,0]
    v_rcp_f32 v140, v140
    v_rcp_f32 v141, v141
    v_rcp_f32 v142, v142
    v_rcp_f32 v143, v143
    s_nop 0
    v_pk_mul_f32 v[48:49], v[48:49], v[140:141]
    v_pk_mul_f32 v[50:51], v[50:51], v[142:143]
    s_lshl_b32 s48, s25, 1
    s_add_u32 s48, s48, 1
    s_cmp_ge_u32 s48, 9
    s_cselect_b32 s39, 9, 0
    s_sub_u32 s48, s48, s39
    s_lshl_b32 s48, s48, 8

    s_add_u32 s48, s48, s59
    v_cvt_pk_bf16_f32 v148, v48, v49
    v_cvt_pk_bf16_f32 v149, v50, v51
    buffer_store_dwordx2 v[148:149], v4, s[12:15], s48 offen offset:0 sc1

L_m_t1_done:
    s_waitcnt vmcnt(0)
    s_barrier
    s_cmp_eq_u32 s24, 0
    s_cbranch_scc0 L_m_nogf
    s_lshl_b32 s38, s34, 2
    s_lshr_b32 s39, s33, 3
    s_add_u32 s38, s38, s39
    s_mul_i32 s38, s38, 17408
    s_and_b32 s39, s33, 7
    s_lshl_b32 s39, s39, 1
    s_add_u32 s39, s39, s32
    s_lshl_b32 s39, s39, 7
    s_add_u32 s38, s38, s39
    s_add_u32 s38, s38, 31981568
    v_lshrrev_b32 v6, 2, v0
    v_mul_u32_u24 v6, 2176, v6
    v_and_b32 v7, 3, v0
    v_lshl_add_u32 v6, v7, 4, v6
    v_mov_b32 v8, s28
    v_mov_b32 v9, s28
    v_mov_b32 v10, s28
    v_mov_b32 v11, s28
    s_mov_b32 exec_hi, 0
    buffer_store_dwordx4 v[8:11], v6, s[12:15], s38 offen sc1
    s_mov_b64 exec, 1
    v_mov_b32 v6, 0
    v_mov_b32 v7, s28

    s_mov_b64 exec, -1
L_m_nogf:
    s_mov_b32 s20, s10
    s_and_b32 s21, s11, 0xffff
    s_mov_b32 s22, 4096
    s_mov_b32 s23, 0x00020000
    s_mov_b32 s64, s46
    s_and_b32 s65, s47, 0xffff
    s_mov_b32 s66, 2359296
    s_mov_b32 s67, 0x00020000
    s_lshr_b32 s38, s24, 2
    s_lshl_b32 s39, s36, 1
    s_add_u32 s39, s39, s38
    s_lshl_b32 s39, s39, 4
    s_lshl_b32 s48, s37, 7
    s_add_u32 s62, s48, s39
    s_lshl_b32 s39, s36, 1
    s_add_u32 s39, s39, s24
    s_lshl_b32 s39, s39, 4
    s_add_u32 s63, s48, s39
    v_lshlrev_b32 v156, 1, v1
    s_lshl_b32 s38, s62, 1
    buffer_load_ushort v158, v156, s[20:23], s38 offen
    v_mul_u32_u24 v156, 1152, v1
    v_lshlrev_b32 v157, 4, v2
    v_add_u32 v156, v156, v157
    s_mul_i32 s68, s62, 1152
    s_mul_i32 s38, s34, 288
    s_add_u32 s68, s68, s38
    s_and_b32 s39, s24, 3
    s_lshl_b32 s39, s39, 6
    s_add_u32 s68, s68, s39
    s_cmp_ge_u32 s24, 2
    s_cbranch_scc1 L_m_nosing
    v_lshlrev_b32 v157, 1, v1
    s_lshl_b32 s39, s63, 1
    buffer_load_ushort v159, v157, s[20:23], s39 offen
    v_mul_u32_u24 v157, 1152, v1
    v_lshlrev_b32 v122, 3, v2
    v_add_u32 v157, v157, v122
    s_mul_i32 s69, s63, 1152
    s_add_u32 s69, s69, s38
    s_add_u32 s69, s69, 256

L_m_nosing:
    v_lshrrev_b32 v122, 2, v1
    v_mul_u32_u24 v122, 9216, v122
    v_and_b32 v123, 3, v1
    v_lshl_add_u32 v122, v123, 1, v122
    v_lshl_add_u32 v123, v2, 6, v122
    v_lshl_add_u32 v122, v2, 7, v122
    s_mul_i32 s38, s34, 144
    s_and_b32 s39, s24, 3
    s_lshl_b32 s39, s39, 5
    s_add_u32 s39, s39, s38
    s_lshl_b32 s73, s39, 4
    s_lshr_b32 s39, s62, 5
    s_mul_i32 s39, s39, 36864
    s_add_u32 s73, s73, s39
    s_lshr_b32 s39, s62, 4
    s_and_b32 s39, s39, 1
    s_lshl_b32 s39, s39, 3
    s_add_u32 s73, s73, s39
    s_add_u32 s73, s73, 10485760
    s_add_u32 s38, s38, 128
    s_lshl_b32 s72, s38, 4
    s_lshr_b32 s39, s63, 5
    s_mul_i32 s39, s39, 36864
    s_add_u32 s72, s72, s39
    s_lshr_b32 s39, s63, 4
    s_and_b32 s39, s39, 1
    s_lshl_b32 s39, s39, 3
    s_add_u32 s72, s72, s39
    s_add_u32 s72, s72, 10485760

    buffer_load_ushort v116, v122, s[12:15], s73 offen offset:0
    buffer_load_ushort v108, v122, s[12:15], s73 offen offset:16
    buffer_load_ushort v117, v122, s[12:15], s73 offen offset:32
    buffer_load_ushort v109, v122, s[12:15], s73 offen offset:48
    buffer_load_ushort v118, v122, s[12:15], s73 offen offset:64
    buffer_load_ushort v110, v122, s[12:15], s73 offen offset:80
    buffer_load_ushort v119, v122, s[12:15], s73 offen offset:96
    buffer_load_ushort v111, v122, s[12:15], s73 offen offset:112
    s_cmp_ge_u32 s24, 2
    s_cbranch_scc1 L_m_hs_5
    buffer_load_ushort v120, v123, s[12:15], s72 offen offset:0
    buffer_load_ushort v112, v123, s[12:15], s72 offen offset:16
    buffer_load_ushort v121, v123, s[12:15], s72 offen offset:32
    buffer_load_ushort v113, v123, s[12:15], s72 offen offset:48
L_m_hs_5:
    s_cmp_ge_u32 s24, 4
    s_cbranch_scc1 L_m_loader2
    v_lshrrev_b32 v15, 2, v1
    v_lshlrev_b32 v15, 3, v15
    v_and_b32 v16, 3, v1
    v_add_u32 v15, v15, v16
    v_and_b32 v16, 1, v2
    v_lshlrev_b32 v16, 2, v16
    v_mul_u32_u24 v17, 2304, v2
    v_add_u32 v18, v15, v16
    v_lshlrev_b32 v18, 4, v18
    v_add_u32 v5, v17, v18
    v_xor_b32 v18, 4, v16
    v_add_u32 v18, v15, v18
    v_lshlrev_b32 v18, 4, v18
    v_add_u32 v6, v17, v18
    v_xor_b32 v18, v1, v16
    v_add_u32 v18, 128, v18
    v_lshlrev_b32 v18, 4, v18
    v_add_u32 v7, v17, v18
    v_lshrrev_b32 v15, 2, v1
    v_lshlrev_b32 v16, 2, v2
    v_add_u32 v15, v15, v16
    v_and_b32 v16, 7, v15
    v_lshlrev_b32 v15, 8, v15
    v_and_b32 v17, 3, v1
    v_lshlrev_b32 v17, 3, v17
    v_add_u32 v15, v15, v17
    v_add_u32 v15, 18432, v15
    s_lshl_b32 s38, s25, 1
    v_xor_b32 v17, s38, v16
    v_lshlrev_b32 v17, 5, v17
    v_add_u32 v11, v15, v17
    s_add_u32 s38, s38, 1
    v_xor_b32 v17, s38, v16
    v_lshlrev_b32 v17, 5, v17
    v_add_u32 v12, v15, v17

    v_add_u32 v8, 69632, v5
    v_add_u32 v9, 69632, v6
    v_add_u32 v10, 69632, v7
    v_add_u32 v13, 69632, v11
    v_add_u32 v14, 69632, v12
    v_mov_b32 v32, 0
    v_mov_b32 v33, 0
    v_mov_b32 v34, 0
    v_mov_b32 v35, 0
    v_mov_b32 v36, 0
    v_mov_b32 v37, 0
    v_mov_b32 v38, 0
    v_mov_b32 v39, 0
    v_mov_b32 v40, 0
    v_mov_b32 v41, 0
    v_mov_b32 v42, 0
    v_mov_b32 v43, 0
    v_mov_b32 v44, 0
    v_mov_b32 v45, 0
    v_mov_b32 v46, 0
    v_mov_b32 v47, 0
    v_mov_b32 v48, 0
    v_mov_b32 v49, 0
    v_mov_b32 v50, 0
    v_mov_b32 v51, 0
    v_mov_b32 v52, 0
    v_mov_b32 v53, 0
    v_mov_b32 v54, 0
    v_mov_b32 v55, 0
    v_mov_b32 v56, 0
    v_mov_b32 v57, 0
    v_mov_b32 v58, 0
    v_mov_b32 v59, 0
    v_mov_b32 v60, 0
    v_mov_b32 v61, 0
    v_mov_b32 v62, 0
    v_mov_b32 v63, 0
    v_mov_b32 v64, 0
    v_mov_b32 v65, 0
    v_mov_b32 v66, 0
    v_mov_b32 v67, 0
    v_mov_b32 v68, 0
    v_mov_b32 v69, 0
    v_mov_b32 v70, 0
    v_mov_b32 v71, 0
    v_mov_b32 v72, 0
    v_mov_b32 v73, 0
    v_mov_b32 v74, 0
    v_mov_b32 v75, 0
    v_mov_b32 v76, 0
    v_mov_b32 v77, 0
    v_mov_b32 v78, 0
    v_mov_b32 v79, 0
    v_mov_b32 v80, 0
    v_mov_b32 v81, 0
    v_mov_b32 v82, 0
    v_mov_b32 v83, 0
    v_mov_b32 v84, 0
    v_mov_b32 v85, 0
    v_mov_b32 v86, 0
    v_mov_b32 v87, 0
    v_mov_b32 v88, 0
    v_mov_b32 v89, 0
    v_mov_b32 v90, 0
    v_mov_b32 v91, 0
    v_mov_b32 v92, 0
    v_mov_b32 v93, 0
    v_mov_b32 v94, 0
    v_mov_b32 v95, 0
    v_mov_b32 v96, 0
    v_mov_b32 v97, 0
    v_mov_b32 v98, 0
    v_mov_b32 v99, 0
    v_mov_b32 v100, 0
    v_mov_b32 v101, 0
    v_mov_b32 v102, 0
    v_mov_b32 v103, 0
    s_barrier
    ds_read_b64_tr_b16 a[0:1], v11 offset:0
    ds_read_b64_tr_b16 a[2:3], v11 offset:4096
    ds_read_b64_tr_b16 a[4:5], v12 offset:0
    ds_read_b64_tr_b16 a[6:7], v12 offset:4096
    ds_read_b128 a[8:11], v5 offset:0
    ds_read_b128 a[12:15], v6 offset:0
    ds_read_b128 a[16:19], v5 offset:512
    ds_read_b128 a[20:23], v6 offset:512
    ds_read_b128 a[24:27], v5 offset:1024
    ds_read_b128 a[28:31], v6 offset:1024
    ds_read_b128 a[32:35], v5 offset:1536
    ds_read_b128 a[36:39], v6 offset:1536
    ds_read_b128 a[40:43], v7 offset:0
    s_waitcnt lgkmcnt(8)
    v_mfma_f32_16x16x32_bf16 v[32:35], a[8:11], a[0:3], v[32:35]
    ds_read_b64_tr_b16 a[48:49], v11 offset:8192
    v_mfma_f32_16x16x32_bf16 v[36:39], a[8:11], a[4:7], v[36:39]
    ds_read_b64_tr_b16 a[50:51], v11 offset:12288
    s_waitcnt lgkmcnt(9)
    v_mfma_f32_16x16x32_bf16 v[40:43], a[12:15], a[0:3], v[40:43]
    ds_read_b64_tr_b16 a[52:53], v12 offset:8192
    v_mfma_f32_16x16x32_bf16 v[44:47], a[12:15], a[4:7], v[44:47]
    ds_read_b64_tr_b16 a[54:55], v12 offset:12288
    s_waitcnt lgkmcnt(10)
    v_mfma_f32_16x16x32_bf16 v[48:51], a[16:19], a[0:3], v[48:51]
    ds_read_b128 a[56:59], v5 offset:9216
    v_mfma_f32_16x16x32_bf16 v[52:55], a[16:19], a[4:7], v[52:55]
    ds_read_b128 a[60:63], v6 offset:9216
    s_waitcnt lgkmcnt(11)
    v_mfma_f32_16x16x32_bf16 v[56:59], a[20:23], a[0:3], v[56:59]
    ds_read_b128 a[64:67], v5 offset:9728
    v_mfma_f32_16x16x32_bf16 v[60:63], a[20:23], a[4:7], v[60:63]
    ds_read_b128 a[68:71], v6 offset:9728
    s_waitcnt lgkmcnt(12)
    v_mfma_f32_16x16x32_bf16 v[64:67], a[24:27], a[0:3], v[64:67]
    ds_read_b128 a[72:75], v5 offset:10240
    v_mfma_f32_16x16x32_bf16 v[68:71], a[24:27], a[4:7], v[68:71]
    ds_read_b128 a[76:79], v6 offset:10240
    s_waitcnt lgkmcnt(13)
    v_mfma_f32_16x16x32_bf16 v[72:75], a[28:31], a[0:3], v[72:75]
    ds_read_b128 a[80:83], v5 offset:10752
    v_mfma_f32_16x16x32_bf16 v[76:79], a[28:31], a[4:7], v[76:79]
    ds_read_b128 a[84:87], v6 offset:10752
    s_waitcnt lgkmcnt(14)
    v_mfma_f32_16x16x32_bf16 v[80:83], a[32:35], a[0:3], v[80:83]
    ds_read_b128 a[88:91], v7 offset:9216
    v_mfma_f32_16x16x32_bf16 v[84:87], a[32:35], a[4:7], v[84:87]
    s_waitcnt lgkmcnt(14)
    v_mfma_f32_16x16x32_bf16 v[88:91], a[36:39], a[0:3], v[88:91]
    v_mfma_f32_16x16x32_bf16 v[92:95], a[36:39], a[4:7], v[92:95]
    s_waitcnt lgkmcnt(13)
    v_mfma_f32_16x16x32_bf16 v[96:99], a[40:43], a[0:3], v[96:99]
    v_mfma_f32_16x16x32_bf16 v[100:103], a[40:43], a[4:7], v[100:103]
    s_waitcnt lgkmcnt(0)
    s_barrier
    v_mfma_f32_16x16x32_bf16 v[32:35], a[56:59], a[48:51], v[32:35]
    ds_read_b64_tr_b16 a[0:1], v11 offset:34816
    v_mfma_f32_16x16x32_bf16 v[36:39], a[56:59], a[52:55], v[36:39]
    ds_read_b64_tr_b16 a[2:3], v11 offset:38912
    v_mfma_f32_16x16x32_bf16 v[40:43], a[60:63], a[48:51], v[40:43]
    ds_read_b64_tr_b16 a[4:5], v12 offset:34816
    v_mfma_f32_16x16x32_bf16 v[44:47], a[60:63], a[52:55], v[44:47]
    ds_read_b64_tr_b16 a[6:7], v12 offset:38912
    v_mfma_f32_16x16x32_bf16 v[48:51], a[64:67], a[48:51], v[48:51]
    ds_read_b128 a[8:11], v5 offset:34816
    v_mfma_f32_16x16x32_bf16 v[52:55], a[64:67], a[52:55], v[52:55]
    ds_read_b128 a[12:15], v6 offset:34816
    v_mfma_f32_16x16x32_bf16 v[56:59], a[68:71], a[48:51], v[56:59]
    ds_read_b128 a[16:19], v5 offset:35328
    v_mfma_f32_16x16x32_bf16 v[60:63], a[68:71], a[52:55], v[60:63]
    ds_read_b128 a[20:23], v6 offset:35328
    v_mfma_f32_16x16x32_bf16 v[64:67], a[72:75], a[48:51], v[64:67]
    ds_read_b128 a[24:27], v5 offset:35840
    v_mfma_f32_16x16x32_bf16 v[68:71], a[72:75], a[52:55], v[68:71]
    ds_read_b128 a[28:31], v6 offset:35840
    v_mfma_f32_16x16x32_bf16 v[72:75], a[76:79], a[48:51], v[72:75]
    ds_read_b128 a[32:35], v5 offset:36352
    v_mfma_f32_16x16x32_bf16 v[76:79], a[76:79], a[52:55], v[76:79]
    ds_read_b128 a[36:39], v6 offset:36352
    v_mfma_f32_16x16x32_bf16 v[80:83], a[80:83], a[48:51], v[80:83]
    ds_read_b128 a[40:43], v7 offset:34816
    v_mfma_f32_16x16x32_bf16 v[84:87], a[80:83], a[52:55], v[84:87]
    v_mfma_f32_16x16x32_bf16 v[88:91], a[84:87], a[48:51], v[88:91]
    v_mfma_f32_16x16x32_bf16 v[92:95], a[84:87], a[52:55], v[92:95]
    v_mfma_f32_16x16x32_bf16 v[96:99], a[88:91], a[48:51], v[96:99]
    v_mfma_f32_16x16x32_bf16 v[100:103], a[88:91], a[52:55], v[100:103]
    s_waitcnt lgkmcnt(8)
    v_mfma_f32_16x16x32_bf16 v[32:35], a[8:11], a[0:3], v[32:35]
    ds_read_b64_tr_b16 a[48:49], v11 offset:43008
    v_mfma_f32_16x16x32_bf16 v[36:39], a[8:11], a[4:7], v[36:39]
    ds_read_b64_tr_b16 a[50:51], v11 offset:47104
    s_waitcnt lgkmcnt(9)
    v_mfma_f32_16x16x32_bf16 v[40:43], a[12:15], a[0:3], v[40:43]
    ds_read_b64_tr_b16 a[52:53], v12 offset:43008
    v_mfma_f32_16x16x32_bf16 v[44:47], a[12:15], a[4:7], v[44:47]
    ds_read_b64_tr_b16 a[54:55], v12 offset:47104
    s_waitcnt lgkmcnt(10)
    v_mfma_f32_16x16x32_bf16 v[48:51], a[16:19], a[0:3], v[48:51]
    ds_read_b128 a[56:59], v5 offset:44032
    v_mfma_f32_16x16x32_bf16 v[52:55], a[16:19], a[4:7], v[52:55]
    ds_read_b128 a[60:63], v6 offset:44032
    s_waitcnt lgkmcnt(11)
    v_mfma_f32_16x16x32_bf16 v[56:59], a[20:23], a[0:3], v[56:59]
    ds_read_b128 a[64:67], v5 offset:44544
    v_mfma_f32_16x16x32_bf16 v[60:63], a[20:23], a[4:7], v[60:63]
    ds_read_b128 a[68:71], v6 offset:44544
    s_waitcnt lgkmcnt(12)
    v_mfma_f32_16x16x32_bf16 v[64:67], a[24:27], a[0:3], v[64:67]
    ds_read_b128 a[72:75], v5 offset:45056
    v_mfma_f32_16x16x32_bf16 v[68:71], a[24:27], a[4:7], v[68:71]
    ds_read_b128 a[76:79], v6 offset:45056
    s_waitcnt lgkmcnt(13)
    v_mfma_f32_16x16x32_bf16 v[72:75], a[28:31], a[0:3], v[72:75]
    ds_read_b128 a[80:83], v5 offset:45568
    v_mfma_f32_16x16x32_bf16 v[76:79], a[28:31], a[4:7], v[76:79]
    ds_read_b128 a[84:87], v6 offset:45568
    s_waitcnt lgkmcnt(14)
    v_mfma_f32_16x16x32_bf16 v[80:83], a[32:35], a[0:3], v[80:83]
    ds_read_b128 a[88:91], v7 offset:44032
    v_mfma_f32_16x16x32_bf16 v[84:87], a[32:35], a[4:7], v[84:87]
    s_waitcnt lgkmcnt(14)
    v_mfma_f32_16x16x32_bf16 v[88:91], a[36:39], a[0:3], v[88:91]
    v_mfma_f32_16x16x32_bf16 v[92:95], a[36:39], a[4:7], v[92:95]
    s_waitcnt lgkmcnt(13)
    v_mfma_f32_16x16x32_bf16 v[96:99], a[40:43], a[0:3], v[96:99]
    v_mfma_f32_16x16x32_bf16 v[100:103], a[40:43], a[4:7], v[100:103]
    s_waitcnt lgkmcnt(0)
    s_barrier
    v_mfma_f32_16x16x32_bf16 v[32:35], a[56:59], a[48:51], v[32:35]
    ds_read_b64_tr_b16 a[0:1], v13 offset:0
    v_mfma_f32_16x16x32_bf16 v[36:39], a[56:59], a[52:55], v[36:39]
    ds_read_b64_tr_b16 a[2:3], v13 offset:4096
    v_mfma_f32_16x16x32_bf16 v[40:43], a[60:63], a[48:51], v[40:43]
    ds_read_b64_tr_b16 a[4:5], v14 offset:0
    v_mfma_f32_16x16x32_bf16 v[44:47], a[60:63], a[52:55], v[44:47]
    ds_read_b64_tr_b16 a[6:7], v14 offset:4096
    v_mfma_f32_16x16x32_bf16 v[48:51], a[64:67], a[48:51], v[48:51]
    ds_read_b128 a[8:11], v8 offset:0
    v_mfma_f32_16x16x32_bf16 v[52:55], a[64:67], a[52:55], v[52:55]
    ds_read_b128 a[12:15], v9 offset:0
    v_mfma_f32_16x16x32_bf16 v[56:59], a[68:71], a[48:51], v[56:59]
    ds_read_b128 a[16:19], v8 offset:512
    v_mfma_f32_16x16x32_bf16 v[60:63], a[68:71], a[52:55], v[60:63]
    ds_read_b128 a[20:23], v9 offset:512
    v_mfma_f32_16x16x32_bf16 v[64:67], a[72:75], a[48:51], v[64:67]
    ds_read_b128 a[24:27], v8 offset:1024
    v_mfma_f32_16x16x32_bf16 v[68:71], a[72:75], a[52:55], v[68:71]
    ds_read_b128 a[28:31], v9 offset:1024
    v_mfma_f32_16x16x32_bf16 v[72:75], a[76:79], a[48:51], v[72:75]
    ds_read_b128 a[32:35], v8 offset:1536
    v_mfma_f32_16x16x32_bf16 v[76:79], a[76:79], a[52:55], v[76:79]
    ds_read_b128 a[36:39], v9 offset:1536
    v_mfma_f32_16x16x32_bf16 v[80:83], a[80:83], a[48:51], v[80:83]
    ds_read_b128 a[40:43], v10 offset:0
    v_mfma_f32_16x16x32_bf16 v[84:87], a[80:83], a[52:55], v[84:87]
    v_mfma_f32_16x16x32_bf16 v[88:91], a[84:87], a[48:51], v[88:91]
    v_mfma_f32_16x16x32_bf16 v[92:95], a[84:87], a[52:55], v[92:95]
    v_mfma_f32_16x16x32_bf16 v[96:99], a[88:91], a[48:51], v[96:99]
    v_mfma_f32_16x16x32_bf16 v[100:103], a[88:91], a[52:55], v[100:103]
    s_waitcnt lgkmcnt(8)
    v_mfma_f32_16x16x32_bf16 v[32:35], a[8:11], a[0:3], v[32:35]
    ds_read_b64_tr_b16 a[48:49], v13 offset:8192
    v_mfma_f32_16x16x32_bf16 v[36:39], a[8:11], a[4:7], v[36:39]
    ds_read_b64_tr_b16 a[50:51], v13 offset:12288
    s_waitcnt lgkmcnt(9)
    v_mfma_f32_16x16x32_bf16 v[40:43], a[12:15], a[0:3], v[40:43]
    ds_read_b64_tr_b16 a[52:53], v14 offset:8192
    v_mfma_f32_16x16x32_bf16 v[44:47], a[12:15], a[4:7], v[44:47]
    ds_read_b64_tr_b16 a[54:55], v14 offset:12288
    s_waitcnt lgkmcnt(10)
    v_mfma_f32_16x16x32_bf16 v[48:51], a[16:19], a[0:3], v[48:51]
    ds_read_b128 a[56:59], v8 offset:9216
    v_mfma_f32_16x16x32_bf16 v[52:55], a[16:19], a[4:7], v[52:55]
    ds_read_b128 a[60:63], v9 offset:9216
    s_waitcnt lgkmcnt(11)
    v_mfma_f32_16x16x32_bf16 v[56:59], a[20:23], a[0:3], v[56:59]
    ds_read_b128 a[64:67], v8 offset:9728
    v_mfma_f32_16x16x32_bf16 v[60:63], a[20:23], a[4:7], v[60:63]
    ds_read_b128 a[68:71], v9 offset:9728
    s_waitcnt lgkmcnt(12)
    v_mfma_f32_16x16x32_bf16 v[64:67], a[24:27], a[0:3], v[64:67]
    ds_read_b128 a[72:75], v8 offset:10240
    v_mfma_f32_16x16x32_bf16 v[68:71], a[24:27], a[4:7], v[68:71]
    ds_read_b128 a[76:79], v9 offset:10240
    s_waitcnt lgkmcnt(13)
    v_mfma_f32_16x16x32_bf16 v[72:75], a[28:31], a[0:3], v[72:75]
    ds_read_b128 a[80:83], v8 offset:10752
    v_mfma_f32_16x16x32_bf16 v[76:79], a[28:31], a[4:7], v[76:79]
    ds_read_b128 a[84:87], v9 offset:10752
    s_waitcnt lgkmcnt(14)
    v_mfma_f32_16x16x32_bf16 v[80:83], a[32:35], a[0:3], v[80:83]
    ds_read_b128 a[88:91], v10 offset:9216
    v_mfma_f32_16x16x32_bf16 v[84:87], a[32:35], a[4:7], v[84:87]
    s_waitcnt lgkmcnt(14)
    v_mfma_f32_16x16x32_bf16 v[88:91], a[36:39], a[0:3], v[88:91]
    v_mfma_f32_16x16x32_bf16 v[92:95], a[36:39], a[4:7], v[92:95]
    s_waitcnt lgkmcnt(13)
    v_mfma_f32_16x16x32_bf16 v[96:99], a[40:43], a[0:3], v[96:99]
    v_mfma_f32_16x16x32_bf16 v[100:103], a[40:43], a[4:7], v[100:103]
    s_waitcnt lgkmcnt(0)
    s_barrier
    v_mfma_f32_16x16x32_bf16 v[32:35], a[56:59], a[48:51], v[32:35]
    ds_read_b64_tr_b16 a[0:1], v13 offset:34816
    v_mfma_f32_16x16x32_bf16 v[36:39], a[56:59], a[52:55], v[36:39]
    ds_read_b64_tr_b16 a[2:3], v13 offset:38912
    v_mfma_f32_16x16x32_bf16 v[40:43], a[60:63], a[48:51], v[40:43]
    ds_read_b64_tr_b16 a[4:5], v14 offset:34816
    v_mfma_f32_16x16x32_bf16 v[44:47], a[60:63], a[52:55], v[44:47]
    ds_read_b64_tr_b16 a[6:7], v14 offset:38912
    v_mfma_f32_16x16x32_bf16 v[48:51], a[64:67], a[48:51], v[48:51]
    ds_read_b128 a[8:11], v8 offset:34816
    v_mfma_f32_16x16x32_bf16 v[52:55], a[64:67], a[52:55], v[52:55]
    ds_read_b128 a[12:15], v9 offset:34816
    v_mfma_f32_16x16x32_bf16 v[56:59], a[68:71], a[48:51], v[56:59]
    ds_read_b128 a[16:19], v8 offset:35328
    v_mfma_f32_16x16x32_bf16 v[60:63], a[68:71], a[52:55], v[60:63]
    ds_read_b128 a[20:23], v9 offset:35328
    v_mfma_f32_16x16x32_bf16 v[64:67], a[72:75], a[48:51], v[64:67]
    ds_read_b128 a[24:27], v8 offset:35840
    v_mfma_f32_16x16x32_bf16 v[68:71], a[72:75], a[52:55], v[68:71]
    ds_read_b128 a[28:31], v9 offset:35840
    v_mfma_f32_16x16x32_bf16 v[72:75], a[76:79], a[48:51], v[72:75]
    ds_read_b128 a[32:35], v8 offset:36352
    v_mfma_f32_16x16x32_bf16 v[76:79], a[76:79], a[52:55], v[76:79]
    ds_read_b128 a[36:39], v9 offset:36352
    v_mfma_f32_16x16x32_bf16 v[80:83], a[80:83], a[48:51], v[80:83]
    ds_read_b128 a[40:43], v10 offset:34816
    v_mfma_f32_16x16x32_bf16 v[84:87], a[80:83], a[52:55], v[84:87]
    v_mfma_f32_16x16x32_bf16 v[88:91], a[84:87], a[48:51], v[88:91]
    v_mfma_f32_16x16x32_bf16 v[92:95], a[84:87], a[52:55], v[92:95]
    v_mfma_f32_16x16x32_bf16 v[96:99], a[88:91], a[48:51], v[96:99]
    v_mfma_f32_16x16x32_bf16 v[100:103], a[88:91], a[52:55], v[100:103]
    s_waitcnt lgkmcnt(8)
    v_mfma_f32_16x16x32_bf16 v[32:35], a[8:11], a[0:3], v[32:35]
    ds_read_b64_tr_b16 a[48:49], v13 offset:43008
    v_mfma_f32_16x16x32_bf16 v[36:39], a[8:11], a[4:7], v[36:39]
    ds_read_b64_tr_b16 a[50:51], v13 offset:47104
    s_waitcnt lgkmcnt(9)
    v_mfma_f32_16x16x32_bf16 v[40:43], a[12:15], a[0:3], v[40:43]
    ds_read_b64_tr_b16 a[52:53], v14 offset:43008
    v_mfma_f32_16x16x32_bf16 v[44:47], a[12:15], a[4:7], v[44:47]
    ds_read_b64_tr_b16 a[54:55], v14 offset:47104
    s_waitcnt lgkmcnt(10)
    v_mfma_f32_16x16x32_bf16 v[48:51], a[16:19], a[0:3], v[48:51]
    ds_read_b128 a[56:59], v8 offset:44032
    v_mfma_f32_16x16x32_bf16 v[52:55], a[16:19], a[4:7], v[52:55]
    ds_read_b128 a[60:63], v9 offset:44032
    s_waitcnt lgkmcnt(11)
    v_mfma_f32_16x16x32_bf16 v[56:59], a[20:23], a[0:3], v[56:59]
    ds_read_b128 a[64:67], v8 offset:44544
    v_mfma_f32_16x16x32_bf16 v[60:63], a[20:23], a[4:7], v[60:63]
    ds_read_b128 a[68:71], v9 offset:44544
    s_waitcnt lgkmcnt(12)
    v_mfma_f32_16x16x32_bf16 v[64:67], a[24:27], a[0:3], v[64:67]
    ds_read_b128 a[72:75], v8 offset:45056
    v_mfma_f32_16x16x32_bf16 v[68:71], a[24:27], a[4:7], v[68:71]
    ds_read_b128 a[76:79], v9 offset:45056
    s_waitcnt lgkmcnt(13)
    v_mfma_f32_16x16x32_bf16 v[72:75], a[28:31], a[0:3], v[72:75]
    ds_read_b128 a[80:83], v8 offset:45568
    v_mfma_f32_16x16x32_bf16 v[76:79], a[28:31], a[4:7], v[76:79]
    ds_read_b128 a[84:87], v9 offset:45568
    s_waitcnt lgkmcnt(14)
    v_mfma_f32_16x16x32_bf16 v[80:83], a[32:35], a[0:3], v[80:83]
    ds_read_b128 a[88:91], v10 offset:44032
    v_mfma_f32_16x16x32_bf16 v[84:87], a[32:35], a[4:7], v[84:87]
    s_waitcnt lgkmcnt(14)
    v_mfma_f32_16x16x32_bf16 v[88:91], a[36:39], a[0:3], v[88:91]
    v_mfma_f32_16x16x32_bf16 v[92:95], a[36:39], a[4:7], v[92:95]
    s_waitcnt lgkmcnt(13)
    v_mfma_f32_16x16x32_bf16 v[96:99], a[40:43], a[0:3], v[96:99]
    v_mfma_f32_16x16x32_bf16 v[100:103], a[40:43], a[4:7], v[100:103]
    s_waitcnt lgkmcnt(0)
    s_barrier
    v_mfma_f32_16x16x32_bf16 v[32:35], a[56:59], a[48:51], v[32:35]
    ds_read_b64_tr_b16 a[0:1], v11 offset:0
    v_mfma_f32_16x16x32_bf16 v[36:39], a[56:59], a[52:55], v[36:39]
    ds_read_b64_tr_b16 a[2:3], v11 offset:4096
    v_mfma_f32_16x16x32_bf16 v[40:43], a[60:63], a[48:51], v[40:43]
    ds_read_b64_tr_b16 a[4:5], v12 offset:0
    v_mfma_f32_16x16x32_bf16 v[44:47], a[60:63], a[52:55], v[44:47]
    ds_read_b64_tr_b16 a[6:7], v12 offset:4096
    v_mfma_f32_16x16x32_bf16 v[48:51], a[64:67], a[48:51], v[48:51]
    ds_read_b128 a[8:11], v5 offset:0
    v_mfma_f32_16x16x32_bf16 v[52:55], a[64:67], a[52:55], v[52:55]
    ds_read_b128 a[12:15], v6 offset:0
    v_mfma_f32_16x16x32_bf16 v[56:59], a[68:71], a[48:51], v[56:59]
    ds_read_b128 a[16:19], v5 offset:512
    v_mfma_f32_16x16x32_bf16 v[60:63], a[68:71], a[52:55], v[60:63]
    ds_read_b128 a[20:23], v6 offset:512
    v_mfma_f32_16x16x32_bf16 v[64:67], a[72:75], a[48:51], v[64:67]
    ds_read_b128 a[24:27], v5 offset:1024
    v_mfma_f32_16x16x32_bf16 v[68:71], a[72:75], a[52:55], v[68:71]
    ds_read_b128 a[28:31], v6 offset:1024
    v_mfma_f32_16x16x32_bf16 v[72:75], a[76:79], a[48:51], v[72:75]
    ds_read_b128 a[32:35], v5 offset:1536
    v_mfma_f32_16x16x32_bf16 v[76:79], a[76:79], a[52:55], v[76:79]
    ds_read_b128 a[36:39], v6 offset:1536
    v_mfma_f32_16x16x32_bf16 v[80:83], a[80:83], a[48:51], v[80:83]
    ds_read_b128 a[40:43], v7 offset:0
    v_mfma_f32_16x16x32_bf16 v[84:87], a[80:83], a[52:55], v[84:87]
    v_mfma_f32_16x16x32_bf16 v[88:91], a[84:87], a[48:51], v[88:91]
    v_mfma_f32_16x16x32_bf16 v[92:95], a[84:87], a[52:55], v[92:95]
    v_mfma_f32_16x16x32_bf16 v[96:99], a[88:91], a[48:51], v[96:99]
    v_mfma_f32_16x16x32_bf16 v[100:103], a[88:91], a[52:55], v[100:103]
    s_waitcnt lgkmcnt(8)
    v_mfma_f32_16x16x32_bf16 v[32:35], a[8:11], a[0:3], v[32:35]
    ds_read_b64_tr_b16 a[48:49], v11 offset:8192
    v_mfma_f32_16x16x32_bf16 v[36:39], a[8:11], a[4:7], v[36:39]
    ds_read_b64_tr_b16 a[50:51], v11 offset:12288
    s_waitcnt lgkmcnt(9)
    v_mfma_f32_16x16x32_bf16 v[40:43], a[12:15], a[0:3], v[40:43]
    ds_read_b64_tr_b16 a[52:53], v12 offset:8192
    v_mfma_f32_16x16x32_bf16 v[44:47], a[12:15], a[4:7], v[44:47]
    ds_read_b64_tr_b16 a[54:55], v12 offset:12288
    s_waitcnt lgkmcnt(10)
    v_mfma_f32_16x16x32_bf16 v[48:51], a[16:19], a[0:3], v[48:51]
    ds_read_b128 a[56:59], v5 offset:9216
    v_mfma_f32_16x16x32_bf16 v[52:55], a[16:19], a[4:7], v[52:55]
    ds_read_b128 a[60:63], v6 offset:9216
    s_waitcnt lgkmcnt(11)
    v_mfma_f32_16x16x32_bf16 v[56:59], a[20:23], a[0:3], v[56:59]
    ds_read_b128 a[64:67], v5 offset:9728
    v_mfma_f32_16x16x32_bf16 v[60:63], a[20:23], a[4:7], v[60:63]
    ds_read_b128 a[68:71], v6 offset:9728
    s_waitcnt lgkmcnt(12)
    v_mfma_f32_16x16x32_bf16 v[64:67], a[24:27], a[0:3], v[64:67]
    ds_read_b128 a[72:75], v5 offset:10240
    v_mfma_f32_16x16x32_bf16 v[68:71], a[24:27], a[4:7], v[68:71]
    ds_read_b128 a[76:79], v6 offset:10240
    s_waitcnt lgkmcnt(13)
    v_mfma_f32_16x16x32_bf16 v[72:75], a[28:31], a[0:3], v[72:75]
    ds_read_b128 a[80:83], v5 offset:10752
    v_mfma_f32_16x16x32_bf16 v[76:79], a[28:31], a[4:7], v[76:79]
    ds_read_b128 a[84:87], v6 offset:10752
    s_waitcnt lgkmcnt(14)
    v_mfma_f32_16x16x32_bf16 v[80:83], a[32:35], a[0:3], v[80:83]
    ds_read_b128 a[88:91], v7 offset:9216
    v_mfma_f32_16x16x32_bf16 v[84:87], a[32:35], a[4:7], v[84:87]
    s_waitcnt lgkmcnt(14)
    v_mfma_f32_16x16x32_bf16 v[88:91], a[36:39], a[0:3], v[88:91]
    v_mfma_f32_16x16x32_bf16 v[92:95], a[36:39], a[4:7], v[92:95]
    s_waitcnt lgkmcnt(13)
    v_mfma_f32_16x16x32_bf16 v[96:99], a[40:43], a[0:3], v[96:99]
    v_mfma_f32_16x16x32_bf16 v[100:103], a[40:43], a[4:7], v[100:103]
    s_waitcnt lgkmcnt(0)
    s_barrier
    v_mfma_f32_16x16x32_bf16 v[32:35], a[56:59], a[48:51], v[32:35]
    ds_read_b64_tr_b16 a[0:1], v11 offset:34816
    v_mfma_f32_16x16x32_bf16 v[36:39], a[56:59], a[52:55], v[36:39]
    ds_read_b64_tr_b16 a[2:3], v11 offset:38912
    v_mfma_f32_16x16x32_bf16 v[40:43], a[60:63], a[48:51], v[40:43]
    ds_read_b64_tr_b16 a[4:5], v12 offset:34816
    v_mfma_f32_16x16x32_bf16 v[44:47], a[60:63], a[52:55], v[44:47]
    ds_read_b64_tr_b16 a[6:7], v12 offset:38912
    v_mfma_f32_16x16x32_bf16 v[48:51], a[64:67], a[48:51], v[48:51]
    ds_read_b128 a[8:11], v5 offset:34816
    v_mfma_f32_16x16x32_bf16 v[52:55], a[64:67], a[52:55], v[52:55]
    ds_read_b128 a[12:15], v6 offset:34816
    v_mfma_f32_16x16x32_bf16 v[56:59], a[68:71], a[48:51], v[56:59]
    ds_read_b128 a[16:19], v5 offset:35328
    v_mfma_f32_16x16x32_bf16 v[60:63], a[68:71], a[52:55], v[60:63]
    ds_read_b128 a[20:23], v6 offset:35328
    v_mfma_f32_16x16x32_bf16 v[64:67], a[72:75], a[48:51], v[64:67]
    ds_read_b128 a[24:27], v5 offset:35840
    v_mfma_f32_16x16x32_bf16 v[68:71], a[72:75], a[52:55], v[68:71]
    ds_read_b128 a[28:31], v6 offset:35840
    v_mfma_f32_16x16x32_bf16 v[72:75], a[76:79], a[48:51], v[72:75]
    ds_read_b128 a[32:35], v5 offset:36352
    v_mfma_f32_16x16x32_bf16 v[76:79], a[76:79], a[52:55], v[76:79]
    ds_read_b128 a[36:39], v6 offset:36352
    v_mfma_f32_16x16x32_bf16 v[80:83], a[80:83], a[48:51], v[80:83]
    ds_read_b128 a[40:43], v7 offset:34816
    v_mfma_f32_16x16x32_bf16 v[84:87], a[80:83], a[52:55], v[84:87]
    v_mfma_f32_16x16x32_bf16 v[88:91], a[84:87], a[48:51], v[88:91]
    v_mfma_f32_16x16x32_bf16 v[92:95], a[84:87], a[52:55], v[92:95]
    v_mfma_f32_16x16x32_bf16 v[96:99], a[88:91], a[48:51], v[96:99]
    v_mfma_f32_16x16x32_bf16 v[100:103], a[88:91], a[52:55], v[100:103]
    s_waitcnt lgkmcnt(8)
    v_mfma_f32_16x16x32_bf16 v[32:35], a[8:11], a[0:3], v[32:35]
    ds_read_b64_tr_b16 a[48:49], v11 offset:43008
    v_mfma_f32_16x16x32_bf16 v[36:39], a[8:11], a[4:7], v[36:39]
    ds_read_b64_tr_b16 a[50:51], v11 offset:47104
    s_waitcnt lgkmcnt(9)
    v_mfma_f32_16x16x32_bf16 v[40:43], a[12:15], a[0:3], v[40:43]
    ds_read_b64_tr_b16 a[52:53], v12 offset:43008
    v_mfma_f32_16x16x32_bf16 v[44:47], a[12:15], a[4:7], v[44:47]
    ds_read_b64_tr_b16 a[54:55], v12 offset:47104
    s_waitcnt lgkmcnt(10)
    v_mfma_f32_16x16x32_bf16 v[48:51], a[16:19], a[0:3], v[48:51]
    ds_read_b128 a[56:59], v5 offset:44032
    v_mfma_f32_16x16x32_bf16 v[52:55], a[16:19], a[4:7], v[52:55]
    ds_read_b128 a[60:63], v6 offset:44032
    s_waitcnt lgkmcnt(11)
    v_mfma_f32_16x16x32_bf16 v[56:59], a[20:23], a[0:3], v[56:59]
    ds_read_b128 a[64:67], v5 offset:44544
    v_mfma_f32_16x16x32_bf16 v[60:63], a[20:23], a[4:7], v[60:63]
    ds_read_b128 a[68:71], v6 offset:44544
    s_waitcnt lgkmcnt(12)
    v_mfma_f32_16x16x32_bf16 v[64:67], a[24:27], a[0:3], v[64:67]
    ds_read_b128 a[72:75], v5 offset:45056
    v_mfma_f32_16x16x32_bf16 v[68:71], a[24:27], a[4:7], v[68:71]
    ds_read_b128 a[76:79], v6 offset:45056
    s_waitcnt lgkmcnt(13)
    v_mfma_f32_16x16x32_bf16 v[72:75], a[28:31], a[0:3], v[72:75]
    ds_read_b128 a[80:83], v5 offset:45568
    v_mfma_f32_16x16x32_bf16 v[76:79], a[28:31], a[4:7], v[76:79]
    ds_read_b128 a[84:87], v6 offset:45568
    s_waitcnt lgkmcnt(14)
    v_mfma_f32_16x16x32_bf16 v[80:83], a[32:35], a[0:3], v[80:83]
    ds_read_b128 a[88:91], v7 offset:44032
    v_mfma_f32_16x16x32_bf16 v[84:87], a[32:35], a[4:7], v[84:87]
    s_waitcnt lgkmcnt(14)
    v_mfma_f32_16x16x32_bf16 v[88:91], a[36:39], a[0:3], v[88:91]
    v_mfma_f32_16x16x32_bf16 v[92:95], a[36:39], a[4:7], v[92:95]
    s_waitcnt lgkmcnt(13)
    v_mfma_f32_16x16x32_bf16 v[96:99], a[40:43], a[0:3], v[96:99]
    v_mfma_f32_16x16x32_bf16 v[100:103], a[40:43], a[4:7], v[100:103]
    s_waitcnt lgkmcnt(0)
    s_barrier
    v_mfma_f32_16x16x32_bf16 v[32:35], a[56:59], a[48:51], v[32:35]
    ds_read_b64_tr_b16 a[0:1], v13 offset:0
    v_mfma_f32_16x16x32_bf16 v[36:39], a[56:59], a[52:55], v[36:39]
    ds_read_b64_tr_b16 a[2:3], v13 offset:4096
    v_mfma_f32_16x16x32_bf16 v[40:43], a[60:63], a[48:51], v[40:43]
    ds_read_b64_tr_b16 a[4:5], v14 offset:0
    v_mfma_f32_16x16x32_bf16 v[44:47], a[60:63], a[52:55], v[44:47]
    ds_read_b64_tr_b16 a[6:7], v14 offset:4096
    v_mfma_f32_16x16x32_bf16 v[48:51], a[64:67], a[48:51], v[48:51]
    ds_read_b128 a[8:11], v8 offset:0
    v_mfma_f32_16x16x32_bf16 v[52:55], a[64:67], a[52:55], v[52:55]
    ds_read_b128 a[12:15], v9 offset:0
    v_mfma_f32_16x16x32_bf16 v[56:59], a[68:71], a[48:51], v[56:59]
    ds_read_b128 a[16:19], v8 offset:512
    v_mfma_f32_16x16x32_bf16 v[60:63], a[68:71], a[52:55], v[60:63]
    ds_read_b128 a[20:23], v9 offset:512
    v_mfma_f32_16x16x32_bf16 v[64:67], a[72:75], a[48:51], v[64:67]
    ds_read_b128 a[24:27], v8 offset:1024
    v_mfma_f32_16x16x32_bf16 v[68:71], a[72:75], a[52:55], v[68:71]
    ds_read_b128 a[28:31], v9 offset:1024
    v_mfma_f32_16x16x32_bf16 v[72:75], a[76:79], a[48:51], v[72:75]
    ds_read_b128 a[32:35], v8 offset:1536
    v_mfma_f32_16x16x32_bf16 v[76:79], a[76:79], a[52:55], v[76:79]
    ds_read_b128 a[36:39], v9 offset:1536
    v_mfma_f32_16x16x32_bf16 v[80:83], a[80:83], a[48:51], v[80:83]
    ds_read_b128 a[40:43], v10 offset:0
    v_mfma_f32_16x16x32_bf16 v[84:87], a[80:83], a[52:55], v[84:87]
    v_mfma_f32_16x16x32_bf16 v[88:91], a[84:87], a[48:51], v[88:91]
    v_mfma_f32_16x16x32_bf16 v[92:95], a[84:87], a[52:55], v[92:95]
    v_mfma_f32_16x16x32_bf16 v[96:99], a[88:91], a[48:51], v[96:99]
    v_mfma_f32_16x16x32_bf16 v[100:103], a[88:91], a[52:55], v[100:103]
    s_waitcnt lgkmcnt(8)
    v_mfma_f32_16x16x32_bf16 v[32:35], a[8:11], a[0:3], v[32:35]
    ds_read_b64_tr_b16 a[48:49], v13 offset:8192
    v_mfma_f32_16x16x32_bf16 v[36:39], a[8:11], a[4:7], v[36:39]
    ds_read_b64_tr_b16 a[50:51], v13 offset:12288
    s_waitcnt lgkmcnt(9)
    v_mfma_f32_16x16x32_bf16 v[40:43], a[12:15], a[0:3], v[40:43]
    ds_read_b64_tr_b16 a[52:53], v14 offset:8192
    v_mfma_f32_16x16x32_bf16 v[44:47], a[12:15], a[4:7], v[44:47]
    ds_read_b64_tr_b16 a[54:55], v14 offset:12288
    s_waitcnt lgkmcnt(10)
    v_mfma_f32_16x16x32_bf16 v[48:51], a[16:19], a[0:3], v[48:51]
    ds_read_b128 a[56:59], v8 offset:9216
    v_mfma_f32_16x16x32_bf16 v[52:55], a[16:19], a[4:7], v[52:55]
    ds_read_b128 a[60:63], v9 offset:9216
    s_waitcnt lgkmcnt(11)
    v_mfma_f32_16x16x32_bf16 v[56:59], a[20:23], a[0:3], v[56:59]
    ds_read_b128 a[64:67], v8 offset:9728
    v_mfma_f32_16x16x32_bf16 v[60:63], a[20:23], a[4:7], v[60:63]
    ds_read_b128 a[68:71], v9 offset:9728
    s_waitcnt lgkmcnt(12)
    v_mfma_f32_16x16x32_bf16 v[64:67], a[24:27], a[0:3], v[64:67]
    ds_read_b128 a[72:75], v8 offset:10240
    v_mfma_f32_16x16x32_bf16 v[68:71], a[24:27], a[4:7], v[68:71]
    ds_read_b128 a[76:79], v9 offset:10240
    s_waitcnt lgkmcnt(13)
    v_mfma_f32_16x16x32_bf16 v[72:75], a[28:31], a[0:3], v[72:75]
    ds_read_b128 a[80:83], v8 offset:10752
    v_mfma_f32_16x16x32_bf16 v[76:79], a[28:31], a[4:7], v[76:79]
    ds_read_b128 a[84:87], v9 offset:10752
    s_waitcnt lgkmcnt(14)
    v_mfma_f32_16x16x32_bf16 v[80:83], a[32:35], a[0:3], v[80:83]
    ds_read_b128 a[88:91], v10 offset:9216
    v_mfma_f32_16x16x32_bf16 v[84:87], a[32:35], a[4:7], v[84:87]
    s_waitcnt lgkmcnt(14)
    v_mfma_f32_16x16x32_bf16 v[88:91], a[36:39], a[0:3], v[88:91]
    v_mfma_f32_16x16x32_bf16 v[92:95], a[36:39], a[4:7], v[92:95]
    s_waitcnt lgkmcnt(13)
    v_mfma_f32_16x16x32_bf16 v[96:99], a[40:43], a[0:3], v[96:99]
    v_mfma_f32_16x16x32_bf16 v[100:103], a[40:43], a[4:7], v[100:103]
    s_waitcnt lgkmcnt(0)
    s_barrier
    v_mfma_f32_16x16x32_bf16 v[32:35], a[56:59], a[48:51], v[32:35]
    ds_read_b64_tr_b16 a[0:1], v13 offset:34816
    v_mfma_f32_16x16x32_bf16 v[36:39], a[56:59], a[52:55], v[36:39]
    ds_read_b64_tr_b16 a[2:3], v13 offset:38912
    v_mfma_f32_16x16x32_bf16 v[40:43], a[60:63], a[48:51], v[40:43]
    ds_read_b64_tr_b16 a[4:5], v14 offset:34816
    v_mfma_f32_16x16x32_bf16 v[44:47], a[60:63], a[52:55], v[44:47]
    ds_read_b64_tr_b16 a[6:7], v14 offset:38912
    v_mfma_f32_16x16x32_bf16 v[48:51], a[64:67], a[48:51], v[48:51]
    ds_read_b128 a[8:11], v8 offset:34816
    v_mfma_f32_16x16x32_bf16 v[52:55], a[64:67], a[52:55], v[52:55]
    ds_read_b128 a[12:15], v9 offset:34816
    v_mfma_f32_16x16x32_bf16 v[56:59], a[68:71], a[48:51], v[56:59]
    ds_read_b128 a[16:19], v8 offset:35328
    v_mfma_f32_16x16x32_bf16 v[60:63], a[68:71], a[52:55], v[60:63]
    ds_read_b128 a[20:23], v9 offset:35328
    v_mfma_f32_16x16x32_bf16 v[64:67], a[72:75], a[48:51], v[64:67]
    ds_read_b128 a[24:27], v8 offset:35840
    v_mfma_f32_16x16x32_bf16 v[68:71], a[72:75], a[52:55], v[68:71]
    ds_read_b128 a[28:31], v9 offset:35840
    v_mfma_f32_16x16x32_bf16 v[72:75], a[76:79], a[48:51], v[72:75]
    ds_read_b128 a[32:35], v8 offset:36352
    v_mfma_f32_16x16x32_bf16 v[76:79], a[76:79], a[52:55], v[76:79]
    ds_read_b128 a[36:39], v9 offset:36352
    v_mfma_f32_16x16x32_bf16 v[80:83], a[80:83], a[48:51], v[80:83]
    ds_read_b128 a[40:43], v10 offset:34816
    v_mfma_f32_16x16x32_bf16 v[84:87], a[80:83], a[52:55], v[84:87]
    v_mfma_f32_16x16x32_bf16 v[88:91], a[84:87], a[48:51], v[88:91]
    v_mfma_f32_16x16x32_bf16 v[92:95], a[84:87], a[52:55], v[92:95]
    v_mfma_f32_16x16x32_bf16 v[96:99], a[88:91], a[48:51], v[96:99]
    v_mfma_f32_16x16x32_bf16 v[100:103], a[88:91], a[52:55], v[100:103]
    s_waitcnt lgkmcnt(8)
    v_mfma_f32_16x16x32_bf16 v[32:35], a[8:11], a[0:3], v[32:35]
    ds_read_b64_tr_b16 a[48:49], v13 offset:43008
    v_mfma_f32_16x16x32_bf16 v[36:39], a[8:11], a[4:7], v[36:39]
    ds_read_b64_tr_b16 a[50:51], v13 offset:47104
    s_waitcnt lgkmcnt(9)
    v_mfma_f32_16x16x32_bf16 v[40:43], a[12:15], a[0:3], v[40:43]
    ds_read_b64_tr_b16 a[52:53], v14 offset:43008
    v_mfma_f32_16x16x32_bf16 v[44:47], a[12:15], a[4:7], v[44:47]
    ds_read_b64_tr_b16 a[54:55], v14 offset:47104
    s_waitcnt lgkmcnt(10)
    v_mfma_f32_16x16x32_bf16 v[48:51], a[16:19], a[0:3], v[48:51]
    ds_read_b128 a[56:59], v8 offset:44032
    v_mfma_f32_16x16x32_bf16 v[52:55], a[16:19], a[4:7], v[52:55]
    ds_read_b128 a[60:63], v9 offset:44032
    s_waitcnt lgkmcnt(11)
    v_mfma_f32_16x16x32_bf16 v[56:59], a[20:23], a[0:3], v[56:59]
    ds_read_b128 a[64:67], v8 offset:44544
    v_mfma_f32_16x16x32_bf16 v[60:63], a[20:23], a[4:7], v[60:63]
    ds_read_b128 a[68:71], v9 offset:44544
    s_waitcnt lgkmcnt(12)
    v_mfma_f32_16x16x32_bf16 v[64:67], a[24:27], a[0:3], v[64:67]
    ds_read_b128 a[72:75], v8 offset:45056
    v_mfma_f32_16x16x32_bf16 v[68:71], a[24:27], a[4:7], v[68:71]
    ds_read_b128 a[76:79], v9 offset:45056
    s_waitcnt lgkmcnt(13)
    v_mfma_f32_16x16x32_bf16 v[72:75], a[28:31], a[0:3], v[72:75]
    ds_read_b128 a[80:83], v8 offset:45568
    v_mfma_f32_16x16x32_bf16 v[76:79], a[28:31], a[4:7], v[76:79]
    ds_read_b128 a[84:87], v9 offset:45568
    s_waitcnt lgkmcnt(14)
    v_mfma_f32_16x16x32_bf16 v[80:83], a[32:35], a[0:3], v[80:83]
    ds_read_b128 a[88:91], v10 offset:44032
    v_mfma_f32_16x16x32_bf16 v[84:87], a[32:35], a[4:7], v[84:87]
    s_waitcnt lgkmcnt(14)
    v_mfma_f32_16x16x32_bf16 v[88:91], a[36:39], a[0:3], v[88:91]
    v_mfma_f32_16x16x32_bf16 v[92:95], a[36:39], a[4:7], v[92:95]
    s_waitcnt lgkmcnt(13)
    v_mfma_f32_16x16x32_bf16 v[96:99], a[40:43], a[0:3], v[96:99]
    v_mfma_f32_16x16x32_bf16 v[100:103], a[40:43], a[4:7], v[100:103]
    s_waitcnt lgkmcnt(0)
    s_barrier
    v_mfma_f32_16x16x32_bf16 v[32:35], a[56:59], a[48:51], v[32:35]
    ds_read_b64_tr_b16 a[0:1], v11 offset:0
    v_mfma_f32_16x16x32_bf16 v[36:39], a[56:59], a[52:55], v[36:39]
    ds_read_b64_tr_b16 a[2:3], v11 offset:4096
    v_mfma_f32_16x16x32_bf16 v[40:43], a[60:63], a[48:51], v[40:43]
    ds_read_b64_tr_b16 a[4:5], v12 offset:0
    v_mfma_f32_16x16x32_bf16 v[44:47], a[60:63], a[52:55], v[44:47]
    ds_read_b64_tr_b16 a[6:7], v12 offset:4096
    v_mfma_f32_16x16x32_bf16 v[48:51], a[64:67], a[48:51], v[48:51]
    ds_read_b128 a[8:11], v5 offset:0
    v_mfma_f32_16x16x32_bf16 v[52:55], a[64:67], a[52:55], v[52:55]
    ds_read_b128 a[12:15], v6 offset:0
    v_mfma_f32_16x16x32_bf16 v[56:59], a[68:71], a[48:51], v[56:59]
    ds_read_b128 a[16:19], v5 offset:512
    v_mfma_f32_16x16x32_bf16 v[60:63], a[68:71], a[52:55], v[60:63]
    ds_read_b128 a[20:23], v6 offset:512
    v_mfma_f32_16x16x32_bf16 v[64:67], a[72:75], a[48:51], v[64:67]
    ds_read_b128 a[24:27], v5 offset:1024
    v_mfma_f32_16x16x32_bf16 v[68:71], a[72:75], a[52:55], v[68:71]
    ds_read_b128 a[28:31], v6 offset:1024
    v_mfma_f32_16x16x32_bf16 v[72:75], a[76:79], a[48:51], v[72:75]
    ds_read_b128 a[32:35], v5 offset:1536
    v_mfma_f32_16x16x32_bf16 v[76:79], a[76:79], a[52:55], v[76:79]
    ds_read_b128 a[36:39], v6 offset:1536
    v_mfma_f32_16x16x32_bf16 v[80:83], a[80:83], a[48:51], v[80:83]
    ds_read_b128 a[40:43], v7 offset:0
    v_mfma_f32_16x16x32_bf16 v[84:87], a[80:83], a[52:55], v[84:87]
    v_mfma_f32_16x16x32_bf16 v[88:91], a[84:87], a[48:51], v[88:91]
    v_mfma_f32_16x16x32_bf16 v[92:95], a[84:87], a[52:55], v[92:95]
    v_mfma_f32_16x16x32_bf16 v[96:99], a[88:91], a[48:51], v[96:99]
    v_mfma_f32_16x16x32_bf16 v[100:103], a[88:91], a[52:55], v[100:103]
    s_waitcnt lgkmcnt(8)
    v_mfma_f32_16x16x32_bf16 v[32:35], a[8:11], a[0:3], v[32:35]
    ds_read_b64_tr_b16 a[48:49], v11 offset:8192
    v_mfma_f32_16x16x32_bf16 v[36:39], a[8:11], a[4:7], v[36:39]
    ds_read_b64_tr_b16 a[50:51], v11 offset:12288
    s_waitcnt lgkmcnt(9)
    v_mfma_f32_16x16x32_bf16 v[40:43], a[12:15], a[0:3], v[40:43]
    ds_read_b64_tr_b16 a[52:53], v12 offset:8192
    v_mfma_f32_16x16x32_bf16 v[44:47], a[12:15], a[4:7], v[44:47]
    ds_read_b64_tr_b16 a[54:55], v12 offset:12288
    s_waitcnt lgkmcnt(10)
    v_mfma_f32_16x16x32_bf16 v[48:51], a[16:19], a[0:3], v[48:51]
    ds_read_b128 a[56:59], v5 offset:9216
    v_mfma_f32_16x16x32_bf16 v[52:55], a[16:19], a[4:7], v[52:55]
    ds_read_b128 a[60:63], v6 offset:9216
    s_waitcnt lgkmcnt(11)
    v_mfma_f32_16x16x32_bf16 v[56:59], a[20:23], a[0:3], v[56:59]
    ds_read_b128 a[64:67], v5 offset:9728
    v_mfma_f32_16x16x32_bf16 v[60:63], a[20:23], a[4:7], v[60:63]
    ds_read_b128 a[68:71], v6 offset:9728
    s_waitcnt lgkmcnt(12)
    v_mfma_f32_16x16x32_bf16 v[64:67], a[24:27], a[0:3], v[64:67]
    ds_read_b128 a[72:75], v5 offset:10240
    v_mfma_f32_16x16x32_bf16 v[68:71], a[24:27], a[4:7], v[68:71]
    ds_read_b128 a[76:79], v6 offset:10240
    s_waitcnt lgkmcnt(13)
    v_mfma_f32_16x16x32_bf16 v[72:75], a[28:31], a[0:3], v[72:75]
    ds_read_b128 a[80:83], v5 offset:10752
    v_mfma_f32_16x16x32_bf16 v[76:79], a[28:31], a[4:7], v[76:79]
    ds_read_b128 a[84:87], v6 offset:10752
    s_waitcnt lgkmcnt(14)
    v_mfma_f32_16x16x32_bf16 v[80:83], a[32:35], a[0:3], v[80:83]
    ds_read_b128 a[88:91], v7 offset:9216
    v_mfma_f32_16x16x32_bf16 v[84:87], a[32:35], a[4:7], v[84:87]
    s_waitcnt lgkmcnt(14)
    v_mfma_f32_16x16x32_bf16 v[88:91], a[36:39], a[0:3], v[88:91]
    v_mfma_f32_16x16x32_bf16 v[92:95], a[36:39], a[4:7], v[92:95]
    s_waitcnt lgkmcnt(13)
    v_mfma_f32_16x16x32_bf16 v[96:99], a[40:43], a[0:3], v[96:99]
    v_mfma_f32_16x16x32_bf16 v[100:103], a[40:43], a[4:7], v[100:103]
    s_waitcnt lgkmcnt(0)
    s_barrier
    v_mfma_f32_16x16x32_bf16 v[32:35], a[56:59], a[48:51], v[32:35]
    ds_read_b64_tr_b16 a[0:1], v11 offset:34816
    v_mfma_f32_16x16x32_bf16 v[36:39], a[56:59], a[52:55], v[36:39]
    ds_read_b64_tr_b16 a[2:3], v11 offset:38912
    v_mfma_f32_16x16x32_bf16 v[40:43], a[60:63], a[48:51], v[40:43]
    ds_read_b64_tr_b16 a[4:5], v12 offset:34816
    v_mfma_f32_16x16x32_bf16 v[44:47], a[60:63], a[52:55], v[44:47]
    ds_read_b64_tr_b16 a[6:7], v12 offset:38912
    v_mfma_f32_16x16x32_bf16 v[48:51], a[64:67], a[48:51], v[48:51]
    ds_read_b128 a[8:11], v5 offset:34816
    v_mfma_f32_16x16x32_bf16 v[52:55], a[64:67], a[52:55], v[52:55]
    ds_read_b128 a[12:15], v6 offset:34816
    v_mfma_f32_16x16x32_bf16 v[56:59], a[68:71], a[48:51], v[56:59]
    ds_read_b128 a[16:19], v5 offset:35328
    v_mfma_f32_16x16x32_bf16 v[60:63], a[68:71], a[52:55], v[60:63]
    ds_read_b128 a[20:23], v6 offset:35328
    v_mfma_f32_16x16x32_bf16 v[64:67], a[72:75], a[48:51], v[64:67]
    ds_read_b128 a[24:27], v5 offset:35840
    v_mfma_f32_16x16x32_bf16 v[68:71], a[72:75], a[52:55], v[68:71]
    ds_read_b128 a[28:31], v6 offset:35840
    v_mfma_f32_16x16x32_bf16 v[72:75], a[76:79], a[48:51], v[72:75]
    ds_read_b128 a[32:35], v5 offset:36352
    v_mfma_f32_16x16x32_bf16 v[76:79], a[76:79], a[52:55], v[76:79]
    ds_read_b128 a[36:39], v6 offset:36352
    v_mfma_f32_16x16x32_bf16 v[80:83], a[80:83], a[48:51], v[80:83]
    ds_read_b128 a[40:43], v7 offset:34816
    v_mfma_f32_16x16x32_bf16 v[84:87], a[80:83], a[52:55], v[84:87]
    v_mfma_f32_16x16x32_bf16 v[88:91], a[84:87], a[48:51], v[88:91]
    v_mfma_f32_16x16x32_bf16 v[92:95], a[84:87], a[52:55], v[92:95]
    v_mfma_f32_16x16x32_bf16 v[96:99], a[88:91], a[48:51], v[96:99]
    v_mfma_f32_16x16x32_bf16 v[100:103], a[88:91], a[52:55], v[100:103]
    s_waitcnt lgkmcnt(8)
    v_mfma_f32_16x16x32_bf16 v[32:35], a[8:11], a[0:3], v[32:35]
    ds_read_b64_tr_b16 a[48:49], v11 offset:43008
    v_mfma_f32_16x16x32_bf16 v[36:39], a[8:11], a[4:7], v[36:39]
    ds_read_b64_tr_b16 a[50:51], v11 offset:47104
    s_waitcnt lgkmcnt(9)
    v_mfma_f32_16x16x32_bf16 v[40:43], a[12:15], a[0:3], v[40:43]
    ds_read_b64_tr_b16 a[52:53], v12 offset:43008
    v_mfma_f32_16x16x32_bf16 v[44:47], a[12:15], a[4:7], v[44:47]
    ds_read_b64_tr_b16 a[54:55], v12 offset:47104
    s_waitcnt lgkmcnt(10)
    v_mfma_f32_16x16x32_bf16 v[48:51], a[16:19], a[0:3], v[48:51]
    ds_read_b128 a[56:59], v5 offset:44032
    v_mfma_f32_16x16x32_bf16 v[52:55], a[16:19], a[4:7], v[52:55]
    ds_read_b128 a[60:63], v6 offset:44032
    s_waitcnt lgkmcnt(11)
    v_mfma_f32_16x16x32_bf16 v[56:59], a[20:23], a[0:3], v[56:59]
    ds_read_b128 a[64:67], v5 offset:44544
    v_mfma_f32_16x16x32_bf16 v[60:63], a[20:23], a[4:7], v[60:63]
    ds_read_b128 a[68:71], v6 offset:44544
    s_waitcnt lgkmcnt(12)
    v_mfma_f32_16x16x32_bf16 v[64:67], a[24:27], a[0:3], v[64:67]
    ds_read_b128 a[72:75], v5 offset:45056
    v_mfma_f32_16x16x32_bf16 v[68:71], a[24:27], a[4:7], v[68:71]
    ds_read_b128 a[76:79], v6 offset:45056
    s_waitcnt lgkmcnt(13)
    v_mfma_f32_16x16x32_bf16 v[72:75], a[28:31], a[0:3], v[72:75]
    ds_read_b128 a[80:83], v5 offset:45568
    v_mfma_f32_16x16x32_bf16 v[76:79], a[28:31], a[4:7], v[76:79]
    ds_read_b128 a[84:87], v6 offset:45568
    s_waitcnt lgkmcnt(14)
    v_mfma_f32_16x16x32_bf16 v[80:83], a[32:35], a[0:3], v[80:83]
    ds_read_b128 a[88:91], v7 offset:44032
    v_mfma_f32_16x16x32_bf16 v[84:87], a[32:35], a[4:7], v[84:87]
    s_waitcnt lgkmcnt(14)
    v_mfma_f32_16x16x32_bf16 v[88:91], a[36:39], a[0:3], v[88:91]
    v_mfma_f32_16x16x32_bf16 v[92:95], a[36:39], a[4:7], v[92:95]
    s_waitcnt lgkmcnt(13)
    v_mfma_f32_16x16x32_bf16 v[96:99], a[40:43], a[0:3], v[96:99]
    v_mfma_f32_16x16x32_bf16 v[100:103], a[40:43], a[4:7], v[100:103]
    s_waitcnt lgkmcnt(0)
    s_barrier
    v_mfma_f32_16x16x32_bf16 v[32:35], a[56:59], a[48:51], v[32:35]
    ds_read_b64_tr_b16 a[0:1], v13 offset:0
    v_mfma_f32_16x16x32_bf16 v[36:39], a[56:59], a[52:55], v[36:39]
    ds_read_b64_tr_b16 a[2:3], v13 offset:4096
    v_mfma_f32_16x16x32_bf16 v[40:43], a[60:63], a[48:51], v[40:43]
    ds_read_b64_tr_b16 a[4:5], v14 offset:0
    v_mfma_f32_16x16x32_bf16 v[44:47], a[60:63], a[52:55], v[44:47]
    ds_read_b64_tr_b16 a[6:7], v14 offset:4096
    v_mfma_f32_16x16x32_bf16 v[48:51], a[64:67], a[48:51], v[48:51]
    ds_read_b128 a[8:11], v8 offset:0
    v_mfma_f32_16x16x32_bf16 v[52:55], a[64:67], a[52:55], v[52:55]
    ds_read_b128 a[12:15], v9 offset:0
    v_mfma_f32_16x16x32_bf16 v[56:59], a[68:71], a[48:51], v[56:59]
    ds_read_b128 a[16:19], v8 offset:512
    v_mfma_f32_16x16x32_bf16 v[60:63], a[68:71], a[52:55], v[60:63]
    ds_read_b128 a[20:23], v9 offset:512
    v_mfma_f32_16x16x32_bf16 v[64:67], a[72:75], a[48:51], v[64:67]
    ds_read_b128 a[24:27], v8 offset:1024
    v_mfma_f32_16x16x32_bf16 v[68:71], a[72:75], a[52:55], v[68:71]
    ds_read_b128 a[28:31], v9 offset:1024
    v_mfma_f32_16x16x32_bf16 v[72:75], a[76:79], a[48:51], v[72:75]
    ds_read_b128 a[32:35], v8 offset:1536
    v_mfma_f32_16x16x32_bf16 v[76:79], a[76:79], a[52:55], v[76:79]
    ds_read_b128 a[36:39], v9 offset:1536
    v_mfma_f32_16x16x32_bf16 v[80:83], a[80:83], a[48:51], v[80:83]
    ds_read_b128 a[40:43], v10 offset:0
    v_mfma_f32_16x16x32_bf16 v[84:87], a[80:83], a[52:55], v[84:87]
    v_mfma_f32_16x16x32_bf16 v[88:91], a[84:87], a[48:51], v[88:91]
    v_mfma_f32_16x16x32_bf16 v[92:95], a[84:87], a[52:55], v[92:95]
    v_mfma_f32_16x16x32_bf16 v[96:99], a[88:91], a[48:51], v[96:99]
    v_mfma_f32_16x16x32_bf16 v[100:103], a[88:91], a[52:55], v[100:103]
    s_waitcnt lgkmcnt(8)
    v_mfma_f32_16x16x32_bf16 v[32:35], a[8:11], a[0:3], v[32:35]
    ds_read_b64_tr_b16 a[48:49], v13 offset:8192
    v_mfma_f32_16x16x32_bf16 v[36:39], a[8:11], a[4:7], v[36:39]
    ds_read_b64_tr_b16 a[50:51], v13 offset:12288
    s_waitcnt lgkmcnt(9)
    v_mfma_f32_16x16x32_bf16 v[40:43], a[12:15], a[0:3], v[40:43]
    ds_read_b64_tr_b16 a[52:53], v14 offset:8192
    v_mfma_f32_16x16x32_bf16 v[44:47], a[12:15], a[4:7], v[44:47]
    ds_read_b64_tr_b16 a[54:55], v14 offset:12288
    s_waitcnt lgkmcnt(10)
    v_mfma_f32_16x16x32_bf16 v[48:51], a[16:19], a[0:3], v[48:51]
    ds_read_b128 a[56:59], v8 offset:9216
    v_mfma_f32_16x16x32_bf16 v[52:55], a[16:19], a[4:7], v[52:55]
    ds_read_b128 a[60:63], v9 offset:9216
    s_waitcnt lgkmcnt(11)
    v_mfma_f32_16x16x32_bf16 v[56:59], a[20:23], a[0:3], v[56:59]
    ds_read_b128 a[64:67], v8 offset:9728
    v_mfma_f32_16x16x32_bf16 v[60:63], a[20:23], a[4:7], v[60:63]
    ds_read_b128 a[68:71], v9 offset:9728
    s_waitcnt lgkmcnt(12)
    v_mfma_f32_16x16x32_bf16 v[64:67], a[24:27], a[0:3], v[64:67]
    ds_read_b128 a[72:75], v8 offset:10240
    v_mfma_f32_16x16x32_bf16 v[68:71], a[24:27], a[4:7], v[68:71]
    ds_read_b128 a[76:79], v9 offset:10240
    s_waitcnt lgkmcnt(13)
    v_mfma_f32_16x16x32_bf16 v[72:75], a[28:31], a[0:3], v[72:75]
    ds_read_b128 a[80:83], v8 offset:10752
    v_mfma_f32_16x16x32_bf16 v[76:79], a[28:31], a[4:7], v[76:79]
    ds_read_b128 a[84:87], v9 offset:10752
    s_waitcnt lgkmcnt(14)
    v_mfma_f32_16x16x32_bf16 v[80:83], a[32:35], a[0:3], v[80:83]
    ds_read_b128 a[88:91], v10 offset:9216
    v_mfma_f32_16x16x32_bf16 v[84:87], a[32:35], a[4:7], v[84:87]
    s_waitcnt lgkmcnt(14)
    v_mfma_f32_16x16x32_bf16 v[88:91], a[36:39], a[0:3], v[88:91]
    v_mfma_f32_16x16x32_bf16 v[92:95], a[36:39], a[4:7], v[92:95]
    s_waitcnt lgkmcnt(13)
    v_mfma_f32_16x16x32_bf16 v[96:99], a[40:43], a[0:3], v[96:99]
    v_mfma_f32_16x16x32_bf16 v[100:103], a[40:43], a[4:7], v[100:103]
    s_waitcnt lgkmcnt(0)
    s_barrier
    v_mfma_f32_16x16x32_bf16 v[32:35], a[56:59], a[48:51], v[32:35]
    ds_read_b64_tr_b16 a[0:1], v13 offset:34816
    v_mfma_f32_16x16x32_bf16 v[36:39], a[56:59], a[52:55], v[36:39]
    ds_read_b64_tr_b16 a[2:3], v13 offset:38912
    v_mfma_f32_16x16x32_bf16 v[40:43], a[60:63], a[48:51], v[40:43]
    ds_read_b64_tr_b16 a[4:5], v14 offset:34816
    v_mfma_f32_16x16x32_bf16 v[44:47], a[60:63], a[52:55], v[44:47]
    ds_read_b64_tr_b16 a[6:7], v14 offset:38912
    v_mfma_f32_16x16x32_bf16 v[48:51], a[64:67], a[48:51], v[48:51]
    ds_read_b128 a[8:11], v8 offset:34816
    v_mfma_f32_16x16x32_bf16 v[52:55], a[64:67], a[52:55], v[52:55]
    ds_read_b128 a[12:15], v9 offset:34816
    v_mfma_f32_16x16x32_bf16 v[56:59], a[68:71], a[48:51], v[56:59]
    ds_read_b128 a[16:19], v8 offset:35328
    v_mfma_f32_16x16x32_bf16 v[60:63], a[68:71], a[52:55], v[60:63]
    ds_read_b128 a[20:23], v9 offset:35328
    v_mfma_f32_16x16x32_bf16 v[64:67], a[72:75], a[48:51], v[64:67]
    ds_read_b128 a[24:27], v8 offset:35840
    v_mfma_f32_16x16x32_bf16 v[68:71], a[72:75], a[52:55], v[68:71]
    ds_read_b128 a[28:31], v9 offset:35840
    v_mfma_f32_16x16x32_bf16 v[72:75], a[76:79], a[48:51], v[72:75]
    ds_read_b128 a[32:35], v8 offset:36352
    v_mfma_f32_16x16x32_bf16 v[76:79], a[76:79], a[52:55], v[76:79]
    ds_read_b128 a[36:39], v9 offset:36352
    v_mfma_f32_16x16x32_bf16 v[80:83], a[80:83], a[48:51], v[80:83]
    ds_read_b128 a[40:43], v10 offset:34816
    v_mfma_f32_16x16x32_bf16 v[84:87], a[80:83], a[52:55], v[84:87]
    v_mfma_f32_16x16x32_bf16 v[88:91], a[84:87], a[48:51], v[88:91]
    v_mfma_f32_16x16x32_bf16 v[92:95], a[84:87], a[52:55], v[92:95]
    v_mfma_f32_16x16x32_bf16 v[96:99], a[88:91], a[48:51], v[96:99]
    v_mfma_f32_16x16x32_bf16 v[100:103], a[88:91], a[52:55], v[100:103]
    s_waitcnt lgkmcnt(8)
    v_mfma_f32_16x16x32_bf16 v[32:35], a[8:11], a[0:3], v[32:35]
    ds_read_b64_tr_b16 a[48:49], v13 offset:43008
    v_mfma_f32_16x16x32_bf16 v[36:39], a[8:11], a[4:7], v[36:39]
    ds_read_b64_tr_b16 a[50:51], v13 offset:47104
    s_waitcnt lgkmcnt(9)
    v_mfma_f32_16x16x32_bf16 v[40:43], a[12:15], a[0:3], v[40:43]
    ds_read_b64_tr_b16 a[52:53], v14 offset:43008
    v_mfma_f32_16x16x32_bf16 v[44:47], a[12:15], a[4:7], v[44:47]
    ds_read_b64_tr_b16 a[54:55], v14 offset:47104
    s_waitcnt lgkmcnt(10)
    v_mfma_f32_16x16x32_bf16 v[48:51], a[16:19], a[0:3], v[48:51]
    ds_read_b128 a[56:59], v8 offset:44032
    v_mfma_f32_16x16x32_bf16 v[52:55], a[16:19], a[4:7], v[52:55]
    ds_read_b128 a[60:63], v9 offset:44032
    s_waitcnt lgkmcnt(11)
    v_mfma_f32_16x16x32_bf16 v[56:59], a[20:23], a[0:3], v[56:59]
    ds_read_b128 a[64:67], v8 offset:44544
    v_mfma_f32_16x16x32_bf16 v[60:63], a[20:23], a[4:7], v[60:63]
    ds_read_b128 a[68:71], v9 offset:44544
    s_waitcnt lgkmcnt(12)
    v_mfma_f32_16x16x32_bf16 v[64:67], a[24:27], a[0:3], v[64:67]
    ds_read_b128 a[72:75], v8 offset:45056
    v_mfma_f32_16x16x32_bf16 v[68:71], a[24:27], a[4:7], v[68:71]
    ds_read_b128 a[76:79], v9 offset:45056
    s_waitcnt lgkmcnt(13)
    v_mfma_f32_16x16x32_bf16 v[72:75], a[28:31], a[0:3], v[72:75]
    ds_read_b128 a[80:83], v8 offset:45568
    v_mfma_f32_16x16x32_bf16 v[76:79], a[28:31], a[4:7], v[76:79]
    ds_read_b128 a[84:87], v9 offset:45568
    s_waitcnt lgkmcnt(14)
    v_mfma_f32_16x16x32_bf16 v[80:83], a[32:35], a[0:3], v[80:83]
    ds_read_b128 a[88:91], v10 offset:44032
    v_mfma_f32_16x16x32_bf16 v[84:87], a[32:35], a[4:7], v[84:87]
    s_waitcnt lgkmcnt(14)
    v_mfma_f32_16x16x32_bf16 v[88:91], a[36:39], a[0:3], v[88:91]
    v_mfma_f32_16x16x32_bf16 v[92:95], a[36:39], a[4:7], v[92:95]
    s_waitcnt lgkmcnt(13)
    v_mfma_f32_16x16x32_bf16 v[96:99], a[40:43], a[0:3], v[96:99]
    v_mfma_f32_16x16x32_bf16 v[100:103], a[40:43], a[4:7], v[100:103]
    s_waitcnt lgkmcnt(0)
    s_barrier
    v_mfma_f32_16x16x32_bf16 v[32:35], a[56:59], a[48:51], v[32:35]
    ds_read_b64_tr_b16 a[0:1], v11 offset:0
    v_mfma_f32_16x16x32_bf16 v[36:39], a[56:59], a[52:55], v[36:39]
    ds_read_b64_tr_b16 a[2:3], v11 offset:4096
    v_mfma_f32_16x16x32_bf16 v[40:43], a[60:63], a[48:51], v[40:43]
    ds_read_b64_tr_b16 a[4:5], v12 offset:0
    v_mfma_f32_16x16x32_bf16 v[44:47], a[60:63], a[52:55], v[44:47]
    ds_read_b64_tr_b16 a[6:7], v12 offset:4096
    v_mfma_f32_16x16x32_bf16 v[48:51], a[64:67], a[48:51], v[48:51]
    ds_read_b128 a[8:11], v5 offset:0
    v_mfma_f32_16x16x32_bf16 v[52:55], a[64:67], a[52:55], v[52:55]
    ds_read_b128 a[12:15], v6 offset:0
    v_mfma_f32_16x16x32_bf16 v[56:59], a[68:71], a[48:51], v[56:59]
    ds_read_b128 a[16:19], v5 offset:512
    v_mfma_f32_16x16x32_bf16 v[60:63], a[68:71], a[52:55], v[60:63]
    ds_read_b128 a[20:23], v6 offset:512
    v_mfma_f32_16x16x32_bf16 v[64:67], a[72:75], a[48:51], v[64:67]
    ds_read_b128 a[24:27], v5 offset:1024
    v_mfma_f32_16x16x32_bf16 v[68:71], a[72:75], a[52:55], v[68:71]
    ds_read_b128 a[28:31], v6 offset:1024
    v_mfma_f32_16x16x32_bf16 v[72:75], a[76:79], a[48:51], v[72:75]
    ds_read_b128 a[32:35], v5 offset:1536
    v_mfma_f32_16x16x32_bf16 v[76:79], a[76:79], a[52:55], v[76:79]
    ds_read_b128 a[36:39], v6 offset:1536
    v_mfma_f32_16x16x32_bf16 v[80:83], a[80:83], a[48:51], v[80:83]
    ds_read_b128 a[40:43], v7 offset:0
    v_mfma_f32_16x16x32_bf16 v[84:87], a[80:83], a[52:55], v[84:87]
    v_mfma_f32_16x16x32_bf16 v[88:91], a[84:87], a[48:51], v[88:91]
    v_mfma_f32_16x16x32_bf16 v[92:95], a[84:87], a[52:55], v[92:95]
    v_mfma_f32_16x16x32_bf16 v[96:99], a[88:91], a[48:51], v[96:99]
    v_mfma_f32_16x16x32_bf16 v[100:103], a[88:91], a[52:55], v[100:103]
    s_waitcnt lgkmcnt(8)
    v_mfma_f32_16x16x32_bf16 v[32:35], a[8:11], a[0:3], v[32:35]
    ds_read_b64_tr_b16 a[48:49], v11 offset:8192
    v_mfma_f32_16x16x32_bf16 v[36:39], a[8:11], a[4:7], v[36:39]
    ds_read_b64_tr_b16 a[50:51], v11 offset:12288
    s_waitcnt lgkmcnt(9)
    v_mfma_f32_16x16x32_bf16 v[40:43], a[12:15], a[0:3], v[40:43]
    ds_read_b64_tr_b16 a[52:53], v12 offset:8192
    v_mfma_f32_16x16x32_bf16 v[44:47], a[12:15], a[4:7], v[44:47]
    ds_read_b64_tr_b16 a[54:55], v12 offset:12288
    s_waitcnt lgkmcnt(10)
    v_mfma_f32_16x16x32_bf16 v[48:51], a[16:19], a[0:3], v[48:51]
    ds_read_b128 a[56:59], v5 offset:9216
    v_mfma_f32_16x16x32_bf16 v[52:55], a[16:19], a[4:7], v[52:55]
    ds_read_b128 a[60:63], v6 offset:9216
    s_waitcnt lgkmcnt(11)
    v_mfma_f32_16x16x32_bf16 v[56:59], a[20:23], a[0:3], v[56:59]
    ds_read_b128 a[64:67], v5 offset:9728
    v_mfma_f32_16x16x32_bf16 v[60:63], a[20:23], a[4:7], v[60:63]
    ds_read_b128 a[68:71], v6 offset:9728
    s_waitcnt lgkmcnt(12)
    v_mfma_f32_16x16x32_bf16 v[64:67], a[24:27], a[0:3], v[64:67]
    ds_read_b128 a[72:75], v5 offset:10240
    v_mfma_f32_16x16x32_bf16 v[68:71], a[24:27], a[4:7], v[68:71]
    ds_read_b128 a[76:79], v6 offset:10240
    s_waitcnt lgkmcnt(13)
    v_mfma_f32_16x16x32_bf16 v[72:75], a[28:31], a[0:3], v[72:75]
    ds_read_b128 a[80:83], v5 offset:10752
    v_mfma_f32_16x16x32_bf16 v[76:79], a[28:31], a[4:7], v[76:79]
    ds_read_b128 a[84:87], v6 offset:10752
    s_waitcnt lgkmcnt(14)
    v_mfma_f32_16x16x32_bf16 v[80:83], a[32:35], a[0:3], v[80:83]
    ds_read_b128 a[88:91], v7 offset:9216
    v_mfma_f32_16x16x32_bf16 v[84:87], a[32:35], a[4:7], v[84:87]
    s_waitcnt lgkmcnt(14)
    v_mfma_f32_16x16x32_bf16 v[88:91], a[36:39], a[0:3], v[88:91]
    v_mfma_f32_16x16x32_bf16 v[92:95], a[36:39], a[4:7], v[92:95]
    s_waitcnt lgkmcnt(13)
    v_mfma_f32_16x16x32_bf16 v[96:99], a[40:43], a[0:3], v[96:99]
    v_mfma_f32_16x16x32_bf16 v[100:103], a[40:43], a[4:7], v[100:103]
    s_waitcnt lgkmcnt(0)
    s_barrier
    v_mfma_f32_16x16x32_bf16 v[32:35], a[56:59], a[48:51], v[32:35]
    ds_read_b64_tr_b16 a[0:1], v11 offset:34816
    v_mfma_f32_16x16x32_bf16 v[36:39], a[56:59], a[52:55], v[36:39]
    ds_read_b64_tr_b16 a[2:3], v11 offset:38912
    v_mfma_f32_16x16x32_bf16 v[40:43], a[60:63], a[48:51], v[40:43]
    ds_read_b64_tr_b16 a[4:5], v12 offset:34816
    v_mfma_f32_16x16x32_bf16 v[44:47], a[60:63], a[52:55], v[44:47]
    ds_read_b64_tr_b16 a[6:7], v12 offset:38912
    v_mfma_f32_16x16x32_bf16 v[48:51], a[64:67], a[48:51], v[48:51]
    ds_read_b128 a[8:11], v5 offset:34816
    v_mfma_f32_16x16x32_bf16 v[52:55], a[64:67], a[52:55], v[52:55]
    ds_read_b128 a[12:15], v6 offset:34816
    v_mfma_f32_16x16x32_bf16 v[56:59], a[68:71], a[48:51], v[56:59]
    ds_read_b128 a[16:19], v5 offset:35328
    v_mfma_f32_16x16x32_bf16 v[60:63], a[68:71], a[52:55], v[60:63]
    ds_read_b128 a[20:23], v6 offset:35328
    v_mfma_f32_16x16x32_bf16 v[64:67], a[72:75], a[48:51], v[64:67]
    ds_read_b128 a[24:27], v5 offset:35840
    v_mfma_f32_16x16x32_bf16 v[68:71], a[72:75], a[52:55], v[68:71]
    ds_read_b128 a[28:31], v6 offset:35840
    v_mfma_f32_16x16x32_bf16 v[72:75], a[76:79], a[48:51], v[72:75]
    ds_read_b128 a[32:35], v5 offset:36352
    v_mfma_f32_16x16x32_bf16 v[76:79], a[76:79], a[52:55], v[76:79]
    ds_read_b128 a[36:39], v6 offset:36352
    v_mfma_f32_16x16x32_bf16 v[80:83], a[80:83], a[48:51], v[80:83]
    ds_read_b128 a[40:43], v7 offset:34816
    v_mfma_f32_16x16x32_bf16 v[84:87], a[80:83], a[52:55], v[84:87]
    v_mfma_f32_16x16x32_bf16 v[88:91], a[84:87], a[48:51], v[88:91]
    v_mfma_f32_16x16x32_bf16 v[92:95], a[84:87], a[52:55], v[92:95]
    v_mfma_f32_16x16x32_bf16 v[96:99], a[88:91], a[48:51], v[96:99]
    v_mfma_f32_16x16x32_bf16 v[100:103], a[88:91], a[52:55], v[100:103]
    s_waitcnt lgkmcnt(8)
    v_mfma_f32_16x16x32_bf16 v[32:35], a[8:11], a[0:3], v[32:35]
    ds_read_b64_tr_b16 a[48:49], v11 offset:43008
    v_mfma_f32_16x16x32_bf16 v[36:39], a[8:11], a[4:7], v[36:39]
    ds_read_b64_tr_b16 a[50:51], v11 offset:47104
    s_waitcnt lgkmcnt(9)
    v_mfma_f32_16x16x32_bf16 v[40:43], a[12:15], a[0:3], v[40:43]
    ds_read_b64_tr_b16 a[52:53], v12 offset:43008
    v_mfma_f32_16x16x32_bf16 v[44:47], a[12:15], a[4:7], v[44:47]
    ds_read_b64_tr_b16 a[54:55], v12 offset:47104
    s_waitcnt lgkmcnt(10)
    v_mfma_f32_16x16x32_bf16 v[48:51], a[16:19], a[0:3], v[48:51]
    ds_read_b128 a[56:59], v5 offset:44032
    v_mfma_f32_16x16x32_bf16 v[52:55], a[16:19], a[4:7], v[52:55]
    ds_read_b128 a[60:63], v6 offset:44032
    s_waitcnt lgkmcnt(11)
    v_mfma_f32_16x16x32_bf16 v[56:59], a[20:23], a[0:3], v[56:59]
    ds_read_b128 a[64:67], v5 offset:44544
    v_mfma_f32_16x16x32_bf16 v[60:63], a[20:23], a[4:7], v[60:63]
    ds_read_b128 a[68:71], v6 offset:44544
    s_waitcnt lgkmcnt(12)
    v_mfma_f32_16x16x32_bf16 v[64:67], a[24:27], a[0:3], v[64:67]
    ds_read_b128 a[72:75], v5 offset:45056
    v_mfma_f32_16x16x32_bf16 v[68:71], a[24:27], a[4:7], v[68:71]
    ds_read_b128 a[76:79], v6 offset:45056
    s_waitcnt lgkmcnt(13)
    v_mfma_f32_16x16x32_bf16 v[72:75], a[28:31], a[0:3], v[72:75]
    ds_read_b128 a[80:83], v5 offset:45568
    v_mfma_f32_16x16x32_bf16 v[76:79], a[28:31], a[4:7], v[76:79]
    ds_read_b128 a[84:87], v6 offset:45568
    s_waitcnt lgkmcnt(14)
    v_mfma_f32_16x16x32_bf16 v[80:83], a[32:35], a[0:3], v[80:83]
    ds_read_b128 a[88:91], v7 offset:44032
    v_mfma_f32_16x16x32_bf16 v[84:87], a[32:35], a[4:7], v[84:87]
    s_waitcnt lgkmcnt(14)
    v_mfma_f32_16x16x32_bf16 v[88:91], a[36:39], a[0:3], v[88:91]
    v_mfma_f32_16x16x32_bf16 v[92:95], a[36:39], a[4:7], v[92:95]
    s_waitcnt lgkmcnt(13)
    v_mfma_f32_16x16x32_bf16 v[96:99], a[40:43], a[0:3], v[96:99]
    v_mfma_f32_16x16x32_bf16 v[100:103], a[40:43], a[4:7], v[100:103]
    s_waitcnt lgkmcnt(0)
    s_barrier
    v_mfma_f32_16x16x32_bf16 v[32:35], a[56:59], a[48:51], v[32:35]
    ds_read_b64_tr_b16 a[0:1], v13 offset:0
    v_mfma_f32_16x16x32_bf16 v[36:39], a[56:59], a[52:55], v[36:39]
    ds_read_b64_tr_b16 a[2:3], v13 offset:4096
    v_mfma_f32_16x16x32_bf16 v[40:43], a[60:63], a[48:51], v[40:43]
    ds_read_b64_tr_b16 a[4:5], v14 offset:0
    v_mfma_f32_16x16x32_bf16 v[44:47], a[60:63], a[52:55], v[44:47]
    ds_read_b64_tr_b16 a[6:7], v14 offset:4096
    v_mfma_f32_16x16x32_bf16 v[48:51], a[64:67], a[48:51], v[48:51]
    ds_read_b128 a[8:11], v8 offset:0
    v_mfma_f32_16x16x32_bf16 v[52:55], a[64:67], a[52:55], v[52:55]
    ds_read_b128 a[12:15], v9 offset:0
    v_mfma_f32_16x16x32_bf16 v[56:59], a[68:71], a[48:51], v[56:59]
    ds_read_b128 a[16:19], v8 offset:512
    v_mfma_f32_16x16x32_bf16 v[60:63], a[68:71], a[52:55], v[60:63]
    ds_read_b128 a[20:23], v9 offset:512
    v_mfma_f32_16x16x32_bf16 v[64:67], a[72:75], a[48:51], v[64:67]
    ds_read_b128 a[24:27], v8 offset:1024
    v_mfma_f32_16x16x32_bf16 v[68:71], a[72:75], a[52:55], v[68:71]
    ds_read_b128 a[28:31], v9 offset:1024
    v_mfma_f32_16x16x32_bf16 v[72:75], a[76:79], a[48:51], v[72:75]
    ds_read_b128 a[32:35], v8 offset:1536
    v_mfma_f32_16x16x32_bf16 v[76:79], a[76:79], a[52:55], v[76:79]
    ds_read_b128 a[36:39], v9 offset:1536
    v_mfma_f32_16x16x32_bf16 v[80:83], a[80:83], a[48:51], v[80:83]
    ds_read_b128 a[40:43], v10 offset:0
    v_mfma_f32_16x16x32_bf16 v[84:87], a[80:83], a[52:55], v[84:87]
    v_mfma_f32_16x16x32_bf16 v[88:91], a[84:87], a[48:51], v[88:91]
    v_mfma_f32_16x16x32_bf16 v[92:95], a[84:87], a[52:55], v[92:95]
    v_mfma_f32_16x16x32_bf16 v[96:99], a[88:91], a[48:51], v[96:99]
    v_mfma_f32_16x16x32_bf16 v[100:103], a[88:91], a[52:55], v[100:103]
    s_waitcnt lgkmcnt(8)
    v_mfma_f32_16x16x32_bf16 v[32:35], a[8:11], a[0:3], v[32:35]
    ds_read_b64_tr_b16 a[48:49], v13 offset:8192
    v_mfma_f32_16x16x32_bf16 v[36:39], a[8:11], a[4:7], v[36:39]
    ds_read_b64_tr_b16 a[50:51], v13 offset:12288
    s_waitcnt lgkmcnt(9)
    v_mfma_f32_16x16x32_bf16 v[40:43], a[12:15], a[0:3], v[40:43]
    ds_read_b64_tr_b16 a[52:53], v14 offset:8192
    v_mfma_f32_16x16x32_bf16 v[44:47], a[12:15], a[4:7], v[44:47]
    ds_read_b64_tr_b16 a[54:55], v14 offset:12288
    s_waitcnt lgkmcnt(10)
    v_mfma_f32_16x16x32_bf16 v[48:51], a[16:19], a[0:3], v[48:51]
    ds_read_b128 a[56:59], v8 offset:9216
    v_mfma_f32_16x16x32_bf16 v[52:55], a[16:19], a[4:7], v[52:55]
    ds_read_b128 a[60:63], v9 offset:9216
    s_waitcnt lgkmcnt(11)
    v_mfma_f32_16x16x32_bf16 v[56:59], a[20:23], a[0:3], v[56:59]
    ds_read_b128 a[64:67], v8 offset:9728
    v_mfma_f32_16x16x32_bf16 v[60:63], a[20:23], a[4:7], v[60:63]
    ds_read_b128 a[68:71], v9 offset:9728
    s_waitcnt lgkmcnt(12)
    v_mfma_f32_16x16x32_bf16 v[64:67], a[24:27], a[0:3], v[64:67]
    ds_read_b128 a[72:75], v8 offset:10240
    v_mfma_f32_16x16x32_bf16 v[68:71], a[24:27], a[4:7], v[68:71]
    ds_read_b128 a[76:79], v9 offset:10240
    s_waitcnt lgkmcnt(13)
    v_mfma_f32_16x16x32_bf16 v[72:75], a[28:31], a[0:3], v[72:75]
    ds_read_b128 a[80:83], v8 offset:10752
    v_mfma_f32_16x16x32_bf16 v[76:79], a[28:31], a[4:7], v[76:79]
    ds_read_b128 a[84:87], v9 offset:10752
    s_waitcnt lgkmcnt(14)
    v_mfma_f32_16x16x32_bf16 v[80:83], a[32:35], a[0:3], v[80:83]
    ds_read_b128 a[88:91], v10 offset:9216
    v_mfma_f32_16x16x32_bf16 v[84:87], a[32:35], a[4:7], v[84:87]
    s_waitcnt lgkmcnt(14)
    v_mfma_f32_16x16x32_bf16 v[88:91], a[36:39], a[0:3], v[88:91]
    v_mfma_f32_16x16x32_bf16 v[92:95], a[36:39], a[4:7], v[92:95]
    s_waitcnt lgkmcnt(13)
    v_mfma_f32_16x16x32_bf16 v[96:99], a[40:43], a[0:3], v[96:99]
    v_mfma_f32_16x16x32_bf16 v[100:103], a[40:43], a[4:7], v[100:103]
    s_waitcnt lgkmcnt(0)
    s_barrier
    v_mfma_f32_16x16x32_bf16 v[32:35], a[56:59], a[48:51], v[32:35]
    ds_read_b64_tr_b16 a[0:1], v13 offset:34816
    v_mfma_f32_16x16x32_bf16 v[36:39], a[56:59], a[52:55], v[36:39]
    ds_read_b64_tr_b16 a[2:3], v13 offset:38912
    v_mfma_f32_16x16x32_bf16 v[40:43], a[60:63], a[48:51], v[40:43]
    ds_read_b64_tr_b16 a[4:5], v14 offset:34816
    v_mfma_f32_16x16x32_bf16 v[44:47], a[60:63], a[52:55], v[44:47]
    ds_read_b64_tr_b16 a[6:7], v14 offset:38912
    v_mfma_f32_16x16x32_bf16 v[48:51], a[64:67], a[48:51], v[48:51]
    ds_read_b128 a[8:11], v8 offset:34816
    v_mfma_f32_16x16x32_bf16 v[52:55], a[64:67], a[52:55], v[52:55]
    ds_read_b128 a[12:15], v9 offset:34816
    v_mfma_f32_16x16x32_bf16 v[56:59], a[68:71], a[48:51], v[56:59]
    ds_read_b128 a[16:19], v8 offset:35328
    v_mfma_f32_16x16x32_bf16 v[60:63], a[68:71], a[52:55], v[60:63]
    ds_read_b128 a[20:23], v9 offset:35328
    v_mfma_f32_16x16x32_bf16 v[64:67], a[72:75], a[48:51], v[64:67]
    ds_read_b128 a[24:27], v8 offset:35840
    v_mfma_f32_16x16x32_bf16 v[68:71], a[72:75], a[52:55], v[68:71]
    ds_read_b128 a[28:31], v9 offset:35840
    v_mfma_f32_16x16x32_bf16 v[72:75], a[76:79], a[48:51], v[72:75]
    ds_read_b128 a[32:35], v8 offset:36352
    v_mfma_f32_16x16x32_bf16 v[76:79], a[76:79], a[52:55], v[76:79]
    ds_read_b128 a[36:39], v9 offset:36352
    v_mfma_f32_16x16x32_bf16 v[80:83], a[80:83], a[48:51], v[80:83]
    ds_read_b128 a[40:43], v10 offset:34816
    v_mfma_f32_16x16x32_bf16 v[84:87], a[80:83], a[52:55], v[84:87]
    v_mfma_f32_16x16x32_bf16 v[88:91], a[84:87], a[48:51], v[88:91]
    v_mfma_f32_16x16x32_bf16 v[92:95], a[84:87], a[52:55], v[92:95]
    v_mfma_f32_16x16x32_bf16 v[96:99], a[88:91], a[48:51], v[96:99]
    v_mfma_f32_16x16x32_bf16 v[100:103], a[88:91], a[52:55], v[100:103]
    s_waitcnt lgkmcnt(8)
    v_mfma_f32_16x16x32_bf16 v[32:35], a[8:11], a[0:3], v[32:35]
    ds_read_b64_tr_b16 a[48:49], v13 offset:43008
    v_mfma_f32_16x16x32_bf16 v[36:39], a[8:11], a[4:7], v[36:39]
    ds_read_b64_tr_b16 a[50:51], v13 offset:47104
    s_waitcnt lgkmcnt(9)
    v_mfma_f32_16x16x32_bf16 v[40:43], a[12:15], a[0:3], v[40:43]
    ds_read_b64_tr_b16 a[52:53], v14 offset:43008
    v_mfma_f32_16x16x32_bf16 v[44:47], a[12:15], a[4:7], v[44:47]
    ds_read_b64_tr_b16 a[54:55], v14 offset:47104
    s_waitcnt lgkmcnt(10)
    v_mfma_f32_16x16x32_bf16 v[48:51], a[16:19], a[0:3], v[48:51]
    ds_read_b128 a[56:59], v8 offset:44032
    v_mfma_f32_16x16x32_bf16 v[52:55], a[16:19], a[4:7], v[52:55]
    ds_read_b128 a[60:63], v9 offset:44032
    s_waitcnt lgkmcnt(11)
    v_mfma_f32_16x16x32_bf16 v[56:59], a[20:23], a[0:3], v[56:59]
    ds_read_b128 a[64:67], v8 offset:44544
    v_mfma_f32_16x16x32_bf16 v[60:63], a[20:23], a[4:7], v[60:63]
    ds_read_b128 a[68:71], v9 offset:44544
    s_waitcnt lgkmcnt(12)
    v_mfma_f32_16x16x32_bf16 v[64:67], a[24:27], a[0:3], v[64:67]
    ds_read_b128 a[72:75], v8 offset:45056
    v_mfma_f32_16x16x32_bf16 v[68:71], a[24:27], a[4:7], v[68:71]
    ds_read_b128 a[76:79], v9 offset:45056
    s_waitcnt lgkmcnt(13)
    v_mfma_f32_16x16x32_bf16 v[72:75], a[28:31], a[0:3], v[72:75]
    ds_read_b128 a[80:83], v8 offset:45568
    v_mfma_f32_16x16x32_bf16 v[76:79], a[28:31], a[4:7], v[76:79]
    ds_read_b128 a[84:87], v9 offset:45568
    s_waitcnt lgkmcnt(14)
    v_mfma_f32_16x16x32_bf16 v[80:83], a[32:35], a[0:3], v[80:83]
    ds_read_b128 a[88:91], v10 offset:44032
    v_mfma_f32_16x16x32_bf16 v[84:87], a[32:35], a[4:7], v[84:87]
    s_waitcnt lgkmcnt(14)
    v_mfma_f32_16x16x32_bf16 v[88:91], a[36:39], a[0:3], v[88:91]
    v_mfma_f32_16x16x32_bf16 v[92:95], a[36:39], a[4:7], v[92:95]
    s_waitcnt lgkmcnt(13)
    v_mfma_f32_16x16x32_bf16 v[96:99], a[40:43], a[0:3], v[96:99]
    v_mfma_f32_16x16x32_bf16 v[100:103], a[40:43], a[4:7], v[100:103]
    s_waitcnt lgkmcnt(0)
    s_barrier
    v_mfma_f32_16x16x32_bf16 v[32:35], a[56:59], a[48:51], v[32:35]
    ds_read_b64_tr_b16 a[0:1], v11 offset:0
    v_mfma_f32_16x16x32_bf16 v[36:39], a[56:59], a[52:55], v[36:39]
    ds_read_b64_tr_b16 a[2:3], v11 offset:4096
    v_mfma_f32_16x16x32_bf16 v[40:43], a[60:63], a[48:51], v[40:43]
    ds_read_b64_tr_b16 a[4:5], v12 offset:0
    v_mfma_f32_16x16x32_bf16 v[44:47], a[60:63], a[52:55], v[44:47]
    ds_read_b64_tr_b16 a[6:7], v12 offset:4096
    v_mfma_f32_16x16x32_bf16 v[48:51], a[64:67], a[48:51], v[48:51]
    ds_read_b128 a[8:11], v5 offset:0
    v_mfma_f32_16x16x32_bf16 v[52:55], a[64:67], a[52:55], v[52:55]
    ds_read_b128 a[12:15], v6 offset:0
    v_mfma_f32_16x16x32_bf16 v[56:59], a[68:71], a[48:51], v[56:59]
    ds_read_b128 a[16:19], v5 offset:512
    v_mfma_f32_16x16x32_bf16 v[60:63], a[68:71], a[52:55], v[60:63]
    ds_read_b128 a[20:23], v6 offset:512
    v_mfma_f32_16x16x32_bf16 v[64:67], a[72:75], a[48:51], v[64:67]
    ds_read_b128 a[24:27], v5 offset:1024
    v_mfma_f32_16x16x32_bf16 v[68:71], a[72:75], a[52:55], v[68:71]
    ds_read_b128 a[28:31], v6 offset:1024
    v_mfma_f32_16x16x32_bf16 v[72:75], a[76:79], a[48:51], v[72:75]
    ds_read_b128 a[32:35], v5 offset:1536
    v_mfma_f32_16x16x32_bf16 v[76:79], a[76:79], a[52:55], v[76:79]
    ds_read_b128 a[36:39], v6 offset:1536
    v_mfma_f32_16x16x32_bf16 v[80:83], a[80:83], a[48:51], v[80:83]
    ds_read_b128 a[40:43], v7 offset:0
    v_mfma_f32_16x16x32_bf16 v[84:87], a[80:83], a[52:55], v[84:87]
    v_mfma_f32_16x16x32_bf16 v[88:91], a[84:87], a[48:51], v[88:91]
    v_mfma_f32_16x16x32_bf16 v[92:95], a[84:87], a[52:55], v[92:95]
    v_mfma_f32_16x16x32_bf16 v[96:99], a[88:91], a[48:51], v[96:99]
    v_mfma_f32_16x16x32_bf16 v[100:103], a[88:91], a[52:55], v[100:103]
    s_waitcnt lgkmcnt(8)
    v_mfma_f32_16x16x32_bf16 v[32:35], a[8:11], a[0:3], v[32:35]
    ds_read_b64_tr_b16 a[48:49], v11 offset:8192
    v_mfma_f32_16x16x32_bf16 v[36:39], a[8:11], a[4:7], v[36:39]
    ds_read_b64_tr_b16 a[50:51], v11 offset:12288
    s_waitcnt lgkmcnt(9)
    v_mfma_f32_16x16x32_bf16 v[40:43], a[12:15], a[0:3], v[40:43]
    ds_read_b64_tr_b16 a[52:53], v12 offset:8192
    v_mfma_f32_16x16x32_bf16 v[44:47], a[12:15], a[4:7], v[44:47]
    ds_read_b64_tr_b16 a[54:55], v12 offset:12288
    s_waitcnt lgkmcnt(10)
    v_mfma_f32_16x16x32_bf16 v[48:51], a[16:19], a[0:3], v[48:51]
    ds_read_b128 a[56:59], v5 offset:9216
    v_mfma_f32_16x16x32_bf16 v[52:55], a[16:19], a[4:7], v[52:55]
    ds_read_b128 a[60:63], v6 offset:9216
    s_waitcnt lgkmcnt(11)
    v_mfma_f32_16x16x32_bf16 v[56:59], a[20:23], a[0:3], v[56:59]
    ds_read_b128 a[64:67], v5 offset:9728
    v_mfma_f32_16x16x32_bf16 v[60:63], a[20:23], a[4:7], v[60:63]
    ds_read_b128 a[68:71], v6 offset:9728
    s_waitcnt lgkmcnt(12)
    v_mfma_f32_16x16x32_bf16 v[64:67], a[24:27], a[0:3], v[64:67]
    ds_read_b128 a[72:75], v5 offset:10240
    v_mfma_f32_16x16x32_bf16 v[68:71], a[24:27], a[4:7], v[68:71]
    ds_read_b128 a[76:79], v6 offset:10240
    s_waitcnt lgkmcnt(13)
    v_mfma_f32_16x16x32_bf16 v[72:75], a[28:31], a[0:3], v[72:75]
    ds_read_b128 a[80:83], v5 offset:10752
    v_mfma_f32_16x16x32_bf16 v[76:79], a[28:31], a[4:7], v[76:79]
    ds_read_b128 a[84:87], v6 offset:10752
    s_waitcnt lgkmcnt(14)
    v_mfma_f32_16x16x32_bf16 v[80:83], a[32:35], a[0:3], v[80:83]
    ds_read_b128 a[88:91], v7 offset:9216
    v_mfma_f32_16x16x32_bf16 v[84:87], a[32:35], a[4:7], v[84:87]
    s_waitcnt lgkmcnt(14)
    v_mfma_f32_16x16x32_bf16 v[88:91], a[36:39], a[0:3], v[88:91]
    v_mfma_f32_16x16x32_bf16 v[92:95], a[36:39], a[4:7], v[92:95]
    s_waitcnt lgkmcnt(13)
    v_mfma_f32_16x16x32_bf16 v[96:99], a[40:43], a[0:3], v[96:99]
    v_mfma_f32_16x16x32_bf16 v[100:103], a[40:43], a[4:7], v[100:103]
    s_waitcnt lgkmcnt(0)
    s_barrier
    v_mfma_f32_16x16x32_bf16 v[32:35], a[56:59], a[48:51], v[32:35]
    ds_read_b64_tr_b16 a[0:1], v11 offset:34816
    v_mfma_f32_16x16x32_bf16 v[36:39], a[56:59], a[52:55], v[36:39]
    ds_read_b64_tr_b16 a[2:3], v11 offset:38912
    v_mfma_f32_16x16x32_bf16 v[40:43], a[60:63], a[48:51], v[40:43]
    ds_read_b64_tr_b16 a[4:5], v12 offset:34816
    v_mfma_f32_16x16x32_bf16 v[44:47], a[60:63], a[52:55], v[44:47]
    ds_read_b64_tr_b16 a[6:7], v12 offset:38912
    v_mfma_f32_16x16x32_bf16 v[48:51], a[64:67], a[48:51], v[48:51]
    ds_read_b128 a[8:11], v5 offset:34816
    v_mfma_f32_16x16x32_bf16 v[52:55], a[64:67], a[52:55], v[52:55]
    ds_read_b128 a[12:15], v6 offset:34816
    v_mfma_f32_16x16x32_bf16 v[56:59], a[68:71], a[48:51], v[56:59]
    ds_read_b128 a[16:19], v5 offset:35328
    v_mfma_f32_16x16x32_bf16 v[60:63], a[68:71], a[52:55], v[60:63]
    ds_read_b128 a[20:23], v6 offset:35328
    v_mfma_f32_16x16x32_bf16 v[64:67], a[72:75], a[48:51], v[64:67]
    ds_read_b128 a[24:27], v5 offset:35840
    v_mfma_f32_16x16x32_bf16 v[68:71], a[72:75], a[52:55], v[68:71]
    ds_read_b128 a[28:31], v6 offset:35840
    v_mfma_f32_16x16x32_bf16 v[72:75], a[76:79], a[48:51], v[72:75]
    ds_read_b128 a[32:35], v5 offset:36352
    v_mfma_f32_16x16x32_bf16 v[76:79], a[76:79], a[52:55], v[76:79]
    ds_read_b128 a[36:39], v6 offset:36352
    v_mfma_f32_16x16x32_bf16 v[80:83], a[80:83], a[48:51], v[80:83]
    ds_read_b128 a[40:43], v7 offset:34816
    v_mfma_f32_16x16x32_bf16 v[84:87], a[80:83], a[52:55], v[84:87]
    v_mfma_f32_16x16x32_bf16 v[88:91], a[84:87], a[48:51], v[88:91]
    v_mfma_f32_16x16x32_bf16 v[92:95], a[84:87], a[52:55], v[92:95]
    v_mfma_f32_16x16x32_bf16 v[96:99], a[88:91], a[48:51], v[96:99]
    v_mfma_f32_16x16x32_bf16 v[100:103], a[88:91], a[52:55], v[100:103]
    s_waitcnt lgkmcnt(8)
    v_mfma_f32_16x16x32_bf16 v[32:35], a[8:11], a[0:3], v[32:35]
    ds_read_b64_tr_b16 a[48:49], v11 offset:43008
    v_mfma_f32_16x16x32_bf16 v[36:39], a[8:11], a[4:7], v[36:39]
    ds_read_b64_tr_b16 a[50:51], v11 offset:47104
    s_waitcnt lgkmcnt(9)
    v_mfma_f32_16x16x32_bf16 v[40:43], a[12:15], a[0:3], v[40:43]
    ds_read_b64_tr_b16 a[52:53], v12 offset:43008
    v_mfma_f32_16x16x32_bf16 v[44:47], a[12:15], a[4:7], v[44:47]
    ds_read_b64_tr_b16 a[54:55], v12 offset:47104
    s_waitcnt lgkmcnt(10)
    v_mfma_f32_16x16x32_bf16 v[48:51], a[16:19], a[0:3], v[48:51]
    ds_read_b128 a[56:59], v5 offset:44032
    v_mfma_f32_16x16x32_bf16 v[52:55], a[16:19], a[4:7], v[52:55]
    ds_read_b128 a[60:63], v6 offset:44032
    s_waitcnt lgkmcnt(11)
    v_mfma_f32_16x16x32_bf16 v[56:59], a[20:23], a[0:3], v[56:59]
    ds_read_b128 a[64:67], v5 offset:44544
    v_mfma_f32_16x16x32_bf16 v[60:63], a[20:23], a[4:7], v[60:63]
    ds_read_b128 a[68:71], v6 offset:44544
    s_waitcnt lgkmcnt(12)
    v_mfma_f32_16x16x32_bf16 v[64:67], a[24:27], a[0:3], v[64:67]
    ds_read_b128 a[72:75], v5 offset:45056
    v_mfma_f32_16x16x32_bf16 v[68:71], a[24:27], a[4:7], v[68:71]
    ds_read_b128 a[76:79], v6 offset:45056
    s_waitcnt lgkmcnt(13)
    v_mfma_f32_16x16x32_bf16 v[72:75], a[28:31], a[0:3], v[72:75]
    ds_read_b128 a[80:83], v5 offset:45568
    v_mfma_f32_16x16x32_bf16 v[76:79], a[28:31], a[4:7], v[76:79]
    ds_read_b128 a[84:87], v6 offset:45568
    s_waitcnt lgkmcnt(14)
    v_mfma_f32_16x16x32_bf16 v[80:83], a[32:35], a[0:3], v[80:83]
    ds_read_b128 a[88:91], v7 offset:44032
    v_mfma_f32_16x16x32_bf16 v[84:87], a[32:35], a[4:7], v[84:87]
    s_waitcnt lgkmcnt(14)
    v_mfma_f32_16x16x32_bf16 v[88:91], a[36:39], a[0:3], v[88:91]
    v_mfma_f32_16x16x32_bf16 v[92:95], a[36:39], a[4:7], v[92:95]
    s_waitcnt lgkmcnt(13)
    v_mfma_f32_16x16x32_bf16 v[96:99], a[40:43], a[0:3], v[96:99]
    v_mfma_f32_16x16x32_bf16 v[100:103], a[40:43], a[4:7], v[100:103]
    s_waitcnt lgkmcnt(0)
    s_barrier
    v_mfma_f32_16x16x32_bf16 v[32:35], a[56:59], a[48:51], v[32:35]
    v_mfma_f32_16x16x32_bf16 v[36:39], a[56:59], a[52:55], v[36:39]
    v_mfma_f32_16x16x32_bf16 v[40:43], a[60:63], a[48:51], v[40:43]
    v_mfma_f32_16x16x32_bf16 v[44:47], a[60:63], a[52:55], v[44:47]
    v_mfma_f32_16x16x32_bf16 v[48:51], a[64:67], a[48:51], v[48:51]
    v_mfma_f32_16x16x32_bf16 v[52:55], a[64:67], a[52:55], v[52:55]
    v_mfma_f32_16x16x32_bf16 v[56:59], a[68:71], a[48:51], v[56:59]
    v_mfma_f32_16x16x32_bf16 v[60:63], a[68:71], a[52:55], v[60:63]
    v_mfma_f32_16x16x32_bf16 v[64:67], a[72:75], a[48:51], v[64:67]
    v_mfma_f32_16x16x32_bf16 v[68:71], a[72:75], a[52:55], v[68:71]
    v_mfma_f32_16x16x32_bf16 v[72:75], a[76:79], a[48:51], v[72:75]
    v_mfma_f32_16x16x32_bf16 v[76:79], a[76:79], a[52:55], v[76:79]
    v_mfma_f32_16x16x32_bf16 v[80:83], a[80:83], a[48:51], v[80:83]
    v_mfma_f32_16x16x32_bf16 v[84:87], a[80:83], a[52:55], v[84:87]
    v_mfma_f32_16x16x32_bf16 v[88:91], a[84:87], a[48:51], v[88:91]
    v_mfma_f32_16x16x32_bf16 v[92:95], a[84:87], a[52:55], v[92:95]
    v_mfma_f32_16x16x32_bf16 v[96:99], a[88:91], a[48:51], v[96:99]
    v_mfma_f32_16x16x32_bf16 v[100:103], a[88:91], a[52:55], v[100:103]
    s_nop 7
    s_nop 7
    s_lshl_b32 s38, s37, 2
    s_add_u32 s38, s38, s34
    s_lshl_b32 s38, s38, 2
    s_add_u32 s39, s38, s25
    s_lshl_b32 s56, s39, 9
    s_lshl_b32 s48, s36, 7
    s_add_u32 s56, s56, s48
    s_add_u32 s56, s56, 31719424

    s_mul_i32 s39, s39, 3
    s_add_u32 s39, s39, s36
    s_cmp_gt_u32 s36, s25
    s_cselect_b32 s48, 1, 0
    s_sub_u32 s39, s39, s48

    s_mul_i32 s54, s39, 9216
    s_add_u32 s54, s54, 42991616
    s_cmp_eq_u32 s25, s36
    s_cbranch_scc1 L_m_t2_keep

    v_cvt_pk_f16_f32 v124, v32, v33
    v_cvt_pk_f16_f32 v125, v34, v35
    v_cvt_pk_f16_f32 v126, v40, v41
    v_cvt_pk_f16_f32 v127, v42, v43

    buffer_store_dwordx4 v[124:127], v3, s[12:15], s54 offen offset:0 sc1
    v_cvt_pk_f16_f32 v128, v48, v49
    v_cvt_pk_f16_f32 v129, v50, v51
    v_cvt_pk_f16_f32 v130, v56, v57
    v_cvt_pk_f16_f32 v131, v58, v59

    buffer_store_dwordx4 v[128:131], v3, s[12:15], s54 offen offset:1024 sc1
    v_cvt_pk_f16_f32 v132, v64, v65
    v_cvt_pk_f16_f32 v133, v66, v67
    v_cvt_pk_f16_f32 v134, v72, v73
    v_cvt_pk_f16_f32 v135, v74, v75

    buffer_store_dwordx4 v[132:135], v3, s[12:15], s54 offen offset:2048 sc1
    v_cvt_pk_f16_f32 v136, v80, v81
    v_cvt_pk_f16_f32 v137, v82, v83
    v_cvt_pk_f16_f32 v138, v88, v89
    v_cvt_pk_f16_f32 v139, v90, v91

    buffer_store_dwordx4 v[136:139], v3, s[12:15], s54 offen offset:3072 sc1
    v_cvt_pk_f16_f32 v140, v36, v37
    v_cvt_pk_f16_f32 v141, v38, v39
    v_cvt_pk_f16_f32 v142, v44, v45
    v_cvt_pk_f16_f32 v143, v46, v47

    s_add_u32 s54, s54, 4096
    buffer_store_dwordx4 v[140:143], v3, s[12:15], s54 offen offset:0 sc1
    v_cvt_pk_f16_f32 v144, v52, v53
    v_cvt_pk_f16_f32 v145, v54, v55
    v_cvt_pk_f16_f32 v146, v60, v61
    v_cvt_pk_f16_f32 v147, v62, v63

    buffer_store_dwordx4 v[144:147], v3, s[12:15], s54 offen offset:1024 sc1
    v_cvt_pk_f16_f32 v148, v68, v69
    v_cvt_pk_f16_f32 v149, v70, v71
    v_cvt_pk_f16_f32 v150, v76, v77
    v_cvt_pk_f16_f32 v151, v78, v79

    buffer_store_dwordx4 v[148:151], v3, s[12:15], s54 offen offset:2048 sc1
    v_cvt_pk_f16_f32 v152, v84, v85
    v_cvt_pk_f16_f32 v153, v86, v87
    v_cvt_pk_f16_f32 v154, v92, v93
    v_cvt_pk_f16_f32 v155, v94, v95

    buffer_store_dwordx4 v[152:155], v3, s[12:15], s54 offen offset:3072 sc1
    v_cvt_pk_f16_f32 v104, v96, v97
    v_cvt_pk_f16_f32 v105, v98, v99
    v_cvt_pk_f16_f32 v106, v100, v101
    v_cvt_pk_f16_f32 v107, v102, v103

    s_add_u32 s54, s54, 4096
    buffer_store_dwordx4 v[104:107], v3, s[12:15], s54 offen offset:0 sc1
    s_barrier
    s_branch L_m_t2_fin
L_m_t2_keep:
    ds_write_b128 v3, v[32:35] offset:0
    ds_write_b128 v3, v[36:39] offset:1024
    ds_write_b128 v3, v[40:43] offset:2048
    ds_write_b128 v3, v[44:47] offset:3072
    ds_write_b128 v3, v[48:51] offset:4096
    ds_write_b128 v3, v[52:55] offset:5120
    ds_write_b128 v3, v[56:59] offset:6144
    ds_write_b128 v3, v[60:63] offset:7168
    ds_write_b128 v3, v[64:67] offset:8192
    ds_write_b128 v3, v[68:71] offset:9216
    ds_write_b128 v3, v[72:75] offset:10240
    ds_write_b128 v3, v[76:79] offset:11264
    ds_write_b128 v3, v[80:83] offset:12288
    ds_write_b128 v3, v[84:87] offset:13312
    ds_write_b128 v3, v[88:91] offset:14336
    ds_write_b128 v3, v[92:95] offset:15360
    ds_write_b128 v3, v[96:99] offset:16384
    ds_write_b128 v3, v[100:103] offset:17408
    s_waitcnt lgkmcnt(0)
    s_barrier
    s_branch L_m_t2_fin
L_m_loader2:
    s_mov_b32 s52, s8
    s_and_b32 s53, s9, 0xffff
    s_mov_b32 s54, 18874368
    s_mov_b32 s55, 0x00020000
    s_sub_u32 s38, s24, 4
    s_lshl_b32 s39, s31, 2
    s_add_u32 s38, s38, s39
    s_lshr_b32 s39, s38, 4
    s_mul_i32 s42, s36, 1152
    s_add_u32 s42, s42, s39
    s_lshl_b32 s42, s42, 12
    s_and_b32 s38, s38, 15
    s_lshl_b32 s38, s38, 7
    s_add_u32 s42, s42, s38
    s_and_b32 s38, s30, 1
    s_lshl_b32 s38, s38, 11
    s_add_u32 s42, s42, s38
    s_add_u32 s42, s42, 3145728

    s_cmp_ge_u32 s24, 6
    s_cbranch_scc1 L_m_oload2
    s_and_b32 s38, s24, 1
    s_mul_i32 s38, s38, 576
    s_mov_b32 s39, 29826162
    s_add_u32 s48, s38, 0
    v_add_u32 v14, s48, v0
    v_mul_hi_u32 v15, v14, s39
    v_mul_u32_u24 v16, 144, v15
    v_sub_u32 v16, v14, v16

    v_and_b32 v17, 1, v15
    v_lshlrev_b32 v17, 2, v17
    v_xor_b32 v16, v16, v17
    v_mul_u32_u24 v15, 9216, v15
    v_lshlrev_b32 v16, 4, v16
    v_add_u32 v5, v15, v16

    s_add_u32 s48, s38, 64
    v_add_u32 v14, s48, v0
    v_mul_hi_u32 v15, v14, s39
    v_mul_u32_u24 v16, 144, v15
    v_sub_u32 v16, v14, v16

    v_and_b32 v17, 1, v15
    v_lshlrev_b32 v17, 2, v17
    v_xor_b32 v16, v16, v17
    v_mul_u32_u24 v15, 9216, v15
    v_lshlrev_b32 v16, 4, v16
    v_add_u32 v6, v15, v16

    s_add_u32 s48, s38, 128
    v_add_u32 v14, s48, v0
    v_mul_hi_u32 v15, v14, s39
    v_mul_u32_u24 v16, 144, v15
    v_sub_u32 v16, v14, v16

    v_and_b32 v17, 1, v15
    v_lshlrev_b32 v17, 2, v17
    v_xor_b32 v16, v16, v17
    v_mul_u32_u24 v15, 9216, v15
    v_lshlrev_b32 v16, 4, v16
    v_add_u32 v7, v15, v16

    s_add_u32 s48, s38, 192
    v_add_u32 v14, s48, v0
    v_mul_hi_u32 v15, v14, s39
    v_mul_u32_u24 v16, 144, v15
    v_sub_u32 v16, v14, v16

    v_and_b32 v17, 1, v15
    v_lshlrev_b32 v17, 2, v17
    v_xor_b32 v16, v16, v17
    v_mul_u32_u24 v15, 9216, v15
    v_lshlrev_b32 v16, 4, v16
    v_add_u32 v8, v15, v16

    s_add_u32 s48, s38, 256
    v_add_u32 v14, s48, v0
    v_mul_hi_u32 v15, v14, s39
    v_mul_u32_u24 v16, 144, v15
    v_sub_u32 v16, v14, v16

    v_and_b32 v17, 1, v15
    v_lshlrev_b32 v17, 2, v17
    v_xor_b32 v16, v16, v17
    v_mul_u32_u24 v15, 9216, v15
    v_lshlrev_b32 v16, 4, v16
    v_add_u32 v9, v15, v16

    s_add_u32 s48, s38, 320
    v_add_u32 v14, s48, v0
    v_mul_hi_u32 v15, v14, s39
    v_mul_u32_u24 v16, 144, v15
    v_sub_u32 v16, v14, v16

    v_and_b32 v17, 1, v15
    v_lshlrev_b32 v17, 2, v17
    v_xor_b32 v16, v16, v17
    v_mul_u32_u24 v15, 9216, v15
    v_lshlrev_b32 v16, 4, v16
    v_add_u32 v10, v15, v16

    s_add_u32 s48, s38, 384
    v_add_u32 v14, s48, v0
    v_mul_hi_u32 v15, v14, s39
    v_mul_u32_u24 v16, 144, v15
    v_sub_u32 v16, v14, v16

    v_and_b32 v17, 1, v15
    v_lshlrev_b32 v17, 2, v17
    v_xor_b32 v16, v16, v17
    v_mul_u32_u24 v15, 9216, v15
    v_lshlrev_b32 v16, 4, v16
    v_add_u32 v11, v15, v16

    s_add_u32 s48, s38, 448
    v_add_u32 v14, s48, v0
    v_mul_hi_u32 v15, v14, s39
    v_mul_u32_u24 v16, 144, v15
    v_sub_u32 v16, v14, v16

    v_and_b32 v17, 1, v15
    v_lshlrev_b32 v17, 2, v17
    v_xor_b32 v16, v16, v17
    v_mul_u32_u24 v15, 9216, v15
    v_lshlrev_b32 v16, 4, v16
    v_add_u32 v12, v15, v16

    s_add_u32 s48, s38, 512
    v_add_u32 v14, s48, v0
    v_mul_hi_u32 v15, v14, s39
    v_mul_u32_u24 v16, 144, v15
    v_sub_u32 v16, v14, v16

    v_and_b32 v17, 1, v15
    v_lshlrev_b32 v17, 2, v17
    v_xor_b32 v16, v16, v17
    v_mul_u32_u24 v15, 9216, v15
    v_lshlrev_b32 v16, 4, v16
    v_add_u32 v13, v15, v16

    s_mul_i32 s40, s36, 1327104
    s_mul_i32 s38, s34, 2304
    s_add_u32 s40, s40, s38
    s_add_u32 s40, s40, 13631488
    s_and_b32 s41, s24, 1
    s_mul_i32 s41, s41, 9216
    s_mov_b32 s49, 0

    s_lshl_b32 s38, s34, 2
    s_add_u32 s38, s38, s36
    s_mul_i32 s38, s38, 17408
    s_and_b32 s39, s37, 7
    s_mul_i32 s39, s39, 2176
    s_add_u32 s38, s38, s39
    s_add_u32 s38, s38, 31981568
    v_lshlrev_b32 v14, 7, v1
    s_mov_b64 exec, 0xffff

    s_mov_b32 s49, 0
    buffer_load_dword v140, v14, s[12:15], s38 offen sc1
L_m_pg:
    s_waitcnt vmcnt(0)
    v_cmp_eq_u32 vcc, s28, v140
    s_nop 0
    s_cmp_eq_u64 vcc, exec
    s_cbranch_scc1 L_m_pg_ok
    s_sleep 1
    buffer_load_dword v140, v14, s[12:15], s38 offen sc1
    s_add_u32 s49, s49, 1
    s_cmp_gt_u32 s49, 8000
    s_cbranch_scc0 L_m_pg

L_m_pg_ok:
    s_mov_b64 exec, -1
    s_add_u32 m0, s41, 0
    s_nop 0
    buffer_load_dwordx4 v5, s[12:15], s40 offen  lds
    s_add_u32 m0, s41, 1024
    s_nop 0
    buffer_load_dwordx4 v6, s[12:15], s40 offen  lds
    s_add_u32 m0, s41, 2048
    s_nop 0
    buffer_load_dwordx4 v7, s[12:15], s40 offen  lds
    s_add_u32 m0, s41, 3072
    s_nop 0
    buffer_load_dwordx4 v8, s[12:15], s40 offen  lds
    s_add_u32 m0, s41, 4096
    s_nop 0
    buffer_load_dwordx4 v9, s[12:15], s40 offen  lds
    s_add_u32 m0, s41, 5120
    s_nop 0
    buffer_load_dwordx4 v10, s[12:15], s40 offen  lds
    s_add_u32 m0, s41, 6144
    s_nop 0
    buffer_load_dwordx4 v11, s[12:15], s40 offen  lds
    s_add_u32 m0, s41, 7168
    s_nop 0
    buffer_load_dwordx4 v12, s[12:15], s40 offen  lds
    s_add_u32 m0, s41, 8192
    s_nop 0
    buffer_load_dwordx4 v13, s[12:15], s40 offen  lds
    s_add_u32 s40, s40, 73728
    s_add_u32 m0, s41, 34816
    s_nop 0
    buffer_load_dwordx4 v5, s[12:15], s40 offen  lds
    s_add_u32 m0, s41, 35840
    s_nop 0
    buffer_load_dwordx4 v6, s[12:15], s40 offen  lds
    s_add_u32 m0, s41, 36864
    s_nop 0
    buffer_load_dwordx4 v7, s[12:15], s40 offen  lds
    s_add_u32 m0, s41, 37888
    s_nop 0
    buffer_load_dwordx4 v8, s[12:15], s40 offen  lds
    s_add_u32 m0, s41, 38912
    s_nop 0
    buffer_load_dwordx4 v9, s[12:15], s40 offen  lds
    s_add_u32 m0, s41, 39936
    s_nop 0
    buffer_load_dwordx4 v10, s[12:15], s40 offen  lds
    s_add_u32 m0, s41, 40960
    s_nop 0
    buffer_load_dwordx4 v11, s[12:15], s40 offen  lds
    s_add_u32 m0, s41, 41984
    s_nop 0
    buffer_load_dwordx4 v12, s[12:15], s40 offen  lds
    s_add_u32 m0, s41, 43008
    s_nop 0
    buffer_load_dwordx4 v13, s[12:15], s40 offen  lds
    s_add_u32 s40, s40, 73728
    s_add_u32 m0, s41, 69632
    s_nop 0
    buffer_load_dwordx4 v5, s[12:15], s40 offen  lds
    s_add_u32 m0, s41, 70656
    s_nop 0
    buffer_load_dwordx4 v6, s[12:15], s40 offen  lds
    s_add_u32 m0, s41, 71680
    s_nop 0
    buffer_load_dwordx4 v7, s[12:15], s40 offen  lds
    s_add_u32 m0, s41, 72704
    s_nop 0
    buffer_load_dwordx4 v8, s[12:15], s40 offen  lds
    s_add_u32 m0, s41, 73728
    s_nop 0
    buffer_load_dwordx4 v9, s[12:15], s40 offen  lds
    s_add_u32 m0, s41, 74752
    s_nop 0
    buffer_load_dwordx4 v10, s[12:15], s40 offen  lds
    s_add_u32 m0, s41, 75776
    s_nop 0
    buffer_load_dwordx4 v11, s[12:15], s40 offen  lds
    s_add_u32 m0, s41, 76800
    s_nop 0
    buffer_load_dwordx4 v12, s[12:15], s40 offen  lds
    s_add_u32 m0, s41, 77824
    s_nop 0
    buffer_load_dwordx4 v13, s[12:15], s40 offen  lds
    s_add_u32 s40, s40, 73728
    s_add_u32 m0, s41, 104448
    s_nop 0
    buffer_load_dwordx4 v5, s[12:15], s40 offen  lds
    s_add_u32 m0, s41, 105472
    s_nop 0
    buffer_load_dwordx4 v6, s[12:15], s40 offen  lds
    s_add_u32 m0, s41, 106496
    s_nop 0
    buffer_load_dwordx4 v7, s[12:15], s40 offen  lds
    s_add_u32 m0, s41, 107520
    s_nop 0
    buffer_load_dwordx4 v8, s[12:15], s40 offen  lds
    s_add_u32 m0, s41, 108544
    s_nop 0
    buffer_load_dwordx4 v9, s[12:15], s40 offen  lds
    s_add_u32 m0, s41, 109568
    s_nop 0
    buffer_load_dwordx4 v10, s[12:15], s40 offen  lds
    s_add_u32 m0, s41, 110592
    s_nop 0
    buffer_load_dwordx4 v11, s[12:15], s40 offen  lds
    s_add_u32 m0, s41, 111616
    s_nop 0
    buffer_load_dwordx4 v12, s[12:15], s40 offen  lds
    s_add_u32 m0, s41, 112640
    s_nop 0
    buffer_load_dwordx4 v13, s[12:15], s40 offen  lds
    s_add_u32 s40, s40, 73728
    s_waitcnt vmcnt(27)
    s_barrier
    s_waitcnt vmcnt(18)
    s_barrier
    s_add_u32 m0, s41, 0
    s_nop 0
    buffer_load_dwordx4 v5, s[12:15], s40 offen  lds
    s_add_u32 m0, s41, 1024
    s_nop 0
    buffer_load_dwordx4 v6, s[12:15], s40 offen  lds
    s_add_u32 m0, s41, 2048
    s_nop 0
    buffer_load_dwordx4 v7, s[12:15], s40 offen  lds
    s_add_u32 m0, s41, 3072
    s_nop 0
    buffer_load_dwordx4 v8, s[12:15], s40 offen  lds
    s_add_u32 m0, s41, 4096
    s_nop 0
    buffer_load_dwordx4 v9, s[12:15], s40 offen  lds
    s_add_u32 m0, s41, 5120
    s_nop 0
    buffer_load_dwordx4 v10, s[12:15], s40 offen  lds
    s_add_u32 m0, s41, 6144
    s_nop 0
    buffer_load_dwordx4 v11, s[12:15], s40 offen  lds
    s_add_u32 m0, s41, 7168
    s_nop 0
    buffer_load_dwordx4 v12, s[12:15], s40 offen  lds
    s_add_u32 m0, s41, 8192
    s_nop 0
    buffer_load_dwordx4 v13, s[12:15], s40 offen  lds
    s_add_u32 s40, s40, 73728
    s_buffer_load_dwordx2 s[50:51], s[52:55], s42 offset:60
    s_buffer_load_dwordx2 s[50:51], s[52:55], s42 offset:32828
    s_buffer_load_dwordx2 s[50:51], s[52:55], s42 offset:65596
    s_buffer_load_dwordx2 s[50:51], s[52:55], s42 offset:98364
    s_waitcnt vmcnt(18)
    s_barrier
    s_add_u32 m0, s41, 34816
    s_nop 0
    buffer_load_dwordx4 v5, s[12:15], s40 offen  lds
    s_add_u32 m0, s41, 35840
    s_nop 0
    buffer_load_dwordx4 v6, s[12:15], s40 offen  lds
    s_add_u32 m0, s41, 36864
    s_nop 0
    buffer_load_dwordx4 v7, s[12:15], s40 offen  lds
    s_add_u32 m0, s41, 37888
    s_nop 0
    buffer_load_dwordx4 v8, s[12:15], s40 offen  lds
    s_add_u32 m0, s41, 38912
    s_nop 0
    buffer_load_dwordx4 v9, s[12:15], s40 offen  lds
    s_add_u32 m0, s41, 39936
    s_nop 0
    buffer_load_dwordx4 v10, s[12:15], s40 offen  lds
    s_add_u32 m0, s41, 40960
    s_nop 0
    buffer_load_dwordx4 v11, s[12:15], s40 offen  lds
    s_add_u32 m0, s41, 41984
    s_nop 0
    buffer_load_dwordx4 v12, s[12:15], s40 offen  lds
    s_add_u32 m0, s41, 43008
    s_nop 0
    buffer_load_dwordx4 v13, s[12:15], s40 offen  lds
    s_add_u32 s40, s40, 73728
    s_buffer_load_dwordx2 s[50:51], s[52:55], s42 offset:131132
    s_buffer_load_dwordx2 s[50:51], s[52:55], s42 offset:163900
    s_buffer_load_dwordx2 s[50:51], s[52:55], s42 offset:196668
    s_buffer_load_dwordx2 s[50:51], s[52:55], s42 offset:229436
    s_waitcnt vmcnt(18)
    s_barrier
    s_add_u32 m0, s41, 69632
    s_nop 0
    buffer_load_dwordx4 v5, s[12:15], s40 offen  lds
    s_add_u32 m0, s41, 70656
    s_nop 0
    buffer_load_dwordx4 v6, s[12:15], s40 offen  lds
    s_add_u32 m0, s41, 71680
    s_nop 0
    buffer_load_dwordx4 v7, s[12:15], s40 offen  lds
    s_add_u32 m0, s41, 72704
    s_nop 0
    buffer_load_dwordx4 v8, s[12:15], s40 offen  lds
    s_add_u32 m0, s41, 73728
    s_nop 0
    buffer_load_dwordx4 v9, s[12:15], s40 offen  lds
    s_add_u32 m0, s41, 74752
    s_nop 0
    buffer_load_dwordx4 v10, s[12:15], s40 offen  lds
    s_add_u32 m0, s41, 75776
    s_nop 0
    buffer_load_dwordx4 v11, s[12:15], s40 offen  lds
    s_add_u32 m0, s41, 76800
    s_nop 0
    buffer_load_dwordx4 v12, s[12:15], s40 offen  lds
    s_add_u32 m0, s41, 77824
    s_nop 0
    buffer_load_dwordx4 v13, s[12:15], s40 offen  lds
    s_add_u32 s40, s40, 73728
    s_buffer_load_dwordx2 s[50:51], s[52:55], s42 offset:262204
    s_buffer_load_dwordx2 s[50:51], s[52:55], s42 offset:294972
    s_buffer_load_dwordx2 s[50:51], s[52:55], s42 offset:327740
    s_buffer_load_dwordx2 s[50:51], s[52:55], s42 offset:360508
    s_waitcnt vmcnt(18)
    s_barrier
    s_add_u32 m0, s41, 104448
    s_nop 0
    buffer_load_dwordx4 v5, s[12:15], s40 offen  lds
    s_add_u32 m0, s41, 105472
    s_nop 0
    buffer_load_dwordx4 v6, s[12:15], s40 offen  lds
    s_add_u32 m0, s41, 106496
    s_nop 0
    buffer_load_dwordx4 v7, s[12:15], s40 offen  lds
    s_add_u32 m0, s41, 107520
    s_nop 0
    buffer_load_dwordx4 v8, s[12:15], s40 offen  lds
    s_add_u32 m0, s41, 108544
    s_nop 0
    buffer_load_dwordx4 v9, s[12:15], s40 offen  lds
    s_add_u32 m0, s41, 109568
    s_nop 0
    buffer_load_dwordx4 v10, s[12:15], s40 offen  lds
    s_add_u32 m0, s41, 110592
    s_nop 0
    buffer_load_dwordx4 v11, s[12:15], s40 offen  lds
    s_add_u32 m0, s41, 111616
    s_nop 0
    buffer_load_dwordx4 v12, s[12:15], s40 offen  lds
    s_add_u32 m0, s41, 112640
    s_nop 0
    buffer_load_dwordx4 v13, s[12:15], s40 offen  lds
    s_add_u32 s40, s40, 73728
    s_buffer_load_dwordx2 s[50:51], s[52:55], s42 offset:393276
    s_buffer_load_dwordx2 s[50:51], s[52:55], s42 offset:426044
    s_buffer_load_dwordx2 s[50:51], s[52:55], s42 offset:458812
    s_buffer_load_dwordx2 s[50:51], s[52:55], s42 offset:491580
    s_waitcnt vmcnt(18)
    s_barrier
    s_add_u32 m0, s41, 0
    s_nop 0
    buffer_load_dwordx4 v5, s[12:15], s40 offen  lds
    s_add_u32 m0, s41, 1024
    s_nop 0
    buffer_load_dwordx4 v6, s[12:15], s40 offen  lds
    s_add_u32 m0, s41, 2048
    s_nop 0
    buffer_load_dwordx4 v7, s[12:15], s40 offen  lds
    s_add_u32 m0, s41, 3072
    s_nop 0
    buffer_load_dwordx4 v8, s[12:15], s40 offen  lds
    s_add_u32 m0, s41, 4096
    s_nop 0
    buffer_load_dwordx4 v9, s[12:15], s40 offen  lds
    s_add_u32 m0, s41, 5120
    s_nop 0
    buffer_load_dwordx4 v10, s[12:15], s40 offen  lds
    s_add_u32 m0, s41, 6144
    s_nop 0
    buffer_load_dwordx4 v11, s[12:15], s40 offen  lds
    s_add_u32 m0, s41, 7168
    s_nop 0
    buffer_load_dwordx4 v12, s[12:15], s40 offen  lds
    s_add_u32 m0, s41, 8192
    s_nop 0
    buffer_load_dwordx4 v13, s[12:15], s40 offen  lds
    s_add_u32 s40, s40, 73728
    s_buffer_load_dwordx2 s[50:51], s[52:55], s42 offset:524348
    s_buffer_load_dwordx2 s[50:51], s[52:55], s42 offset:557116
    s_buffer_load_dwordx2 s[50:51], s[52:55], s42 offset:589884
    s_buffer_load_dwordx2 s[50:51], s[52:55], s42 offset:622652
    s_waitcnt vmcnt(18)
    s_barrier
    s_add_u32 m0, s41, 34816
    s_nop 0
    buffer_load_dwordx4 v5, s[12:15], s40 offen  lds
    s_add_u32 m0, s41, 35840
    s_nop 0
    buffer_load_dwordx4 v6, s[12:15], s40 offen  lds
    s_add_u32 m0, s41, 36864
    s_nop 0
    buffer_load_dwordx4 v7, s[12:15], s40 offen  lds
    s_add_u32 m0, s41, 37888
    s_nop 0
    buffer_load_dwordx4 v8, s[12:15], s40 offen  lds
    s_add_u32 m0, s41, 38912
    s_nop 0
    buffer_load_dwordx4 v9, s[12:15], s40 offen  lds
    s_add_u32 m0, s41, 39936
    s_nop 0
    buffer_load_dwordx4 v10, s[12:15], s40 offen  lds
    s_add_u32 m0, s41, 40960
    s_nop 0
    buffer_load_dwordx4 v11, s[12:15], s40 offen  lds
    s_add_u32 m0, s41, 41984
    s_nop 0
    buffer_load_dwordx4 v12, s[12:15], s40 offen  lds
    s_add_u32 m0, s41, 43008
    s_nop 0
    buffer_load_dwordx4 v13, s[12:15], s40 offen  lds
    s_add_u32 s40, s40, 73728
    s_buffer_load_dwordx2 s[50:51], s[52:55], s42 offset:655420
    s_buffer_load_dwordx2 s[50:51], s[52:55], s42 offset:688188
    s_buffer_load_dwordx2 s[50:51], s[52:55], s42 offset:720956
    s_buffer_load_dwordx2 s[50:51], s[52:55], s42 offset:753724
    s_waitcnt vmcnt(18)
    s_barrier
    s_add_u32 m0, s41, 69632
    s_nop 0
    buffer_load_dwordx4 v5, s[12:15], s40 offen  lds
    s_add_u32 m0, s41, 70656
    s_nop 0
    buffer_load_dwordx4 v6, s[12:15], s40 offen  lds
    s_add_u32 m0, s41, 71680
    s_nop 0
    buffer_load_dwordx4 v7, s[12:15], s40 offen  lds
    s_add_u32 m0, s41, 72704
    s_nop 0
    buffer_load_dwordx4 v8, s[12:15], s40 offen  lds
    s_add_u32 m0, s41, 73728
    s_nop 0
    buffer_load_dwordx4 v9, s[12:15], s40 offen  lds
    s_add_u32 m0, s41, 74752
    s_nop 0
    buffer_load_dwordx4 v10, s[12:15], s40 offen  lds
    s_add_u32 m0, s41, 75776
    s_nop 0
    buffer_load_dwordx4 v11, s[12:15], s40 offen  lds
    s_add_u32 m0, s41, 76800
    s_nop 0
    buffer_load_dwordx4 v12, s[12:15], s40 offen  lds
    s_add_u32 m0, s41, 77824
    s_nop 0
    buffer_load_dwordx4 v13, s[12:15], s40 offen  lds
    s_add_u32 s40, s40, 73728
    s_buffer_load_dwordx2 s[50:51], s[52:55], s42 offset:786492
    s_buffer_load_dwordx2 s[50:51], s[52:55], s42 offset:819260
    s_buffer_load_dwordx2 s[50:51], s[52:55], s42 offset:852028
    s_buffer_load_dwordx2 s[50:51], s[52:55], s42 offset:884796
    s_waitcnt vmcnt(18)
    s_barrier
    s_add_u32 m0, s41, 104448
    s_nop 0
    buffer_load_dwordx4 v5, s[12:15], s40 offen  lds
    s_add_u32 m0, s41, 105472
    s_nop 0
    buffer_load_dwordx4 v6, s[12:15], s40 offen  lds
    s_add_u32 m0, s41, 106496
    s_nop 0
    buffer_load_dwordx4 v7, s[12:15], s40 offen  lds
    s_add_u32 m0, s41, 107520
    s_nop 0
    buffer_load_dwordx4 v8, s[12:15], s40 offen  lds
    s_add_u32 m0, s41, 108544
    s_nop 0
    buffer_load_dwordx4 v9, s[12:15], s40 offen  lds
    s_add_u32 m0, s41, 109568
    s_nop 0
    buffer_load_dwordx4 v10, s[12:15], s40 offen  lds
    s_add_u32 m0, s41, 110592
    s_nop 0
    buffer_load_dwordx4 v11, s[12:15], s40 offen  lds
    s_add_u32 m0, s41, 111616
    s_nop 0
    buffer_load_dwordx4 v12, s[12:15], s40 offen  lds
    s_add_u32 m0, s41, 112640
    s_nop 0
    buffer_load_dwordx4 v13, s[12:15], s40 offen  lds
    s_add_u32 s40, s40, 73728
    s_buffer_load_dwordx2 s[50:51], s[52:55], s42 offset:917564
    s_buffer_load_dwordx2 s[50:51], s[52:55], s42 offset:950332
    s_buffer_load_dwordx2 s[50:51], s[52:55], s42 offset:983100
    s_buffer_load_dwordx2 s[50:51], s[52:55], s42 offset:1015868
    s_waitcnt vmcnt(18)
    s_barrier
    s_add_u32 m0, s41, 0
    s_nop 0
    buffer_load_dwordx4 v5, s[12:15], s40 offen  lds
    s_add_u32 m0, s41, 1024
    s_nop 0
    buffer_load_dwordx4 v6, s[12:15], s40 offen  lds
    s_add_u32 m0, s41, 2048
    s_nop 0
    buffer_load_dwordx4 v7, s[12:15], s40 offen  lds
    s_add_u32 m0, s41, 3072
    s_nop 0
    buffer_load_dwordx4 v8, s[12:15], s40 offen  lds
    s_add_u32 m0, s41, 4096
    s_nop 0
    buffer_load_dwordx4 v9, s[12:15], s40 offen  lds
    s_add_u32 m0, s41, 5120
    s_nop 0
    buffer_load_dwordx4 v10, s[12:15], s40 offen  lds
    s_add_u32 m0, s41, 6144
    s_nop 0
    buffer_load_dwordx4 v11, s[12:15], s40 offen  lds
    s_add_u32 m0, s41, 7168
    s_nop 0
    buffer_load_dwordx4 v12, s[12:15], s40 offen  lds
    s_add_u32 m0, s41, 8192
    s_nop 0
    buffer_load_dwordx4 v13, s[12:15], s40 offen  lds
    s_add_u32 s40, s40, 73728
    s_add_u32 s42, s42, 1048576
    s_buffer_load_dwordx2 s[50:51], s[52:55], s42 offset:60
    s_buffer_load_dwordx2 s[50:51], s[52:55], s42 offset:32828
    s_buffer_load_dwordx2 s[50:51], s[52:55], s42 offset:65596
    s_buffer_load_dwordx2 s[50:51], s[52:55], s42 offset:98364
    s_waitcnt vmcnt(18)
    s_barrier
    s_add_u32 m0, s41, 34816
    s_nop 0
    buffer_load_dwordx4 v5, s[12:15], s40 offen  lds
    s_add_u32 m0, s41, 35840
    s_nop 0
    buffer_load_dwordx4 v6, s[12:15], s40 offen  lds
    s_add_u32 m0, s41, 36864
    s_nop 0
    buffer_load_dwordx4 v7, s[12:15], s40 offen  lds
    s_add_u32 m0, s41, 37888
    s_nop 0
    buffer_load_dwordx4 v8, s[12:15], s40 offen  lds
    s_add_u32 m0, s41, 38912
    s_nop 0
    buffer_load_dwordx4 v9, s[12:15], s40 offen  lds
    s_add_u32 m0, s41, 39936
    s_nop 0
    buffer_load_dwordx4 v10, s[12:15], s40 offen  lds
    s_add_u32 m0, s41, 40960
    s_nop 0
    buffer_load_dwordx4 v11, s[12:15], s40 offen  lds
    s_add_u32 m0, s41, 41984
    s_nop 0
    buffer_load_dwordx4 v12, s[12:15], s40 offen  lds
    s_add_u32 m0, s41, 43008
    s_nop 0
    buffer_load_dwordx4 v13, s[12:15], s40 offen  lds
    s_add_u32 s40, s40, 73728
    s_buffer_load_dwordx2 s[50:51], s[52:55], s42 offset:131132
    s_buffer_load_dwordx2 s[50:51], s[52:55], s42 offset:163900
    s_buffer_load_dwordx2 s[50:51], s[52:55], s42 offset:196668
    s_buffer_load_dwordx2 s[50:51], s[52:55], s42 offset:229436
    s_waitcnt vmcnt(18)
    s_barrier
    s_add_u32 m0, s41, 69632
    s_nop 0
    buffer_load_dwordx4 v5, s[12:15], s40 offen  lds
    s_add_u32 m0, s41, 70656
    s_nop 0
    buffer_load_dwordx4 v6, s[12:15], s40 offen  lds
    s_add_u32 m0, s41, 71680
    s_nop 0
    buffer_load_dwordx4 v7, s[12:15], s40 offen  lds
    s_add_u32 m0, s41, 72704
    s_nop 0
    buffer_load_dwordx4 v8, s[12:15], s40 offen  lds
    s_add_u32 m0, s41, 73728
    s_nop 0
    buffer_load_dwordx4 v9, s[12:15], s40 offen  lds
    s_add_u32 m0, s41, 74752
    s_nop 0
    buffer_load_dwordx4 v10, s[12:15], s40 offen  lds
    s_add_u32 m0, s41, 75776
    s_nop 0
    buffer_load_dwordx4 v11, s[12:15], s40 offen  lds
    s_add_u32 m0, s41, 76800
    s_nop 0
    buffer_load_dwordx4 v12, s[12:15], s40 offen  lds
    s_add_u32 m0, s41, 77824
    s_nop 0
    buffer_load_dwordx4 v13, s[12:15], s40 offen  lds
    s_add_u32 s40, s40, 73728
    s_buffer_load_dwordx2 s[50:51], s[52:55], s42 offset:262204
    s_buffer_load_dwordx2 s[50:51], s[52:55], s42 offset:294972
    s_buffer_load_dwordx2 s[50:51], s[52:55], s42 offset:327740
    s_buffer_load_dwordx2 s[50:51], s[52:55], s42 offset:360508
    s_waitcnt vmcnt(18)
    s_barrier
    s_add_u32 m0, s41, 104448
    s_nop 0
    buffer_load_dwordx4 v5, s[12:15], s40 offen  lds
    s_add_u32 m0, s41, 105472
    s_nop 0
    buffer_load_dwordx4 v6, s[12:15], s40 offen  lds
    s_add_u32 m0, s41, 106496
    s_nop 0
    buffer_load_dwordx4 v7, s[12:15], s40 offen  lds
    s_add_u32 m0, s41, 107520
    s_nop 0
    buffer_load_dwordx4 v8, s[12:15], s40 offen  lds
    s_add_u32 m0, s41, 108544
    s_nop 0
    buffer_load_dwordx4 v9, s[12:15], s40 offen  lds
    s_add_u32 m0, s41, 109568
    s_nop 0
    buffer_load_dwordx4 v10, s[12:15], s40 offen  lds
    s_add_u32 m0, s41, 110592
    s_nop 0
    buffer_load_dwordx4 v11, s[12:15], s40 offen  lds
    s_add_u32 m0, s41, 111616
    s_nop 0
    buffer_load_dwordx4 v12, s[12:15], s40 offen  lds
    s_add_u32 m0, s41, 112640
    s_nop 0
    buffer_load_dwordx4 v13, s[12:15], s40 offen  lds
    s_add_u32 s40, s40, 73728
    s_buffer_load_dwordx2 s[50:51], s[52:55], s42 offset:393276
    s_buffer_load_dwordx2 s[50:51], s[52:55], s42 offset:426044
    s_buffer_load_dwordx2 s[50:51], s[52:55], s42 offset:458812
    s_buffer_load_dwordx2 s[50:51], s[52:55], s42 offset:491580
    s_waitcnt vmcnt(18)
    s_barrier
    s_add_u32 m0, s41, 0
    s_nop 0
    buffer_load_dwordx4 v5, s[12:15], s40 offen  lds
    s_add_u32 m0, s41, 1024
    s_nop 0
    buffer_load_dwordx4 v6, s[12:15], s40 offen  lds
    s_add_u32 m0, s41, 2048
    s_nop 0
    buffer_load_dwordx4 v7, s[12:15], s40 offen  lds
    s_add_u32 m0, s41, 3072
    s_nop 0
    buffer_load_dwordx4 v8, s[12:15], s40 offen  lds
    s_add_u32 m0, s41, 4096
    s_nop 0
    buffer_load_dwordx4 v9, s[12:15], s40 offen  lds
    s_add_u32 m0, s41, 5120
    s_nop 0
    buffer_load_dwordx4 v10, s[12:15], s40 offen  lds
    s_add_u32 m0, s41, 6144
    s_nop 0
    buffer_load_dwordx4 v11, s[12:15], s40 offen  lds
    s_add_u32 m0, s41, 7168
    s_nop 0
    buffer_load_dwordx4 v12, s[12:15], s40 offen  lds
    s_add_u32 m0, s41, 8192
    s_nop 0
    buffer_load_dwordx4 v13, s[12:15], s40 offen  lds
    s_add_u32 s40, s40, 73728
    s_waitcnt vmcnt(18)
    s_barrier
    s_add_u32 m0, s41, 34816
    s_nop 0
    buffer_load_dwordx4 v5, s[12:15], s40 offen  lds
    s_add_u32 m0, s41, 35840
    s_nop 0
    buffer_load_dwordx4 v6, s[12:15], s40 offen  lds
    s_add_u32 m0, s41, 36864
    s_nop 0
    buffer_load_dwordx4 v7, s[12:15], s40 offen  lds
    s_add_u32 m0, s41, 37888
    s_nop 0
    buffer_load_dwordx4 v8, s[12:15], s40 offen  lds
    s_add_u32 m0, s41, 38912
    s_nop 0
    buffer_load_dwordx4 v9, s[12:15], s40 offen  lds
    s_add_u32 m0, s41, 39936
    s_nop 0
    buffer_load_dwordx4 v10, s[12:15], s40 offen  lds
    s_add_u32 m0, s41, 40960
    s_nop 0
    buffer_load_dwordx4 v11, s[12:15], s40 offen  lds
    s_add_u32 m0, s41, 41984
    s_nop 0
    buffer_load_dwordx4 v12, s[12:15], s40 offen  lds
    s_add_u32 m0, s41, 43008
    s_nop 0
    buffer_load_dwordx4 v13, s[12:15], s40 offen  lds
    s_add_u32 s40, s40, 73728
    s_waitcnt vmcnt(18)
    s_barrier
    s_waitcnt vmcnt(9)
    s_barrier
    s_waitcnt vmcnt(0)
    s_barrier
    s_waitcnt vmcnt(0)
    s_barrier
    s_branch L_m_l2_done
L_m_oload2:
    s_mov_b32 s16, s8
    s_and_b32 s17, s9, 0xffff
    s_mov_b32 s18, 18874368
    s_mov_b32 s19, 0x00020000
    s_and_b32 s38, s24, 1
    s_lshl_b32 s38, s38, 5
    v_add_u32 v14, s38, v2
    v_lshrrev_b32 v15, 1, v1
    v_and_b32 v16, 1, v1
    v_lshlrev_b32 v16, 4, v16

    v_add_u32 v17, 0, v14
    v_and_b32 v18, 7, v17
    v_xor_b32 v18, v18, v15
    v_lshlrev_b32 v18, 5, v18
    v_add_u32 v18, v18, v16
    v_lshlrev_b32 v17, 12, v17
    v_add_u32 v5, v17, v18

    v_add_u32 v17, 4, v14
    v_and_b32 v18, 7, v17
    v_xor_b32 v18, v18, v15
    v_lshlrev_b32 v18, 5, v18
    v_add_u32 v18, v18, v16
    v_lshlrev_b32 v17, 12, v17
    v_add_u32 v6, v17, v18

    v_add_u32 v17, 8, v14
    v_and_b32 v18, 7, v17
    v_xor_b32 v18, v18, v15
    v_lshlrev_b32 v18, 5, v18
    v_add_u32 v18, v18, v16
    v_lshlrev_b32 v17, 12, v17
    v_add_u32 v7, v17, v18

    v_add_u32 v17, 12, v14
    v_and_b32 v18, 7, v17
    v_xor_b32 v18, v18, v15
    v_lshlrev_b32 v18, 5, v18
    v_add_u32 v18, v18, v16
    v_lshlrev_b32 v17, 12, v17
    v_add_u32 v8, v17, v18

    v_add_u32 v17, 16, v14
    v_and_b32 v18, 7, v17
    v_xor_b32 v18, v18, v15
    v_lshlrev_b32 v18, 5, v18
    v_add_u32 v18, v18, v16
    v_lshlrev_b32 v17, 12, v17
    v_add_u32 v9, v17, v18

    v_add_u32 v17, 20, v14
    v_and_b32 v18, 7, v17
    v_xor_b32 v18, v18, v15
    v_lshlrev_b32 v18, 5, v18
    v_add_u32 v18, v18, v16
    v_lshlrev_b32 v17, 12, v17
    v_add_u32 v10, v17, v18

    v_add_u32 v17, 24, v14
    v_and_b32 v18, 7, v17
    v_xor_b32 v18, v18, v15
    v_lshlrev_b32 v18, 5, v18
    v_add_u32 v18, v18, v16
    v_lshlrev_b32 v17, 12, v17
    v_add_u32 v11, v17, v18

    v_add_u32 v17, 28, v14
    v_and_b32 v18, 7, v17
    v_xor_b32 v18, v18, v15
    v_lshlrev_b32 v18, 5, v18
    v_add_u32 v18, v18, v16
    v_lshlrev_b32 v17, 12, v17
    v_add_u32 v12, v17, v18

    s_mul_i32 s40, s36, 4718592
    s_lshl_b32 s38, s37, 8
    s_add_u32 s40, s40, s38
    s_add_u32 s40, s40, 0
    s_and_b32 s41, s24, 1
    s_lshl_b32 s41, s41, 13
    s_add_u32 s41, s41, 18432

    s_add_u32 m0, s41, 0
    s_nop 0
    buffer_load_dwordx4 v5, s[16:19], s40 offen  lds
    s_add_u32 m0, s41, 1024
    s_nop 0
    buffer_load_dwordx4 v6, s[16:19], s40 offen  lds
    s_add_u32 m0, s41, 2048
    s_nop 0
    buffer_load_dwordx4 v7, s[16:19], s40 offen  lds
    s_add_u32 m0, s41, 3072
    s_nop 0
    buffer_load_dwordx4 v8, s[16:19], s40 offen  lds
    s_add_u32 m0, s41, 4096
    s_nop 0
    buffer_load_dwordx4 v9, s[16:19], s40 offen  lds
    s_add_u32 m0, s41, 5120
    s_nop 0
    buffer_load_dwordx4 v10, s[16:19], s40 offen  lds
    s_add_u32 m0, s41, 6144
    s_nop 0
    buffer_load_dwordx4 v11, s[16:19], s40 offen  lds
    s_add_u32 m0, s41, 7168
    s_nop 0
    buffer_load_dwordx4 v12, s[16:19], s40 offen  lds
    s_add_u32 s40, s40, 262144
    s_add_u32 m0, s41, 34816
    s_nop 0
    buffer_load_dwordx4 v5, s[16:19], s40 offen  lds
    s_add_u32 m0, s41, 35840
    s_nop 0
    buffer_load_dwordx4 v6, s[16:19], s40 offen  lds
    s_add_u32 m0, s41, 36864
    s_nop 0
    buffer_load_dwordx4 v7, s[16:19], s40 offen  lds
    s_add_u32 m0, s41, 37888
    s_nop 0
    buffer_load_dwordx4 v8, s[16:19], s40 offen  lds
    s_add_u32 m0, s41, 38912
    s_nop 0
    buffer_load_dwordx4 v9, s[16:19], s40 offen  lds
    s_add_u32 m0, s41, 39936
    s_nop 0
    buffer_load_dwordx4 v10, s[16:19], s40 offen  lds
    s_add_u32 m0, s41, 40960
    s_nop 0
    buffer_load_dwordx4 v11, s[16:19], s40 offen  lds
    s_add_u32 m0, s41, 41984
    s_nop 0
    buffer_load_dwordx4 v12, s[16:19], s40 offen  lds
    s_add_u32 s40, s40, 262144
    s_add_u32 m0, s41, 69632
    s_nop 0
    buffer_load_dwordx4 v5, s[16:19], s40 offen  lds
    s_add_u32 m0, s41, 70656
    s_nop 0
    buffer_load_dwordx4 v6, s[16:19], s40 offen  lds
    s_add_u32 m0, s41, 71680
    s_nop 0
    buffer_load_dwordx4 v7, s[16:19], s40 offen  lds
    s_add_u32 m0, s41, 72704
    s_nop 0
    buffer_load_dwordx4 v8, s[16:19], s40 offen  lds
    s_add_u32 m0, s41, 73728
    s_nop 0
    buffer_load_dwordx4 v9, s[16:19], s40 offen  lds
    s_add_u32 m0, s41, 74752
    s_nop 0
    buffer_load_dwordx4 v10, s[16:19], s40 offen  lds
    s_add_u32 m0, s41, 75776
    s_nop 0
    buffer_load_dwordx4 v11, s[16:19], s40 offen  lds
    s_add_u32 m0, s41, 76800
    s_nop 0
    buffer_load_dwordx4 v12, s[16:19], s40 offen  lds
    s_add_u32 s40, s40, 262144
    s_add_u32 m0, s41, 104448
    s_nop 0
    buffer_load_dwordx4 v5, s[16:19], s40 offen  lds
    s_add_u32 m0, s41, 105472
    s_nop 0
    buffer_load_dwordx4 v6, s[16:19], s40 offen  lds
    s_add_u32 m0, s41, 106496
    s_nop 0
    buffer_load_dwordx4 v7, s[16:19], s40 offen  lds
    s_add_u32 m0, s41, 107520
    s_nop 0
    buffer_load_dwordx4 v8, s[16:19], s40 offen  lds
    s_add_u32 m0, s41, 108544
    s_nop 0
    buffer_load_dwordx4 v9, s[16:19], s40 offen  lds
    s_add_u32 m0, s41, 109568
    s_nop 0
    buffer_load_dwordx4 v10, s[16:19], s40 offen  lds
    s_add_u32 m0, s41, 110592
    s_nop 0
    buffer_load_dwordx4 v11, s[16:19], s40 offen  lds
    s_add_u32 m0, s41, 111616
    s_nop 0
    buffer_load_dwordx4 v12, s[16:19], s40 offen  lds
    s_add_u32 s40, s40, 262144
    s_waitcnt vmcnt(24)
    s_barrier
    s_waitcnt vmcnt(16)
    s_barrier
    s_add_u32 m0, s41, 0
    s_nop 0
    buffer_load_dwordx4 v5, s[16:19], s40 offen  lds
    s_add_u32 m0, s41, 1024
    s_nop 0
    buffer_load_dwordx4 v6, s[16:19], s40 offen  lds
    s_add_u32 m0, s41, 2048
    s_nop 0
    buffer_load_dwordx4 v7, s[16:19], s40 offen  lds
    s_add_u32 m0, s41, 3072
    s_nop 0
    buffer_load_dwordx4 v8, s[16:19], s40 offen  lds
    s_add_u32 m0, s41, 4096
    s_nop 0
    buffer_load_dwordx4 v9, s[16:19], s40 offen  lds
    s_add_u32 m0, s41, 5120
    s_nop 0
    buffer_load_dwordx4 v10, s[16:19], s40 offen  lds
    s_add_u32 m0, s41, 6144
    s_nop 0
    buffer_load_dwordx4 v11, s[16:19], s40 offen  lds
    s_add_u32 m0, s41, 7168
    s_nop 0
    buffer_load_dwordx4 v12, s[16:19], s40 offen  lds
    s_add_u32 s40, s40, 262144
    s_buffer_load_dwordx2 s[50:51], s[52:55], s42 offset:60
    s_buffer_load_dwordx2 s[50:51], s[52:55], s42 offset:32828
    s_buffer_load_dwordx2 s[50:51], s[52:55], s42 offset:65596
    s_buffer_load_dwordx2 s[50:51], s[52:55], s42 offset:98364
    s_waitcnt vmcnt(16)
    s_barrier
    s_add_u32 m0, s41, 34816
    s_nop 0
    buffer_load_dwordx4 v5, s[16:19], s40 offen  lds
    s_add_u32 m0, s41, 35840
    s_nop 0
    buffer_load_dwordx4 v6, s[16:19], s40 offen  lds
    s_add_u32 m0, s41, 36864
    s_nop 0
    buffer_load_dwordx4 v7, s[16:19], s40 offen  lds
    s_add_u32 m0, s41, 37888
    s_nop 0
    buffer_load_dwordx4 v8, s[16:19], s40 offen  lds
    s_add_u32 m0, s41, 38912
    s_nop 0
    buffer_load_dwordx4 v9, s[16:19], s40 offen  lds
    s_add_u32 m0, s41, 39936
    s_nop 0
    buffer_load_dwordx4 v10, s[16:19], s40 offen  lds
    s_add_u32 m0, s41, 40960
    s_nop 0
    buffer_load_dwordx4 v11, s[16:19], s40 offen  lds
    s_add_u32 m0, s41, 41984
    s_nop 0
    buffer_load_dwordx4 v12, s[16:19], s40 offen  lds
    s_add_u32 s40, s40, 262144
    s_buffer_load_dwordx2 s[50:51], s[52:55], s42 offset:131132
    s_buffer_load_dwordx2 s[50:51], s[52:55], s42 offset:163900
    s_buffer_load_dwordx2 s[50:51], s[52:55], s42 offset:196668
    s_buffer_load_dwordx2 s[50:51], s[52:55], s42 offset:229436
    s_waitcnt vmcnt(16)
    s_barrier
    s_add_u32 m0, s41, 69632
    s_nop 0
    buffer_load_dwordx4 v5, s[16:19], s40 offen  lds
    s_add_u32 m0, s41, 70656
    s_nop 0
    buffer_load_dwordx4 v6, s[16:19], s40 offen  lds
    s_add_u32 m0, s41, 71680
    s_nop 0
    buffer_load_dwordx4 v7, s[16:19], s40 offen  lds
    s_add_u32 m0, s41, 72704
    s_nop 0
    buffer_load_dwordx4 v8, s[16:19], s40 offen  lds
    s_add_u32 m0, s41, 73728
    s_nop 0
    buffer_load_dwordx4 v9, s[16:19], s40 offen  lds
    s_add_u32 m0, s41, 74752
    s_nop 0
    buffer_load_dwordx4 v10, s[16:19], s40 offen  lds
    s_add_u32 m0, s41, 75776
    s_nop 0
    buffer_load_dwordx4 v11, s[16:19], s40 offen  lds
    s_add_u32 m0, s41, 76800
    s_nop 0
    buffer_load_dwordx4 v12, s[16:19], s40 offen  lds
    s_add_u32 s40, s40, 262144
    s_buffer_load_dwordx2 s[50:51], s[52:55], s42 offset:262204
    s_buffer_load_dwordx2 s[50:51], s[52:55], s42 offset:294972
    s_buffer_load_dwordx2 s[50:51], s[52:55], s42 offset:327740
    s_buffer_load_dwordx2 s[50:51], s[52:55], s42 offset:360508
    s_waitcnt vmcnt(16)
    s_barrier
    s_add_u32 m0, s41, 104448
    s_nop 0
    buffer_load_dwordx4 v5, s[16:19], s40 offen  lds
    s_add_u32 m0, s41, 105472
    s_nop 0
    buffer_load_dwordx4 v6, s[16:19], s40 offen  lds
    s_add_u32 m0, s41, 106496
    s_nop 0
    buffer_load_dwordx4 v7, s[16:19], s40 offen  lds
    s_add_u32 m0, s41, 107520
    s_nop 0
    buffer_load_dwordx4 v8, s[16:19], s40 offen  lds
    s_add_u32 m0, s41, 108544
    s_nop 0
    buffer_load_dwordx4 v9, s[16:19], s40 offen  lds
    s_add_u32 m0, s41, 109568
    s_nop 0
    buffer_load_dwordx4 v10, s[16:19], s40 offen  lds
    s_add_u32 m0, s41, 110592
    s_nop 0
    buffer_load_dwordx4 v11, s[16:19], s40 offen  lds
    s_add_u32 m0, s41, 111616
    s_nop 0
    buffer_load_dwordx4 v12, s[16:19], s40 offen  lds
    s_add_u32 s40, s40, 262144
    s_buffer_load_dwordx2 s[50:51], s[52:55], s42 offset:393276
    s_buffer_load_dwordx2 s[50:51], s[52:55], s42 offset:426044
    s_buffer_load_dwordx2 s[50:51], s[52:55], s42 offset:458812
    s_buffer_load_dwordx2 s[50:51], s[52:55], s42 offset:491580
    s_waitcnt vmcnt(16)
    s_barrier
    s_add_u32 m0, s41, 0
    s_nop 0
    buffer_load_dwordx4 v5, s[16:19], s40 offen  lds
    s_add_u32 m0, s41, 1024
    s_nop 0
    buffer_load_dwordx4 v6, s[16:19], s40 offen  lds
    s_add_u32 m0, s41, 2048
    s_nop 0
    buffer_load_dwordx4 v7, s[16:19], s40 offen  lds
    s_add_u32 m0, s41, 3072
    s_nop 0
    buffer_load_dwordx4 v8, s[16:19], s40 offen  lds
    s_add_u32 m0, s41, 4096
    s_nop 0
    buffer_load_dwordx4 v9, s[16:19], s40 offen  lds
    s_add_u32 m0, s41, 5120
    s_nop 0
    buffer_load_dwordx4 v10, s[16:19], s40 offen  lds
    s_add_u32 m0, s41, 6144
    s_nop 0
    buffer_load_dwordx4 v11, s[16:19], s40 offen  lds
    s_add_u32 m0, s41, 7168
    s_nop 0
    buffer_load_dwordx4 v12, s[16:19], s40 offen  lds
    s_add_u32 s40, s40, 262144
    s_buffer_load_dwordx2 s[50:51], s[52:55], s42 offset:524348
    s_buffer_load_dwordx2 s[50:51], s[52:55], s42 offset:557116
    s_buffer_load_dwordx2 s[50:51], s[52:55], s42 offset:589884
    s_buffer_load_dwordx2 s[50:51], s[52:55], s42 offset:622652
    s_waitcnt vmcnt(16)
    s_barrier
    s_add_u32 m0, s41, 34816
    s_nop 0
    buffer_load_dwordx4 v5, s[16:19], s40 offen  lds
    s_add_u32 m0, s41, 35840
    s_nop 0
    buffer_load_dwordx4 v6, s[16:19], s40 offen  lds
    s_add_u32 m0, s41, 36864
    s_nop 0
    buffer_load_dwordx4 v7, s[16:19], s40 offen  lds
    s_add_u32 m0, s41, 37888
    s_nop 0
    buffer_load_dwordx4 v8, s[16:19], s40 offen  lds
    s_add_u32 m0, s41, 38912
    s_nop 0
    buffer_load_dwordx4 v9, s[16:19], s40 offen  lds
    s_add_u32 m0, s41, 39936
    s_nop 0
    buffer_load_dwordx4 v10, s[16:19], s40 offen  lds
    s_add_u32 m0, s41, 40960
    s_nop 0
    buffer_load_dwordx4 v11, s[16:19], s40 offen  lds
    s_add_u32 m0, s41, 41984
    s_nop 0
    buffer_load_dwordx4 v12, s[16:19], s40 offen  lds
    s_add_u32 s40, s40, 262144
    s_buffer_load_dwordx2 s[50:51], s[52:55], s42 offset:655420
    s_buffer_load_dwordx2 s[50:51], s[52:55], s42 offset:688188
    s_buffer_load_dwordx2 s[50:51], s[52:55], s42 offset:720956
    s_buffer_load_dwordx2 s[50:51], s[52:55], s42 offset:753724
    s_waitcnt vmcnt(16)
    s_barrier
    s_add_u32 m0, s41, 69632
    s_nop 0
    buffer_load_dwordx4 v5, s[16:19], s40 offen  lds
    s_add_u32 m0, s41, 70656
    s_nop 0
    buffer_load_dwordx4 v6, s[16:19], s40 offen  lds
    s_add_u32 m0, s41, 71680
    s_nop 0
    buffer_load_dwordx4 v7, s[16:19], s40 offen  lds
    s_add_u32 m0, s41, 72704
    s_nop 0
    buffer_load_dwordx4 v8, s[16:19], s40 offen  lds
    s_add_u32 m0, s41, 73728
    s_nop 0
    buffer_load_dwordx4 v9, s[16:19], s40 offen  lds
    s_add_u32 m0, s41, 74752
    s_nop 0
    buffer_load_dwordx4 v10, s[16:19], s40 offen  lds
    s_add_u32 m0, s41, 75776
    s_nop 0
    buffer_load_dwordx4 v11, s[16:19], s40 offen  lds
    s_add_u32 m0, s41, 76800
    s_nop 0
    buffer_load_dwordx4 v12, s[16:19], s40 offen  lds
    s_add_u32 s40, s40, 262144
    s_buffer_load_dwordx2 s[50:51], s[52:55], s42 offset:786492
    s_buffer_load_dwordx2 s[50:51], s[52:55], s42 offset:819260
    s_buffer_load_dwordx2 s[50:51], s[52:55], s42 offset:852028
    s_buffer_load_dwordx2 s[50:51], s[52:55], s42 offset:884796
    s_waitcnt vmcnt(16)
    s_barrier
    s_add_u32 m0, s41, 104448
    s_nop 0
    buffer_load_dwordx4 v5, s[16:19], s40 offen  lds
    s_add_u32 m0, s41, 105472
    s_nop 0
    buffer_load_dwordx4 v6, s[16:19], s40 offen  lds
    s_add_u32 m0, s41, 106496
    s_nop 0
    buffer_load_dwordx4 v7, s[16:19], s40 offen  lds
    s_add_u32 m0, s41, 107520
    s_nop 0
    buffer_load_dwordx4 v8, s[16:19], s40 offen  lds
    s_add_u32 m0, s41, 108544
    s_nop 0
    buffer_load_dwordx4 v9, s[16:19], s40 offen  lds
    s_add_u32 m0, s41, 109568
    s_nop 0
    buffer_load_dwordx4 v10, s[16:19], s40 offen  lds
    s_add_u32 m0, s41, 110592
    s_nop 0
    buffer_load_dwordx4 v11, s[16:19], s40 offen  lds
    s_add_u32 m0, s41, 111616
    s_nop 0
    buffer_load_dwordx4 v12, s[16:19], s40 offen  lds
    s_add_u32 s40, s40, 262144
    s_buffer_load_dwordx2 s[50:51], s[52:55], s42 offset:917564
    s_buffer_load_dwordx2 s[50:51], s[52:55], s42 offset:950332
    s_buffer_load_dwordx2 s[50:51], s[52:55], s42 offset:983100
    s_buffer_load_dwordx2 s[50:51], s[52:55], s42 offset:1015868
    s_waitcnt vmcnt(16)
    s_barrier
    s_add_u32 m0, s41, 0
    s_nop 0
    buffer_load_dwordx4 v5, s[16:19], s40 offen  lds
    s_add_u32 m0, s41, 1024
    s_nop 0
    buffer_load_dwordx4 v6, s[16:19], s40 offen  lds
    s_add_u32 m0, s41, 2048
    s_nop 0
    buffer_load_dwordx4 v7, s[16:19], s40 offen  lds
    s_add_u32 m0, s41, 3072
    s_nop 0
    buffer_load_dwordx4 v8, s[16:19], s40 offen  lds
    s_add_u32 m0, s41, 4096
    s_nop 0
    buffer_load_dwordx4 v9, s[16:19], s40 offen  lds
    s_add_u32 m0, s41, 5120
    s_nop 0
    buffer_load_dwordx4 v10, s[16:19], s40 offen  lds
    s_add_u32 m0, s41, 6144
    s_nop 0
    buffer_load_dwordx4 v11, s[16:19], s40 offen  lds
    s_add_u32 m0, s41, 7168
    s_nop 0
    buffer_load_dwordx4 v12, s[16:19], s40 offen  lds
    s_add_u32 s40, s40, 262144
    s_add_u32 s42, s42, 1048576
    s_buffer_load_dwordx2 s[50:51], s[52:55], s42 offset:60
    s_buffer_load_dwordx2 s[50:51], s[52:55], s42 offset:32828
    s_buffer_load_dwordx2 s[50:51], s[52:55], s42 offset:65596
    s_buffer_load_dwordx2 s[50:51], s[52:55], s42 offset:98364
    s_waitcnt vmcnt(16)
    s_barrier
    s_add_u32 m0, s41, 34816
    s_nop 0
    buffer_load_dwordx4 v5, s[16:19], s40 offen  lds
    s_add_u32 m0, s41, 35840
    s_nop 0
    buffer_load_dwordx4 v6, s[16:19], s40 offen  lds
    s_add_u32 m0, s41, 36864
    s_nop 0
    buffer_load_dwordx4 v7, s[16:19], s40 offen  lds
    s_add_u32 m0, s41, 37888
    s_nop 0
    buffer_load_dwordx4 v8, s[16:19], s40 offen  lds
    s_add_u32 m0, s41, 38912
    s_nop 0
    buffer_load_dwordx4 v9, s[16:19], s40 offen  lds
    s_add_u32 m0, s41, 39936
    s_nop 0
    buffer_load_dwordx4 v10, s[16:19], s40 offen  lds
    s_add_u32 m0, s41, 40960
    s_nop 0
    buffer_load_dwordx4 v11, s[16:19], s40 offen  lds
    s_add_u32 m0, s41, 41984
    s_nop 0
    buffer_load_dwordx4 v12, s[16:19], s40 offen  lds
    s_add_u32 s40, s40, 262144
    s_buffer_load_dwordx2 s[50:51], s[52:55], s42 offset:131132
    s_buffer_load_dwordx2 s[50:51], s[52:55], s42 offset:163900
    s_buffer_load_dwordx2 s[50:51], s[52:55], s42 offset:196668
    s_buffer_load_dwordx2 s[50:51], s[52:55], s42 offset:229436
    s_waitcnt vmcnt(16)
    s_barrier
    s_add_u32 m0, s41, 69632
    s_nop 0
    buffer_load_dwordx4 v5, s[16:19], s40 offen  lds
    s_add_u32 m0, s41, 70656
    s_nop 0
    buffer_load_dwordx4 v6, s[16:19], s40 offen  lds
    s_add_u32 m0, s41, 71680
    s_nop 0
    buffer_load_dwordx4 v7, s[16:19], s40 offen  lds
    s_add_u32 m0, s41, 72704
    s_nop 0
    buffer_load_dwordx4 v8, s[16:19], s40 offen  lds
    s_add_u32 m0, s41, 73728
    s_nop 0
    buffer_load_dwordx4 v9, s[16:19], s40 offen  lds
    s_add_u32 m0, s41, 74752
    s_nop 0
    buffer_load_dwordx4 v10, s[16:19], s40 offen  lds
    s_add_u32 m0, s41, 75776
    s_nop 0
    buffer_load_dwordx4 v11, s[16:19], s40 offen  lds
    s_add_u32 m0, s41, 76800
    s_nop 0
    buffer_load_dwordx4 v12, s[16:19], s40 offen  lds
    s_add_u32 s40, s40, 262144
    s_buffer_load_dwordx2 s[50:51], s[52:55], s42 offset:262204
    s_buffer_load_dwordx2 s[50:51], s[52:55], s42 offset:294972
    s_buffer_load_dwordx2 s[50:51], s[52:55], s42 offset:327740
    s_buffer_load_dwordx2 s[50:51], s[52:55], s42 offset:360508
    s_waitcnt vmcnt(16)
    s_barrier
    s_add_u32 m0, s41, 104448
    s_nop 0
    buffer_load_dwordx4 v5, s[16:19], s40 offen  lds
    s_add_u32 m0, s41, 105472
    s_nop 0
    buffer_load_dwordx4 v6, s[16:19], s40 offen  lds
    s_add_u32 m0, s41, 106496
    s_nop 0
    buffer_load_dwordx4 v7, s[16:19], s40 offen  lds
    s_add_u32 m0, s41, 107520
    s_nop 0
    buffer_load_dwordx4 v8, s[16:19], s40 offen  lds
    s_add_u32 m0, s41, 108544
    s_nop 0
    buffer_load_dwordx4 v9, s[16:19], s40 offen  lds
    s_add_u32 m0, s41, 109568
    s_nop 0
    buffer_load_dwordx4 v10, s[16:19], s40 offen  lds
    s_add_u32 m0, s41, 110592
    s_nop 0
    buffer_load_dwordx4 v11, s[16:19], s40 offen  lds
    s_add_u32 m0, s41, 111616
    s_nop 0
    buffer_load_dwordx4 v12, s[16:19], s40 offen  lds
    s_add_u32 s40, s40, 262144
    s_buffer_load_dwordx2 s[50:51], s[52:55], s42 offset:393276
    s_buffer_load_dwordx2 s[50:51], s[52:55], s42 offset:426044
    s_buffer_load_dwordx2 s[50:51], s[52:55], s42 offset:458812
    s_buffer_load_dwordx2 s[50:51], s[52:55], s42 offset:491580
    s_waitcnt vmcnt(16)
    s_barrier
    s_add_u32 m0, s41, 0
    s_nop 0
    buffer_load_dwordx4 v5, s[16:19], s40 offen  lds
    s_add_u32 m0, s41, 1024
    s_nop 0
    buffer_load_dwordx4 v6, s[16:19], s40 offen  lds
    s_add_u32 m0, s41, 2048
    s_nop 0
    buffer_load_dwordx4 v7, s[16:19], s40 offen  lds
    s_add_u32 m0, s41, 3072
    s_nop 0
    buffer_load_dwordx4 v8, s[16:19], s40 offen  lds
    s_add_u32 m0, s41, 4096
    s_nop 0
    buffer_load_dwordx4 v9, s[16:19], s40 offen  lds
    s_add_u32 m0, s41, 5120
    s_nop 0
    buffer_load_dwordx4 v10, s[16:19], s40 offen  lds
    s_add_u32 m0, s41, 6144
    s_nop 0
    buffer_load_dwordx4 v11, s[16:19], s40 offen  lds
    s_add_u32 m0, s41, 7168
    s_nop 0
    buffer_load_dwordx4 v12, s[16:19], s40 offen  lds
    s_add_u32 s40, s40, 262144
    s_waitcnt vmcnt(16)
    s_barrier
    s_add_u32 m0, s41, 34816
    s_nop 0
    buffer_load_dwordx4 v5, s[16:19], s40 offen  lds
    s_add_u32 m0, s41, 35840
    s_nop 0
    buffer_load_dwordx4 v6, s[16:19], s40 offen  lds
    s_add_u32 m0, s41, 36864
    s_nop 0
    buffer_load_dwordx4 v7, s[16:19], s40 offen  lds
    s_add_u32 m0, s41, 37888
    s_nop 0
    buffer_load_dwordx4 v8, s[16:19], s40 offen  lds
    s_add_u32 m0, s41, 38912
    s_nop 0
    buffer_load_dwordx4 v9, s[16:19], s40 offen  lds
    s_add_u32 m0, s41, 39936
    s_nop 0
    buffer_load_dwordx4 v10, s[16:19], s40 offen  lds
    s_add_u32 m0, s41, 40960
    s_nop 0
    buffer_load_dwordx4 v11, s[16:19], s40 offen  lds
    s_add_u32 m0, s41, 41984
    s_nop 0
    buffer_load_dwordx4 v12, s[16:19], s40 offen  lds
    s_add_u32 s40, s40, 262144
    s_waitcnt vmcnt(16)
    s_barrier
    s_waitcnt vmcnt(8)
    s_barrier
    s_waitcnt vmcnt(0)
    s_barrier
    s_waitcnt vmcnt(0)
    s_barrier
L_m_l2_done:
    s_waitcnt lgkmcnt(0)
    s_barrier
L_m_t2_fin:
    s_lshr_b32 s38, s24, 2
    s_and_b32 s39, s24, 3
    s_lshl_b32 s39, s39, 2
    s_add_u32 s39, s39, s38
    s_lshl_b32 s70, s39, 10
    s_add_u32 s71, s24, 16
    s_lshl_b32 s71, s71, 10
    v_add_u32 v4, s70, v3
    v_add_u32 v5, s71, v3
    ds_read_b128 v[32:35], v4
    ds_read_b128 v[36:39], v4 offset:2048
    ds_read_b128 v[40:43], v5
    s_lshl_b32 s38, s37, 2
    s_add_u32 s38, s38, s34
    s_lshl_b32 s38, s38, 2
    s_add_u32 s38, s38, s36
    s_lshl_b32 s57, s38, 9
    s_add_u32 s57, s57, 31719424

    s_mul_i32 s55, s38, 27648
    s_add_u32 s55, s55, 42991616
    s_lshl_b32 s72, s24, 10
    s_add_u32 s54, s55, s72
    s_add_u32 s56, s54, 9216
    s_add_u32 s57, s54, 18432
    s_lshl_b32 s72, s24, 3
    s_add_u32 s72, s72, 8192
    s_add_u32 s70, s55, s72
    s_add_u32 s71, s70, 9216
    s_add_u32 s72, s70, 18432
    s_mov_b32 s48, 0x7c017c01

    s_mov_b64 s[50:51], 15
    s_mov_b64 s[52:53], 15
    s_mov_b64 s[60:61], 15
    s_mov_b32 s49, 0
L_m_sx2l:
    s_mov_b64 exec, s[50:51]
    buffer_load_dwordx4 v[44:47], v3, s[12:15], s54 offen sc1
    s_mov_b64 exec, s[52:53]
    buffer_load_dwordx4 v[50:53], v3, s[12:15], s56 offen sc1
    s_mov_b64 exec, s[60:61]
    buffer_load_dwordx4 v[56:59], v3, s[12:15], s57 offen sc1
    s_waitcnt vmcnt(0)
    s_mov_b64 exec, s[50:51]
    v_cmp_eq_u32 s[50:51], s48, v44
    v_cmp_eq_u32 vcc, s48, v45
    s_or_b64 s[50:51], s[50:51], vcc
    v_cmp_eq_u32 vcc, s48, v46
    s_or_b64 s[50:51], s[50:51], vcc
    v_cmp_eq_u32 vcc, s48, v47
    s_or_b64 s[50:51], s[50:51], vcc
    s_mov_b64 exec, s[52:53]
    v_cmp_eq_u32 s[52:53], s48, v50
    v_cmp_eq_u32 vcc, s48, v51
    s_or_b64 s[52:53], s[52:53], vcc
    v_cmp_eq_u32 vcc, s48, v52
    s_or_b64 s[52:53], s[52:53], vcc
    v_cmp_eq_u32 vcc, s48, v53
    s_or_b64 s[52:53], s[52:53], vcc
    s_mov_b64 exec, s[60:61]
    v_cmp_eq_u32 s[60:61], s48, v56
    v_cmp_eq_u32 vcc, s48, v57
    s_or_b64 s[60:61], s[60:61], vcc
    v_cmp_eq_u32 vcc, s48, v58
    s_or_b64 s[60:61], s[60:61], vcc
    v_cmp_eq_u32 vcc, s48, v59
    s_or_b64 s[60:61], s[60:61], vcc
    s_or_b64 vcc, s[50:51], s[52:53]
    s_or_b64 vcc, vcc, s[60:61]
    s_cmp_eq_u64 vcc, 0
    s_cbranch_scc1 L_m_sx2l_ok
    s_add_u32 s49, s49, 1
    s_cmp_gt_u32 s49, 8000
    s_cbranch_scc1 L_m_sx2l_ok
    s_sleep 1
    s_branch L_m_sx2l
L_m_sx2l_ok:
    s_mov_b64 exec, -1
    s_mov_b64 s[50:51], -1
    s_mov_b64 s[52:53], -1
    s_mov_b64 s[60:61], -1
    s_cmp_lt_u32 s24, 2
    s_cselect_b64 s[74:75], -1, 0
    s_cmp_lt_u32 s24, 2
    s_cselect_b64 s[76:77], -1, 0
    s_cmp_lt_u32 s24, 2
    s_cselect_b64 s[78:79], -1, 0
    s_mov_b32 s49, 0
L_m_sx2:
    s_mov_b64 exec, s[50:51]
    buffer_load_dwordx4 v[44:47], v3, s[12:15], s54 offen sc1
    s_mov_b64 exec, s[52:53]
    buffer_load_dwordx4 v[50:53], v3, s[12:15], s56 offen sc1
    s_mov_b64 exec, s[60:61]
    buffer_load_dwordx4 v[56:59], v3, s[12:15], s57 offen sc1
    s_mov_b64 exec, s[74:75]
    buffer_load_dwordx2 v[48:49], v3, s[12:15], s70 offen sc1
    s_mov_b64 exec, s[76:77]
    buffer_load_dwordx2 v[54:55], v3, s[12:15], s71 offen sc1
    s_mov_b64 exec, s[78:79]
    buffer_load_dwordx2 v[60:61], v3, s[12:15], s72 offen sc1
    s_waitcnt vmcnt(0)
    s_mov_b64 exec, s[50:51]
    v_cmp_eq_u32 s[50:51], s48, v44
    v_cmp_eq_u32 vcc, s48, v45
    s_or_b64 s[50:51], s[50:51], vcc
    v_cmp_eq_u32 vcc, s48, v46
    s_or_b64 s[50:51], s[50:51], vcc
    v_cmp_eq_u32 vcc, s48, v47
    s_or_b64 s[50:51], s[50:51], vcc
    s_mov_b64 exec, s[52:53]
    v_cmp_eq_u32 s[52:53], s48, v50
    v_cmp_eq_u32 vcc, s48, v51
    s_or_b64 s[52:53], s[52:53], vcc
    v_cmp_eq_u32 vcc, s48, v52
    s_or_b64 s[52:53], s[52:53], vcc
    v_cmp_eq_u32 vcc, s48, v53
    s_or_b64 s[52:53], s[52:53], vcc
    s_mov_b64 exec, s[60:61]
    v_cmp_eq_u32 s[60:61], s48, v56
    v_cmp_eq_u32 vcc, s48, v57
    s_or_b64 s[60:61], s[60:61], vcc
    v_cmp_eq_u32 vcc, s48, v58
    s_or_b64 s[60:61], s[60:61], vcc
    v_cmp_eq_u32 vcc, s48, v59
    s_or_b64 s[60:61], s[60:61], vcc
    s_mov_b64 exec, s[74:75]
    v_cmp_eq_u32 s[74:75], s48, v48
    v_cmp_eq_u32 vcc, s48, v49
    s_or_b64 s[74:75], s[74:75], vcc
    s_mov_b64 exec, s[76:77]
    v_cmp_eq_u32 s[76:77], s48, v54
    v_cmp_eq_u32 vcc, s48, v55
    s_or_b64 s[76:77], s[76:77], vcc
    s_mov_b64 exec, s[78:79]
    v_cmp_eq_u32 s[78:79], s48, v60
    v_cmp_eq_u32 vcc, s48, v61
    s_or_b64 s[78:79], s[78:79], vcc
    s_or_b64 vcc, s[50:51], s[52:53]
    s_or_b64 vcc, vcc, s[60:61]
    s_or_b64 vcc, vcc, s[74:75]
    s_or_b64 vcc, vcc, s[76:77]
    s_or_b64 vcc, vcc, s[78:79]
    s_cmp_eq_u64 vcc, 0
    s_cbranch_scc1 L_m_sx2_ok
    s_add_u32 s49, s49, 1
    s_cmp_gt_u32 s49, 8000
    s_cbranch_scc1 L_m_sx2_ok
    s_branch L_m_sx2
L_m_sx2_ok:
    s_mov_b64 exec, -1
    v_lshlrev_b32 v158, 16, v158
    v_lshlrev_b32 v159, 16, v159
    s_waitcnt vmcnt(0) lgkmcnt(0)
    v_fma_mix_f32 v32, v44, 1.0, v32 op_sel:[0,0,0] op_sel_hi:[1,0,0]
    v_fma_mix_f32 v33, v44, 1.0, v33 op_sel:[1,0,0] op_sel_hi:[1,0,0]
    v_fma_mix_f32 v34, v45, 1.0, v34 op_sel:[0,0,0] op_sel_hi:[1,0,0]
    v_fma_mix_f32 v35, v45, 1.0, v35 op_sel:[1,0,0] op_sel_hi:[1,0,0]
    v_fma_mix_f32 v32, v50, 1.0, v32 op_sel:[0,0,0] op_sel_hi:[1,0,0]
    v_fma_mix_f32 v33, v50, 1.0, v33 op_sel:[1,0,0] op_sel_hi:[1,0,0]
    v_fma_mix_f32 v34, v51, 1.0, v34 op_sel:[0,0,0] op_sel_hi:[1,0,0]
    v_fma_mix_f32 v35, v51, 1.0, v35 op_sel:[1,0,0] op_sel_hi:[1,0,0]
    v_fma_mix_f32 v32, v56, 1.0, v32 op_sel:[0,0,0] op_sel_hi:[1,0,0]
    v_fma_mix_f32 v33, v56, 1.0, v33 op_sel:[1,0,0] op_sel_hi:[1,0,0]
    v_fma_mix_f32 v34, v57, 1.0, v34 op_sel:[0,0,0] op_sel_hi:[1,0,0]
    v_fma_mix_f32 v35, v57, 1.0, v35 op_sel:[1,0,0] op_sel_hi:[1,0,0]
    v_cvt_pk_bf16_f32 v140, v32, v33
    v_cvt_pk_bf16_f32 v141, v34, v35
    v_lshlrev_b32 v32, 16, v140
    v_and_b32 v33, 0xffff0000, v140
    v_lshlrev_b32 v34, 16, v141
    v_and_b32 v35, 0xffff0000, v141
    v_add_f32 v32, v32, v158
    v_add_f32 v33, v33, v158
    v_add_f32 v34, v34, v158
    v_add_f32 v35, v35, v158
    v_cvt_pk_bf16_f32 v140, v32, v33
    v_cvt_pk_bf16_f32 v141, v34, v35
    v_lshlrev_b32 v32, 16, v140
    v_and_b32 v33, 0xffff0000, v140
    v_lshlrev_b32 v34, 16, v141
    v_and_b32 v35, 0xffff0000, v141
    v_lshlrev_b32 v142, 16, v116
    v_lshlrev_b32 v143, 16, v108
    v_add_f32 v32, v32, v142
    v_add_f32 v33, v33, v143
    v_lshlrev_b32 v142, 16, v117
    v_lshlrev_b32 v143, 16, v109
    v_add_f32 v34, v34, v142
    v_add_f32 v35, v35, v143
    v_fma_mix_f32 v36, v46, 1.0, v36 op_sel:[0,0,0] op_sel_hi:[1,0,0]
    v_fma_mix_f32 v37, v46, 1.0, v37 op_sel:[1,0,0] op_sel_hi:[1,0,0]
    v_fma_mix_f32 v38, v47, 1.0, v38 op_sel:[0,0,0] op_sel_hi:[1,0,0]
    v_fma_mix_f32 v39, v47, 1.0, v39 op_sel:[1,0,0] op_sel_hi:[1,0,0]
    v_fma_mix_f32 v36, v52, 1.0, v36 op_sel:[0,0,0] op_sel_hi:[1,0,0]
    v_fma_mix_f32 v37, v52, 1.0, v37 op_sel:[1,0,0] op_sel_hi:[1,0,0]
    v_fma_mix_f32 v38, v53, 1.0, v38 op_sel:[0,0,0] op_sel_hi:[1,0,0]
    v_fma_mix_f32 v39, v53, 1.0, v39 op_sel:[1,0,0] op_sel_hi:[1,0,0]
    v_fma_mix_f32 v36, v58, 1.0, v36 op_sel:[0,0,0] op_sel_hi:[1,0,0]
    v_fma_mix_f32 v37, v58, 1.0, v37 op_sel:[1,0,0] op_sel_hi:[1,0,0]
    v_fma_mix_f32 v38, v59, 1.0, v38 op_sel:[0,0,0] op_sel_hi:[1,0,0]
    v_fma_mix_f32 v39, v59, 1.0, v39 op_sel:[1,0,0] op_sel_hi:[1,0,0]
    v_cvt_pk_bf16_f32 v140, v36, v37
    v_cvt_pk_bf16_f32 v141, v38, v39
    v_lshlrev_b32 v36, 16, v140
    v_and_b32 v37, 0xffff0000, v140
    v_lshlrev_b32 v38, 16, v141
    v_and_b32 v39, 0xffff0000, v141
    v_add_f32 v36, v36, v158
    v_add_f32 v37, v37, v158
    v_add_f32 v38, v38, v158
    v_add_f32 v39, v39, v158
    v_cvt_pk_bf16_f32 v140, v36, v37
    v_cvt_pk_bf16_f32 v141, v38, v39
    v_lshlrev_b32 v36, 16, v140
    v_and_b32 v37, 0xffff0000, v140
    v_lshlrev_b32 v38, 16, v141
    v_and_b32 v39, 0xffff0000, v141
    v_lshlrev_b32 v142, 16, v118
    v_lshlrev_b32 v143, 16, v110
    v_add_f32 v36, v36, v142
    v_add_f32 v37, v37, v143
    v_lshlrev_b32 v142, 16, v119
    v_lshlrev_b32 v143, 16, v111
    v_add_f32 v38, v38, v142
    v_add_f32 v39, v39, v143
    v_cvt_pk_bf16_f32 v144, v32, v33
    v_cvt_pk_bf16_f32 v145, v34, v35
    v_cvt_pk_bf16_f32 v146, v36, v37
    v_cvt_pk_bf16_f32 v147, v38, v39
    buffer_store_dwordx4 v[144:147], v156, s[64:67], s68 offen
    s_cmp_ge_u32 s24, 2
    s_cbranch_scc1 L_m_fin

    v_fma_mix_f32 v40, v48, 1.0, v40 op_sel:[0,0,0] op_sel_hi:[1,0,0]
    v_fma_mix_f32 v41, v48, 1.0, v41 op_sel:[1,0,0] op_sel_hi:[1,0,0]
    v_fma_mix_f32 v42, v49, 1.0, v42 op_sel:[0,0,0] op_sel_hi:[1,0,0]
    v_fma_mix_f32 v43, v49, 1.0, v43 op_sel:[1,0,0] op_sel_hi:[1,0,0]
    v_fma_mix_f32 v40, v54, 1.0, v40 op_sel:[0,0,0] op_sel_hi:[1,0,0]
    v_fma_mix_f32 v41, v54, 1.0, v41 op_sel:[1,0,0] op_sel_hi:[1,0,0]
    v_fma_mix_f32 v42, v55, 1.0, v42 op_sel:[0,0,0] op_sel_hi:[1,0,0]
    v_fma_mix_f32 v43, v55, 1.0, v43 op_sel:[1,0,0] op_sel_hi:[1,0,0]
    v_fma_mix_f32 v40, v60, 1.0, v40 op_sel:[0,0,0] op_sel_hi:[1,0,0]
    v_fma_mix_f32 v41, v60, 1.0, v41 op_sel:[1,0,0] op_sel_hi:[1,0,0]
    v_fma_mix_f32 v42, v61, 1.0, v42 op_sel:[0,0,0] op_sel_hi:[1,0,0]
    v_fma_mix_f32 v43, v61, 1.0, v43 op_sel:[1,0,0] op_sel_hi:[1,0,0]
    v_cvt_pk_bf16_f32 v140, v40, v41
    v_cvt_pk_bf16_f32 v141, v42, v43
    v_lshlrev_b32 v40, 16, v140
    v_and_b32 v41, 0xffff0000, v140
    v_lshlrev_b32 v42, 16, v141
    v_and_b32 v43, 0xffff0000, v141
    v_add_f32 v40, v40, v159
    v_add_f32 v41, v41, v159
    v_add_f32 v42, v42, v159
    v_add_f32 v43, v43, v159
    v_cvt_pk_bf16_f32 v140, v40, v41
    v_cvt_pk_bf16_f32 v141, v42, v43
    v_lshlrev_b32 v40, 16, v140
    v_and_b32 v41, 0xffff0000, v140
    v_lshlrev_b32 v42, 16, v141
    v_and_b32 v43, 0xffff0000, v141
    v_lshlrev_b32 v142, 16, v120
    v_lshlrev_b32 v143, 16, v112
    v_add_f32 v40, v40, v142
    v_add_f32 v41, v41, v143
    v_lshlrev_b32 v142, 16, v121
    v_lshlrev_b32 v143, 16, v113
    v_add_f32 v42, v42, v142
    v_add_f32 v43, v43, v143
    v_cvt_pk_bf16_f32 v148, v40, v41
    v_cvt_pk_bf16_f32 v149, v42, v43
    buffer_store_dwordx2 v[148:149], v157, s[64:67], s69 offen

L_m_fin:
L_all_end:
    s_endpgm
.section .rodata,"a"
.p2align 6
.amdhsa_kernel sequential_preLN__ssm_conv_s4d__mixer_token_mlp__prompt_kernel
  .amdhsa_next_free_vgpr 256
  .amdhsa_next_free_sgpr 102
  .amdhsa_accum_offset 160
  .amdhsa_group_segment_fixed_size 0
  .amdhsa_kernarg_size 120
  .amdhsa_user_sgpr_count 2
  .amdhsa_user_sgpr_kernarg_segment_ptr 1
  .amdhsa_system_sgpr_workgroup_id_x 1
.end_amdhsa_kernel
```
